```python
import torch

def _softmax(x, axis=-1):
    return torch.softmax(x, dim=axis)
def _gelu(x):
    return torch.nn.functional.gelu(x, approximate="tanh")
def _silu(x):
    return torch.nn.functional.silu(x)
def _sigmoid(x):
    return torch.sigmoid(x)
def _layernorm(x, axis=-1, eps=1e-5):
    m = x.mean(dim=axis, keepdim=True)
    v = x.var(dim=axis, keepdim=True, unbiased=False)
    return (x - m) / torch.sqrt(v + eps)
def _scatter_add(tgt, idx, src, axis=0):
    return tgt.clone().index_add_(axis, idx, src)
def _segment_sum(src, seg, n):
    out = torch.zeros((n,) + src.shape[1:], dtype=src.dtype)
    return out.index_add_(0, seg, src)
def _pad(x, pw):
    flat = tuple(v for pair in reversed(pw) for v in pair)
    return torch.nn.functional.pad(x, flat)

kernel_name = 'parallel_sum__sliding_local_dilated__dense_activation_relu__prompt'

def setup_inputs():

    _w = (lambda a: (lambda t: t.to(torch.bfloat16) if t.is_floating_point() else t)(torch.as_tensor(a)))
    def _A_setup():
        B, S, D = 1, 2048, 512
        return {
            "x": _w((lambda *s: torch.randn(*s, dtype=torch.bfloat16) * 0.05)(B, S, D)),
            "wqkv": _w((lambda *s: torch.randn(*s, dtype=torch.bfloat16) * 0.05)(D, 3 * D)),
            "wo": _w((lambda *s: torch.randn(*s, dtype=torch.bfloat16) * 0.05)(D, D)),
        }
    _A_in = _A_setup()

    def _B_setup():
        B, S, D, Dff = 1, 2048, 512, 1376
        return {
            "x": _w((lambda *s: torch.randn(*s, dtype=torch.bfloat16) * 0.05)(B, S, D)),
            "w1": _w((lambda *s: torch.randn(*s, dtype=torch.bfloat16) * 0.05)(D, Dff)),
            "w2": _w((lambda *s: torch.randn(*s, dtype=torch.bfloat16) * 0.05)(Dff, D)),
        }
    _B_in = _B_setup()

    return {
        "A_x": _A_in["x"],
        "A_wqkv": _A_in["wqkv"],
        "A_wo": _A_in["wo"],
        "B_x": _B_in["x"],
        "B_w1": _B_in["w1"],
        "B_w2": _B_in["w2"],
    }

def reference(A_x, A_wqkv, A_wo, B_x, B_w1, B_w2):
    def _A_ref(x, wqkv, wo):
        B, S, D = x.shape
        H = 32; Dh = D // H
        W, dil = 8, 2
        qkv = (lambda x, *d: x.permute(*d))((x @ wqkv).reshape(B, S, 3, H, Dh), 2, 0, 3, 1, 4)
        q, k, v = qkv[0], qkv[1], qkv[2]
        scale = Dh ** -0.5
        pos = torch.arange(S)
        off = torch.arange(W) * dil
        idx = pos[:, None] - off[None, :]
        mask = idx >= 0
        idx_c = torch.where(mask, idx, 0).reshape(-1)
        kg = k[:, :, idx_c, :].reshape(B, H, S, W, Dh)
        vg = v[:, :, idx_c, :].reshape(B, H, S, W, Dh)
        logits = torch.einsum("bhsd,bhswd->bhsw", q, kg) * scale
        logits = torch.where(mask[None, None, :, :], logits, -1e9)
        attn = _softmax(logits, axis=-1)
        o = torch.einsum("bhsw,bhswd->bhsd", attn, vg)
        return (lambda x, *d: x.permute(*d))(o, 0, 2, 1, 3).reshape(B, S, D) @ wo

    def _B_ref(x, w1, w2):
        h = torch.einsum("bsd,df->bsf", x, w1)
        zero = torch.zeros_like(h)
        h = torch.maximum(h, zero)
        return torch.einsum("bsf,fd->bsd", h, w2)

    x = A_x
    xn = _layernorm(x, axis=-1)
    return x + _A_ref(xn, A_wqkv, A_wo) + _B_ref(xn, B_w1, B_w2)
```

```asm
; @launch grid=(256,1,1) block=(256,1,1) lds=163840
.amdgcn_target "amdgcn-amd-amdhsa--gfx950"
.text
.globl parallel_sum__sliding_local_dilated__dense_activation_relu__prompt_kernel
.p2align 12
.fill 832, 4, 0xbf810000
.p2align 8
.type parallel_sum__sliding_local_dilated__dense_activation_relu__prompt_kernel,@function
parallel_sum__sliding_local_dilated__dense_activation_relu__prompt_kernel:
    s_cmp_ge_u32 s2, 256
    s_cbranch_scc1 L_end
    s_lshr_b32 s35, s2, 4
    s_and_b32 s35, s35, 1
    s_cmp_eq_u32 s35, 0
    s_cselect_b32 s3, 8, 32
    s_load_dwordx2 s[4:5], s[0:1], 0
    s_load_dwordx2 s[8:9], s[0:1], s3
    s_load_dwordx2 s[12:13], s[0:1], 64
    s_load_dwordx2 s[16:17], s[0:1], 56
    s_load_dwordx2 s[20:21], s[0:1], 40
    s_load_dwordx2 s[24:25], s[0:1], 16
    s_load_dwordx2 s[28:29], s[0:1], 48
    s_memrealtime s[58:59]
    v_and_b32 v239, 63, v0
    v_lshrrev_b32 v5, 6, v0
    v_lshrrev_b32 v1, 3, v239
    v_readfirstlane_b32 s32, v5
    v_and_b32 v2, 7, v239
    v_lshrrev_b32 v3, 4, v239
    v_and_b32 v4, 15, v239
    s_mov_b32 s6, 0x200000
    s_mov_b32 s7, 0x20000
    s_cmp_eq_u32 s35, 0
    s_mov_b32 s10, 1411072
    s_cselect_b32 s10, 1572864, s10
    s_mov_b32 s11, 0x20000
    s_and_b32 s54, s2, 7
    s_lshr_b32 s55, s2, 3
    s_lshr_b32 s56, s54, 1
    s_lshl_b32 s56, s56, 2
    s_lshr_b32 s57, s55, 3
    s_add_u32 s33, s56, s57
    s_and_b32 s56, s54, 1
    s_lshl_b32 s56, s56, 2
    s_bfe_u32 s57, s55, 0x10002
    s_lshl_b32 s57, s57, 1
    s_add_u32 s56, s56, s57
    s_and_b32 s57, s55, 1
    s_add_u32 s34, s56, s57
    s_lshr_b32 s56, s54, 1
    s_lshl_b32 s56, s56, 3
    s_lshr_b32 s57, s55, 2
    s_add_u32 s68, s56, s57
    s_and_b32 s56, s54, 1
    s_lshl_b32 s56, s56, 2
    s_and_b32 s57, s55, 3
    s_add_u32 s69, s56, s57
    s_lshr_b32 s54, s34, 1
    s_mul_i32 s54, s54, 11
    s_and_b32 s55, s34, 1
    s_mul_i32 s56, s55, 6
    s_add_u32 s54, s54, s56
    s_cmp_eq_u32 s34, 7
    s_subb_u32 s74, s54, 0
    s_cmp_eq_u32 s34, 6
    s_cselect_b32 s56, 1, s55
    s_sub_u32 s101, 6, s56
    s_lshl_b32 s54, s33, 7
    s_lshl_b32 s55, s32, 5
    s_add_u32 s55, s55, s54
    v_add_u32 v5, s55, v1
    v_xor_b32 v6, v2, v3
    v_lshlrev_b32 v6, 4, v6
    v_lshl_add_u32 v220, v5, 10, v6
    v_add_u32 v221, 0x1c00, v220
    v_xor_b32 v221, 64, v221
    v_add_u32 v222, 0x3800, v220
    v_add_u32 v223, 0x3800, v221
    s_and_b32 s55, s32, 1
    s_lshl_b32 s55, s55, 4
    s_lshr_b32 s56, s32, 1
    s_lshl_b32 s56, s56, 2
    s_add_u32 s55, s55, s56
    v_lshrrev_b32 v5, 5, v239
    v_lshlrev_b32 v5, 3, v5
    v_and_b32 v6, 3, v1
    v_add3_u32 v5, v5, v6, s55
    v_lshlrev_b32 v6, 1, v3
    v_xor_b32 v6, v2, v6
    v_lshlrev_b32 v6, 4, v6
    s_cmp_eq_u32 s35, 0
    s_mov_b32 s56, 2752
    s_cselect_b32 s56, 3072, s56
    s_lshl_b32 s57, s34, 7
    s_lshl_b32 s52, s74, 6
    s_cmp_eq_u32 s35, 0
    s_cselect_b32 s57, s57, s52
    s_cselect_b32 s55, 0, -896
    s_cselect_b32 s36, 0, 2048
    v_add_u32 v6, s57, v6
    v_mad_u32_u24 v225, v5, s56, v6
    s_add_u32 s37, s36, s55
    s_add_u32 s38, s37, s55
    s_lshl_b32 s39, s56, 5
    s_add_u32 s39, s39, s36
    s_add_u32 s40, s39, s55
    s_add_u32 s41, s40, s55
    s_lshl_b32 s46, s56, 6
    s_mov_b32 s42, 0
    s_lshl_b32 s54, s32, 12
    s_add_u32 s43, s54, 2048
    s_mul_i32 s54, s32, 6144
    s_add_u32 s44, s54, 18432
    s_cmp_eq_u32 s35, 0
    s_cbranch_scc1 L_mlp
    s_cmp_eq_u32 s101, 5
    s_cselect_b32 s54, 0x40000000, 0
    v_lshrrev_b32 v206, 2, v2
    v_lshrrev_b32 v207, 5, v239
    v_xor_b32 v206, v206, v207
    v_lshlrev_b32 v206, 30, v206
    v_and_b32 v206, s54, v206
    v_add_u32 v206, v206, v225
    s_waitcnt lgkmcnt(0)
    s_sub_u32 s8, s8, 2048
    s_subb_u32 s9, s9, 0
    s_add_u32 m0, s43, 0
    s_nop 0
    buffer_load_dwordx4 v220, s[4:7], s42 offen lds
    buffer_load_dwordx4 v221, s[4:7], s42 offen offset:1024 lds
    buffer_load_dwordx4 v222, s[4:7], s42 offen offset:2048 lds
    buffer_load_dwordx4 v223, s[4:7], s42 offen offset:3072 lds
    s_add_u32 m0, s44, 0
    s_nop 0
    buffer_load_dwordx4 v225, s[8:11], s36 offen lds
    buffer_load_dwordx4 v225, s[8:11], s37 offen offset:1024 lds
    buffer_load_dwordx4 v206, s[8:11], s38 offen offset:2048 lds
    s_add_u32 m0, s44, 3072
    s_nop 0
    buffer_load_dwordx4 v225, s[8:11], s39 offen lds
    buffer_load_dwordx4 v225, s[8:11], s40 offen offset:1024 lds
    buffer_load_dwordx4 v206, s[8:11], s41 offen offset:2048 lds
    v_add_u32 v225, s46, v225
    v_add_u32 v206, s46, v206
    s_add_u32 s42, s42, 128
    s_mov_b32 s14, 7864320
    s_mov_b32 s15, 0x20000
    s_mov_b32 s18, 256
    s_mov_b32 s19, 0x20000
    s_mov_b32 s22, 1409024
    s_mov_b32 s23, 0x20000
    s_mov_b32 s26, 524288
    s_mov_b32 s27, 0x20000
    s_mov_b32 s30, 0x200000
    s_mov_b32 s31, 0x20000
    s_and_b32 s54, s2, 15
    s_lshr_b32 s55, s2, 5
    s_lshl_b32 s55, s55, 4
    s_or_b32 s54, s54, s55
    s_lshl_b32 s54, s54, 2
    s_add_u32 s54, s54, s32
    v_lshlrev_b32 v200, 7, v239
    s_cmp_ge_u32 s54, 172
    s_cbranch_scc1 L_pfn_2
    s_sub_u32 s55, s54, 0
    s_lshl_b32 s55, s55, 13
    s_add_u32 s55, s55, 2048
    buffer_load_dword a240, v200, s[8:11], s55 offen
    s_branch L_pfd_1
L_pfn_2:
    s_sub_u32 s55, s54, 172
    s_lshl_b32 s55, s55, 13
    buffer_load_dword a241, v200, s[20:23], s55 offen
L_pfd_1:
    s_mov_b32 s99, 1
    s_cmp_eq_u32 s32, 0
    s_cbranch_scc1 L_pad_m1
    s_cmp_eq_u32 s32, 1
    s_cbranch_scc1 L_pad_m2
    s_cmp_eq_u32 s32, 2
    s_cbranch_scc1 L_pad_m3
    s_cmp_eq_u32 s32, 3
    s_cbranch_scc1 L_pad_m4
L_padback_m:
    s_mov_b32 s99, 0
    s_add_u32 m0, s43, 43008
    v_lshlrev_b32 v240, 4, v239
    buffer_load_dwordx4 v220, s[4:7], s42 offen lds
    v_mov_b32 v212, 0x3f803f80
    v_mov_b32 v213, 0x3f803f80
    v_mov_b32 v214, 0x3f803f80
    v_mov_b32 v215, 0x3f803f80
    v_lshrrev_b32 v5, 1, v4
    v_xor_b32 v5, v5, v3
    buffer_load_dwordx4 v221, s[4:7], s42 offen offset:1024 lds
    v_lshlrev_b32 v5, 4, v5
    v_lshl_add_u32 v5, v4, 7, v5
    s_and_b32 s100, s32, 1
    s_lshl_b32 s54, s100, 13
    s_add_u32 s54, s54, 2048
    v_add_u32 v216, s54, v5
    buffer_load_dwordx4 v222, s[4:7], s42 offen offset:2048 lds
    v_xor_b32 v217, 64, v216
    v_bfe_u32 v7, v239, 2, 2
    v_and_b32 v8, 3, v239
    v_and_b32 v5, 1, v3
    v_lshl_add_u32 v5, v5, 2, v7
    v_lshrrev_b32 v6, 1, v5
    buffer_load_dwordx4 v223, s[4:7], s42 offen offset:3072 lds
    v_lshlrev_b32 v6, 1, v6
    s_and_b32 s54, s32, 2
    s_lshl_b32 s54, s54, 1
    v_xor_b32 v6, s54, v6
    v_lshrrev_b32 v9, 1, v8
    s_add_u32 m0, s44, 43008
    v_add_u32 v6, v6, v9
    buffer_load_dwordx4 v225, s[8:11], s36 offen lds
    v_lshlrev_b32 v6, 4, v6
    v_lshl_add_u32 v6, v5, 7, v6
    v_and_b32 v5, 1, v8
    v_lshl_add_u32 v6, v5, 3, v6
    v_lshrrev_b32 v5, 1, v3
    s_mov_b32 s54, 6144
    buffer_load_dwordx4 v225, s[8:11], s37 offen offset:1024 lds
    v_mad_u32_u24 v6, v5, s54, v6
    v_add_u32 v218, 18432, v6
    v_xor_b32 v219, 32, v218
    v_min_u32 v5, 31, v239
    s_lshl_b32 s54, s32, 5
    s_add_u32 s54, s54, 16
    buffer_load_dwordx4 v206, s[8:11], s38 offen offset:2048 lds
    v_add_u32 v5, s54, v5
    v_lshlrev_b32 v6, 2, v5
    v_add_u32 v238, 161792, v6
    s_lshl_b32 s54, s33, 7
    s_sub_u32 s54, s54, 16
    s_add_u32 m0, s44, 46080
    s_lshl_b32 s60, s33, 7
    buffer_load_dwordx4 v225, s[8:11], s39 offen lds
    s_lshl_b32 s61, s35, 3
    s_add_u32 s61, s61, s34
    s_lshl_b32 s61, s61, 3
    s_add_u32 s61, s61, s60
    s_lshl_b32 s62, s32, 1
    s_add_u32 s61, s61, s62
    buffer_load_dwordx4 v225, s[8:11], s40 offen offset:1024 lds
    v_lshrrev_b32 v12, 5, v239
    v_add_u32 v12, s61, v12
    v_lshlrev_b32 v226, 4, v12
    v_and_b32 v13, 31, v239
    v_lshlrev_b32 v13, 4, v13
    v_lshl_add_u32 v11, v12, 10, v13
    buffer_load_dwordx4 v206, s[8:11], s41 offen offset:2048 lds
    v_add_u32 v225, s46, v225
    v_add_u32 v206, s46, v206
    s_add_u32 s42, s42, 128
    v_add_u32 v5, s54, v5
    v_max_i32 v5, 0, v5
    v_lshlrev_b32 v227, 4, v5
    s_lshl_b32 s54, s33, 3
    s_and_b32 s55, s32, 1
    buffer_load_dwordx4 v[244:247], v11, s[4:7], 0 offen
    buffer_load_dwordx4 v[248:251], v11, s[4:7], 0 offen offset:512
    s_add_u32 m0, s43, 86016
    s_lshl_b32 s55, s55, 2
    buffer_load_dwordx4 v220, s[4:7], s42 offen lds
    s_add_u32 s54, s54, s55
    s_mul_i32 s54, s54, 59
    s_add_u32 s54, s54, s74
    s_lshr_b32 s55, s32, 1
    s_add_u32 s54, s54, s55
    s_lshl_b32 s54, s54, 10
    buffer_load_dwordx4 v221, s[4:7], s42 offen offset:1024 lds
    s_add_u32 s50, s54, 131072
    s_lshl_b32 s54, s33, 1
    s_and_b32 s55, s32, 1
    s_add_u32 s54, s54, s55
    s_lshl_b32 s54, s54, 2
    s_lshr_b32 s55, s34, 1
    buffer_load_dwordx4 v222, s[4:7], s42 offen offset:2048 lds
    s_add_u32 s54, s54, s55
    s_lshl_b32 s54, s54, 4
    s_and_b32 s55, s34, 1
    s_lshl_b32 s55, s55, 1
    s_add_u32 s54, s54, s55
    s_lshr_b32 s55, s32, 1
    buffer_load_dwordx4 v223, s[4:7], s42 offen offset:3072 lds
    s_add_u32 s54, s54, s55
    s_lshl_b32 s54, s54, 3
    s_add_u32 s51, s54, 32800
    v_accvgpr_write_b32 a252, -1
    v_accvgpr_write_b32 a253, -1
    s_add_u32 m0, s44, 86016
    v_accvgpr_write_b32 a254, -1
    buffer_load_dwordx4 v225, s[8:11], s36 offen lds
    v_accvgpr_write_b32 a255, -1
    s_mul_i32 s60, s32, 360448
    s_lshl_b32 s64, s32, 13
    s_add_u32 s64, s64, 129024
    s_cmp_eq_u32 s32, 3
    s_cselect_b32 s61, 5, 6
    s_cselect_b32 s62, 1073741824, s60
    s_lshl_b32 s61, s61, 15
    s_add_u32 s61, s61, s60
    s_lshl_b32 s63, s32, 17
    v_lshrrev_b32 v252, 4, v239
    v_lshlrev_b32 v252, 1, v252
    v_and_b32 v253, 7, v239
    v_xor_b32 v252, v252, v253
    v_lshlrev_b32 v252, 4, v252
    v_lshrrev_b32 v253, 3, v239
    v_lshl_add_u32 v252, v253, 10, v252
    s_lshl_b32 s54, s69, 7
    v_add_u32 v204, s54, v252
    v_add_u32 v205, 7168, v204
    v_bfe_u32 v252, v239, 2, 2
    v_lshrrev_b32 v253, 4, v239
    v_lshl_add_u32 v254, v253, 2, v252
    v_bfe_u32 v255, v254, 1, 2
    v_lshlrev_b32 v255, 5, v255
    v_lshl_add_u32 v255, v254, 7, v255
    v_and_b32 v252, 3, v239
    v_lshl_add_u32 v255, v252, 3, v255
    s_mul_i32 s54, s32, 8192
    s_add_u32 s54, s54, 129024
    v_add_u32 v208, s54, v255
    v_xor_b32 v209, 32, v208
    v_xor_b32 v210, 64, v208
    v_xor_b32 v211, 96, v208
    s_waitcnt vmcnt(18)
    s_barrier
    ds_read_b64_tr_b16 v[136:137], v218 offset:0
    ds_read_b64_tr_b16 v[138:139], v218 offset:12288
    ds_read_b128 v[120:123], v216 offset:0
    ds_read_b128 v[124:127], v216 offset:2048
    ds_read_b128 v[128:131], v216 offset:4096
    ds_read_b128 v[132:135], v216 offset:6144
    ds_read_b64_tr_b16 v[140:141], v219 offset:0
    ds_read_b64_tr_b16 v[142:143], v219 offset:12288
    ds_read_b64_tr_b16 v[144:145], v218 offset:1024
    ds_read_b64_tr_b16 v[146:147], v218 offset:13312
    ds_read_b64_tr_b16 v[148:149], v219 offset:1024
    ds_read_b64_tr_b16 v[150:151], v219 offset:13312
    ds_read_b64_tr_b16 v[152:153], v218 offset:2048
    ds_read_b64_tr_b16 v[154:155], v218 offset:14336
    ds_read_b64_tr_b16 v[156:157], v219 offset:2048
    ds_read_b64_tr_b16 v[158:159], v219 offset:14336
    s_waitcnt lgkmcnt(13)
    v_mfma_f32_16x16x32_bf16 v[0:3], v[136:139], v[120:123], 0
    ds_read_b64_tr_b16 v[176:177], v218 offset:3072
    s_waitcnt lgkmcnt(13)
    v_mfma_f32_16x16x32_bf16 v[4:7], v[136:139], v[124:127], 0
    buffer_load_dwordx4 v225, s[8:11], s37 offen offset:1024 lds
    s_waitcnt lgkmcnt(12)
    v_mfma_f32_16x16x32_bf16 v[8:11], v[136:139], v[128:131], 0
    ds_read_b64_tr_b16 v[178:179], v218 offset:15360
    ds_read_b128 v[160:163], v217 offset:0
    s_waitcnt lgkmcnt(13)
    v_mfma_f32_16x16x32_bf16 v[12:15], v[136:139], v[132:135], 0
    buffer_load_dwordx4 v206, s[8:11], s38 offen offset:2048 lds
    s_waitcnt lgkmcnt(11)
    v_mfma_f32_16x16x32_bf16 v[28:31], v[140:143], v[132:135], 0
    ds_read_b128 v[164:167], v217 offset:2048
    v_mfma_f32_16x16x32_bf16 v[24:27], v[140:143], v[128:131], 0
    ds_read_b128 v[168:171], v217 offset:4096
    s_add_u32 m0, s44, 89088
    v_mfma_f32_16x16x32_bf16 v[20:23], v[140:143], v[124:127], 0
    ds_read_b128 v[172:175], v217 offset:6144
    v_mfma_f32_16x16x32_bf16 v[16:19], v[140:143], v[120:123], 0
    ds_read_b64_tr_b16 v[180:181], v219 offset:3072
    s_waitcnt lgkmcnt(6)
    v_mfma_f32_16x16x32_bf16 v[32:35], v[144:147], v[120:123], 0
    buffer_load_dwordx4 v225, s[8:11], s39 offen lds
    v_mfma_f32_16x16x32_bf16 v[36:39], v[144:147], v[124:127], 0
    ds_read_b64_tr_b16 v[182:183], v219 offset:15360
    ds_read_b64_tr_b16 v[184:185], v218 offset:4096
    v_mfma_f32_16x16x32_bf16 v[40:43], v[144:147], v[128:131], 0
    buffer_load_dwordx4 v225, s[8:11], s40 offen offset:1024 lds
    v_mfma_f32_16x16x32_bf16 v[44:47], v[144:147], v[132:135], 0
    ds_read_b64_tr_b16 v[186:187], v218 offset:16384
    v_mfma_f32_16x16x32_bf16 v[60:63], v[148:151], v[132:135], 0
    ds_read_b64_tr_b16 v[188:189], v219 offset:4096
    v_mfma_f32_16x16x32_bf16 v[56:59], v[148:151], v[128:131], 0
    buffer_load_dwordx2 v[236:237], off, s[16:19], 0 sc1
    v_mfma_f32_16x16x32_bf16 v[52:55], v[148:151], v[124:127], 0
    ds_read_b64_tr_b16 v[190:191], v219 offset:16384
    ds_read_b64_tr_b16 v[192:193], v218 offset:5120
    v_mfma_f32_16x16x32_bf16 v[48:51], v[148:151], v[120:123], 0
    buffer_load_dwordx4 v206, s[8:11], s41 offen offset:2048 lds
    v_mfma_f32_16x16x32_bf16 v[64:67], v[152:155], v[120:123], 0
    ds_read_b64_tr_b16 v[194:195], v218 offset:17408
    v_mfma_f32_16x16x32_bf16 v[68:71], v[152:155], v[124:127], 0
    ds_read_b64_tr_b16 v[196:197], v219 offset:5120
    v_add_u32 v225, s46, v225
    v_mfma_f32_16x16x32_bf16 v[72:75], v[152:155], v[128:131], 0
    ds_read_b64_tr_b16 v[198:199], v219 offset:17408
    v_mfma_f32_16x16x32_bf16 v[76:79], v[152:155], v[132:135], 0
    v_mfma_f32_16x16x32_bf16 v[92:95], v[156:159], v[132:135], 0
    v_add_u32 v206, s46, v206
    v_mfma_f32_16x16x32_bf16 v[88:91], v[156:159], v[128:131], 0
    v_mfma_f32_16x16x32_bf16 v[84:87], v[156:159], v[124:127], 0
    s_add_u32 s42, s42, 128
    v_mfma_f32_16x16x32_bf16 v[80:83], v[156:159], v[120:123], 0
    s_cmp_lg_u32 s100, 0
    s_cbranch_scc1 L_nos_4
    v_mfma_f32_16x16x32_bf16 v[96:99], v[136:139], v[212:215], 0
    v_mfma_f32_16x16x32_bf16 v[100:103], v[140:143], v[212:215], 0
    v_mfma_f32_16x16x32_bf16 v[104:107], v[144:147], v[212:215], 0
    v_mfma_f32_16x16x32_bf16 v[108:111], v[148:151], v[212:215], 0
    v_mfma_f32_16x16x32_bf16 v[112:115], v[152:155], v[212:215], 0
    v_mfma_f32_16x16x32_bf16 v[116:119], v[156:159], v[212:215], 0
L_nos_4:
    s_waitcnt lgkmcnt(0)
    s_waitcnt vmcnt(13)
    s_barrier
    v_mfma_f32_16x16x32_bf16 v[0:3], v[176:179], v[160:163], v[0:3]
    v_add_u32 v218, 0xa800, v218
    s_waitcnt vmcnt(12)
    v_dot2_f32_bf16 v252, v244, v212, 0
    v_mfma_f32_16x16x32_bf16 v[4:7], v[176:179], v[164:167], v[4:7]
    v_add_u32 v216, 0xa800, v216
    s_add_u32 m0, s43, 0
    v_mfma_f32_16x16x32_bf16 v[8:11], v[176:179], v[168:171], v[8:11]
    ds_read_b64_tr_b16 v[136:137], v218 offset:0
    v_dot2_f32_bf16 v254, v244, v244, 0
    v_mfma_f32_16x16x32_bf16 v[12:15], v[176:179], v[172:175], v[12:15]
    ds_read_b64_tr_b16 v[138:139], v218 offset:12288
    v_dot2_f32_bf16 v253, v245, v212, 0
    v_mfma_f32_16x16x32_bf16 v[28:31], v[180:183], v[172:175], v[28:31]
    ds_read_b128 v[120:123], v216 offset:0
    v_add_u32 v219, 0xa800, v219
    v_mfma_f32_16x16x32_bf16 v[24:27], v[180:183], v[168:171], v[24:27]
    buffer_load_dwordx4 v220, s[4:7], s42 offen lds
    v_mfma_f32_16x16x32_bf16 v[20:23], v[180:183], v[164:167], v[20:23]
    v_add_u32 v217, 0xa800, v217
    v_dot2_f32_bf16 v255, v245, v245, 0
    v_mfma_f32_16x16x32_bf16 v[16:19], v[180:183], v[160:163], v[16:19]
    ds_read_b128 v[124:127], v216 offset:2048
    ds_read_b128 v[128:131], v216 offset:4096
    v_mfma_f32_16x16x32_bf16 v[32:35], v[184:187], v[160:163], v[32:35]
    buffer_load_dwordx4 v221, s[4:7], s42 offen offset:1024 lds
    v_mfma_f32_16x16x32_bf16 v[36:39], v[184:187], v[164:167], v[36:39]
    ds_read_b128 v[132:135], v216 offset:6144
    ds_read_b64_tr_b16 v[140:141], v219 offset:0
    v_mfma_f32_16x16x32_bf16 v[40:43], v[184:187], v[168:171], v[40:43]
    ds_read_b64_tr_b16 v[142:143], v219 offset:12288
    v_dot2_f32_bf16 v252, v246, v212, v252
    v_mfma_f32_16x16x32_bf16 v[44:47], v[184:187], v[172:175], v[44:47]
    buffer_load_dwordx4 v222, s[4:7], s42 offen offset:2048 lds
    v_mfma_f32_16x16x32_bf16 v[60:63], v[188:191], v[172:175], v[60:63]
    ds_read_b64_tr_b16 v[144:145], v218 offset:1024
    ds_read_b64_tr_b16 v[146:147], v218 offset:13312
    v_mfma_f32_16x16x32_bf16 v[56:59], v[188:191], v[168:171], v[56:59]
    ds_read_b64_tr_b16 v[148:149], v219 offset:1024
    v_dot2_f32_bf16 v254, v246, v246, v254
    v_mfma_f32_16x16x32_bf16 v[52:55], v[188:191], v[164:167], v[52:55]
    ds_read_b64_tr_b16 v[150:151], v219 offset:13312
    v_dot2_f32_bf16 v253, v247, v212, v253
    v_mfma_f32_16x16x32_bf16 v[48:51], v[188:191], v[160:163], v[48:51]
    buffer_load_dwordx4 v223, s[4:7], s42 offen offset:3072 lds
    v_mfma_f32_16x16x32_bf16 v[64:67], v[192:195], v[160:163], v[64:67]
    ds_read_b64_tr_b16 v[152:153], v218 offset:2048
    ds_read_b64_tr_b16 v[154:155], v218 offset:14336
    v_mfma_f32_16x16x32_bf16 v[68:71], v[192:195], v[164:167], v[68:71]
    ds_read_b64_tr_b16 v[156:157], v219 offset:2048
    v_mfma_f32_16x16x32_bf16 v[72:75], v[192:195], v[168:171], v[72:75]
    ds_read_b64_tr_b16 v[158:159], v219 offset:14336
    s_add_u32 m0, s44, 0
    v_mfma_f32_16x16x32_bf16 v[76:79], v[192:195], v[172:175], v[76:79]
    v_dot2_f32_bf16 v255, v247, v247, v255
    v_mfma_f32_16x16x32_bf16 v[92:95], v[196:199], v[172:175], v[92:95]
    s_waitcnt vmcnt(15)
    v_dot2_f32_bf16 v252, v248, v212, v252
    v_mfma_f32_16x16x32_bf16 v[88:91], v[196:199], v[168:171], v[88:91]
    v_dot2_f32_bf16 v254, v248, v248, v254
    v_mfma_f32_16x16x32_bf16 v[84:87], v[196:199], v[164:167], v[84:87]
    buffer_load_dwordx4 v225, s[8:11], s36 offen lds
    v_mfma_f32_16x16x32_bf16 v[80:83], v[196:199], v[160:163], v[80:83]
    v_dot2_f32_bf16 v253, v249, v212, v253
    v_dot2_f32_bf16 v255, v249, v249, v255
    v_dot2_f32_bf16 v252, v250, v212, v252
    s_cmp_lg_u32 s100, 1
    s_cbranch_scc1 L_nos_5
    v_mfma_f32_16x16x32_bf16 v[96:99], v[176:179], v[212:215], 0
    v_mfma_f32_16x16x32_bf16 v[100:103], v[180:183], v[212:215], 0
    v_mfma_f32_16x16x32_bf16 v[104:107], v[184:187], v[212:215], 0
    v_mfma_f32_16x16x32_bf16 v[108:111], v[188:191], v[212:215], 0
    v_mfma_f32_16x16x32_bf16 v[112:115], v[192:195], v[212:215], 0
    v_mfma_f32_16x16x32_bf16 v[116:119], v[196:199], v[212:215], 0
L_nos_5:
    s_waitcnt lgkmcnt(0)
    v_mfma_f32_16x16x32_bf16 v[0:3], v[136:139], v[120:123], v[0:3]
    ds_read_b64_tr_b16 v[176:177], v218 offset:3072
    v_dot2_f32_bf16 v254, v250, v250, v254
    v_mfma_f32_16x16x32_bf16 v[4:7], v[136:139], v[124:127], v[4:7]
    buffer_load_dwordx4 v225, s[8:11], s37 offen offset:1024 lds
    v_mfma_f32_16x16x32_bf16 v[8:11], v[136:139], v[128:131], v[8:11]
    ds_read_b64_tr_b16 v[178:179], v218 offset:15360
    ds_read_b128 v[160:163], v217 offset:0
    v_mfma_f32_16x16x32_bf16 v[12:15], v[136:139], v[132:135], v[12:15]
    buffer_load_dwordx4 v206, s[8:11], s38 offen offset:2048 lds
    v_mfma_f32_16x16x32_bf16 v[28:31], v[140:143], v[132:135], v[28:31]
    ds_read_b128 v[164:167], v217 offset:2048
    v_dot2_f32_bf16 v253, v251, v212, v253
    v_mfma_f32_16x16x32_bf16 v[24:27], v[140:143], v[128:131], v[24:27]
    ds_read_b128 v[168:171], v217 offset:4096
    v_dot2_f32_bf16 v255, v251, v251, v255
    v_mfma_f32_16x16x32_bf16 v[20:23], v[140:143], v[124:127], v[20:23]
    ds_read_b128 v[172:175], v217 offset:6144
    s_add_u32 m0, s44, 3072
    v_mfma_f32_16x16x32_bf16 v[16:19], v[140:143], v[120:123], v[16:19]
    ds_read_b64_tr_b16 v[180:181], v219 offset:3072
    v_add_f32 v252, v252, v253
    v_mfma_f32_16x16x32_bf16 v[32:35], v[144:147], v[120:123], v[32:35]
    ds_read_b64_tr_b16 v[182:183], v219 offset:15360
    v_add_f32 v254, v254, v255
    v_mfma_f32_16x16x32_bf16 v[36:39], v[144:147], v[124:127], v[36:39]
    buffer_load_dwordx4 v225, s[8:11], s39 offen lds
    v_mfma_f32_16x16x32_bf16 v[40:43], v[144:147], v[128:131], v[40:43]
    ds_read_b64_tr_b16 v[184:185], v218 offset:4096
    ds_read_b64_tr_b16 v[186:187], v218 offset:16384
    v_mfma_f32_16x16x32_bf16 v[44:47], v[144:147], v[132:135], v[44:47]
    buffer_load_dwordx4 v225, s[8:11], s40 offen offset:1024 lds
    v_mfma_f32_16x16x32_bf16 v[60:63], v[148:151], v[132:135], v[60:63]
    ds_read_b64_tr_b16 v[188:189], v219 offset:4096
    v_add_f32_dpp v252, v252, v252 row_ror:8 row_mask:0xf bank_mask:0xf
    v_mfma_f32_16x16x32_bf16 v[56:59], v[148:151], v[128:131], v[56:59]
    ds_read_b64_tr_b16 v[190:191], v219 offset:16384
    v_add_f32_dpp v254, v254, v254 row_ror:8 row_mask:0xf bank_mask:0xf
    v_mfma_f32_16x16x32_bf16 v[52:55], v[148:151], v[124:127], v[52:55]
    buffer_load_dwordx4 v206, s[8:11], s41 offen offset:2048 lds
    v_mfma_f32_16x16x32_bf16 v[48:51], v[148:151], v[120:123], v[48:51]
    ds_read_b64_tr_b16 v[192:193], v218 offset:5120
    v_add_f32_dpp v252, v252, v252 row_ror:4 row_mask:0xf bank_mask:0xf
    v_mfma_f32_16x16x32_bf16 v[64:67], v[152:155], v[120:123], v[64:67]
    ds_read_b64_tr_b16 v[194:195], v218 offset:17408
    v_add_f32_dpp v254, v254, v254 row_ror:4 row_mask:0xf bank_mask:0xf
    v_mfma_f32_16x16x32_bf16 v[68:71], v[152:155], v[124:127], v[68:71]
    ds_read_b64_tr_b16 v[196:197], v219 offset:5120
    v_add_u32 v225, s46, v225
    v_mfma_f32_16x16x32_bf16 v[72:75], v[152:155], v[128:131], v[72:75]
    ds_read_b64_tr_b16 v[198:199], v219 offset:17408
    v_add_f32_dpp v252, v252, v252 row_ror:2 row_mask:0xf bank_mask:0xf
    v_mfma_f32_16x16x32_bf16 v[76:79], v[152:155], v[132:135], v[76:79]
    v_add_f32_dpp v254, v254, v254 row_ror:2 row_mask:0xf bank_mask:0xf
    v_add_u32 v206, s46, v206
    v_mfma_f32_16x16x32_bf16 v[92:95], v[156:159], v[132:135], v[92:95]
    v_mfma_f32_16x16x32_bf16 v[88:91], v[156:159], v[128:131], v[88:91]
    v_add_f32_dpp v252, v252, v252 row_ror:1 row_mask:0xf bank_mask:0xf
    v_mfma_f32_16x16x32_bf16 v[84:87], v[156:159], v[124:127], v[84:87]
    s_add_u32 s42, s42, 128
    v_mfma_f32_16x16x32_bf16 v[80:83], v[156:159], v[120:123], v[80:83]
    v_add_f32_dpp v254, v254, v254 row_ror:1 row_mask:0xf bank_mask:0xf
    s_cmp_lg_u32 s100, 0
    s_cbranch_scc1 L_nos_6
    v_mfma_f32_16x16x32_bf16 v[96:99], v[136:139], v[212:215], v[96:99]
    v_mfma_f32_16x16x32_bf16 v[100:103], v[140:143], v[212:215], v[100:103]
    v_mfma_f32_16x16x32_bf16 v[104:107], v[144:147], v[212:215], v[104:107]
    v_mfma_f32_16x16x32_bf16 v[108:111], v[148:151], v[212:215], v[108:111]
    v_mfma_f32_16x16x32_bf16 v[112:115], v[152:155], v[212:215], v[112:115]
    v_mfma_f32_16x16x32_bf16 v[116:119], v[156:159], v[212:215], v[116:119]
L_nos_6:
    s_waitcnt lgkmcnt(0)
    s_waitcnt vmcnt(10)
    s_barrier
    v_mfma_f32_16x16x32_bf16 v[0:3], v[176:179], v[160:163], v[0:3]
    v_add_u32 v218, 0xa800, v218
    v_mov_b32 v253, v252
    v_mfma_f32_16x16x32_bf16 v[4:7], v[176:179], v[164:167], v[4:7]
    v_add_u32 v216, 0xa800, v216
    s_add_u32 m0, s43, 43008
    v_mfma_f32_16x16x32_bf16 v[8:11], v[176:179], v[168:171], v[8:11]
    ds_read_b64_tr_b16 v[136:137], v218 offset:0
    v_mov_b32 v255, v254
    v_mfma_f32_16x16x32_bf16 v[12:15], v[176:179], v[172:175], v[12:15]
    ds_read_b64_tr_b16 v[138:139], v218 offset:12288
    v_permlane16_swap_b32 v252, v253
    v_mfma_f32_16x16x32_bf16 v[28:31], v[180:183], v[172:175], v[28:31]
    ds_read_b128 v[120:123], v216 offset:0
    v_add_u32 v219, 0xa800, v219
    v_mfma_f32_16x16x32_bf16 v[24:27], v[180:183], v[168:171], v[24:27]
    buffer_load_dwordx4 v220, s[4:7], s42 offen lds
    v_mfma_f32_16x16x32_bf16 v[20:23], v[180:183], v[164:167], v[20:23]
    v_add_u32 v217, 0xa800, v217
    v_permlane16_swap_b32 v254, v255
    v_mfma_f32_16x16x32_bf16 v[16:19], v[180:183], v[160:163], v[16:19]
    ds_read_b128 v[124:127], v216 offset:2048
    ds_read_b128 v[128:131], v216 offset:4096
    v_mfma_f32_16x16x32_bf16 v[32:35], v[184:187], v[160:163], v[32:35]
    buffer_load_dwordx4 v221, s[4:7], s42 offen offset:1024 lds
    v_mfma_f32_16x16x32_bf16 v[36:39], v[184:187], v[164:167], v[36:39]
    ds_read_b128 v[132:135], v216 offset:6144
    ds_read_b64_tr_b16 v[140:141], v219 offset:0
    v_mfma_f32_16x16x32_bf16 v[40:43], v[184:187], v[168:171], v[40:43]
    ds_read_b64_tr_b16 v[142:143], v219 offset:12288
    v_add_f32 v252, v252, v253
    v_mfma_f32_16x16x32_bf16 v[44:47], v[184:187], v[172:175], v[44:47]
    buffer_load_dwordx4 v222, s[4:7], s42 offen offset:2048 lds
    v_mfma_f32_16x16x32_bf16 v[60:63], v[188:191], v[172:175], v[60:63]
    ds_read_b64_tr_b16 v[144:145], v218 offset:1024
    ds_read_b64_tr_b16 v[146:147], v218 offset:13312
    v_mfma_f32_16x16x32_bf16 v[56:59], v[188:191], v[168:171], v[56:59]
    ds_read_b64_tr_b16 v[148:149], v219 offset:1024
    v_add_f32 v254, v254, v255
    v_mfma_f32_16x16x32_bf16 v[52:55], v[188:191], v[164:167], v[52:55]
    ds_read_b64_tr_b16 v[150:151], v219 offset:13312
    v_mul_f32 v228, 0xbb000000, v252
    v_mfma_f32_16x16x32_bf16 v[48:51], v[188:191], v[160:163], v[48:51]
    buffer_load_dwordx4 v223, s[4:7], s42 offen offset:3072 lds
    v_mfma_f32_16x16x32_bf16 v[64:67], v[192:195], v[160:163], v[64:67]
    ds_read_b64_tr_b16 v[152:153], v218 offset:2048
    ds_read_b64_tr_b16 v[154:155], v218 offset:14336
    v_mfma_f32_16x16x32_bf16 v[68:71], v[192:195], v[164:167], v[68:71]
    ds_read_b64_tr_b16 v[156:157], v219 offset:2048
    v_mul_f32 v254, 0x3b000000, v254
    v_mfma_f32_16x16x32_bf16 v[72:75], v[192:195], v[168:171], v[72:75]
    ds_read_b64_tr_b16 v[158:159], v219 offset:14336
    s_add_u32 m0, s44, 43008
    v_mfma_f32_16x16x32_bf16 v[76:79], v[192:195], v[172:175], v[76:79]
    v_fma_f32 v254, -v228, v228, v254
    v_max_f32 v254, 0, v254
    v_mfma_f32_16x16x32_bf16 v[92:95], v[196:199], v[172:175], v[92:95]
    v_add_f32 v254, 0x3727c5ac, v254
    v_mfma_f32_16x16x32_bf16 v[88:91], v[196:199], v[168:171], v[88:91]
    v_mfma_f32_16x16x32_bf16 v[84:87], v[196:199], v[164:167], v[84:87]
    buffer_load_dwordx4 v225, s[8:11], s36 offen lds
    v_mfma_f32_16x16x32_bf16 v[80:83], v[196:199], v[160:163], v[80:83]
    v_rsq_f32 v229, v254
    s_cmp_lg_u32 s100, 1
    s_cbranch_scc1 L_nos_7
    v_mfma_f32_16x16x32_bf16 v[96:99], v[176:179], v[212:215], v[96:99]
    v_mfma_f32_16x16x32_bf16 v[100:103], v[180:183], v[212:215], v[100:103]
    v_mfma_f32_16x16x32_bf16 v[104:107], v[184:187], v[212:215], v[104:107]
    v_mfma_f32_16x16x32_bf16 v[108:111], v[188:191], v[212:215], v[108:111]
    v_mfma_f32_16x16x32_bf16 v[112:115], v[192:195], v[212:215], v[112:115]
    v_mfma_f32_16x16x32_bf16 v[116:119], v[196:199], v[212:215], v[116:119]
L_nos_7:
    s_waitcnt lgkmcnt(0)
    v_mfma_f32_16x16x32_bf16 v[0:3], v[136:139], v[120:123], v[0:3]
    s_add_u32 s53, s63, 49152
    s_add_u32 m0, s64, 0
    v_mfma_f32_16x16x32_bf16 v[4:7], v[136:139], v[124:127], v[4:7]
    ds_read_b64_tr_b16 v[176:177], v218 offset:3072
    ds_read_b64_tr_b16 v[178:179], v218 offset:15360
    v_mfma_f32_16x16x32_bf16 v[8:11], v[136:139], v[128:131], v[8:11]
    v_readfirstlane_b32 s58, v236
    v_readfirstlane_b32 s59, v237
    s_cmp_lg_u32 s58, 0
    s_cbranch_scc1 L_non_ok_8
    s_mov_b32 s75, 0
L_non_again_9:
    s_sleep 1
    buffer_load_dwordx2 v[236:237], off, s[16:19], 0 sc1
    s_waitcnt vmcnt(0)
    v_readfirstlane_b32 s58, v236
    v_readfirstlane_b32 s59, v237
    s_cmp_lg_u32 s58, 0
    s_cbranch_scc1 L_non_ok_8
    s_add_u32 s75, s75, 1
L_pad_m1:
    s_cmp_eq_u32 s99, 1
    s_cbranch_scc1 L_padback_m
    s_cmp_lt_u32 s75, 4000
    s_cbranch_scc1 L_non_again_9
L_non_ok_8:
    s_nop 1
    v_mov_b32 v230, s58
    v_mov_b32 v231, s59
    s_mul_i32 s52, s58, 0x9e3779b1
    s_mov_b32 exec_lo, 1
    s_mov_b32 exec_hi, 1
    buffer_store_dwordx4 v[228:231], v226, s[12:15], 0 offen sc1
    s_mov_b64 exec, -1
    s_lshr_b32 s3, s52, 16
    s_xor_b32 s52, s52, s3
    s_mov_b32 s3, 0x80008000
    buffer_load_dwordx4 v204, s[24:27], s53 offen lds
    v_mfma_f32_16x16x32_bf16 v[12:15], v[136:139], v[132:135], v[12:15]
    ds_read_b128 v[160:163], v217 offset:0
    ds_read_b128 v[164:167], v217 offset:2048
    v_mfma_f32_16x16x32_bf16 v[28:31], v[140:143], v[132:135], v[28:31]
    buffer_load_dwordx4 v205, s[24:27], s53 offen offset:1024 lds
    v_mfma_f32_16x16x32_bf16 v[24:27], v[140:143], v[128:131], v[24:27]
    ds_read_b128 v[168:171], v217 offset:4096
    v_mfma_f32_16x16x32_bf16 v[20:23], v[140:143], v[124:127], v[20:23]
    ds_read_b128 v[172:175], v217 offset:6144
    s_add_u32 m0, s44, 43008
    v_mfma_f32_16x16x32_bf16 v[16:19], v[140:143], v[120:123], v[16:19]
    ds_read_b64_tr_b16 v[180:181], v219 offset:3072
    v_mfma_f32_16x16x32_bf16 v[32:35], v[144:147], v[120:123], v[32:35]
    buffer_load_dwordx4 v225, s[8:11], s37 offen offset:1024 lds
    v_mfma_f32_16x16x32_bf16 v[36:39], v[144:147], v[124:127], v[36:39]
    ds_read_b64_tr_b16 v[182:183], v219 offset:15360
    ds_read_b64_tr_b16 v[184:185], v218 offset:4096
    v_mfma_f32_16x16x32_bf16 v[40:43], v[144:147], v[128:131], v[40:43]
    buffer_load_dwordx4 v206, s[8:11], s38 offen offset:2048 lds
    v_mfma_f32_16x16x32_bf16 v[44:47], v[144:147], v[132:135], v[44:47]
    ds_read_b64_tr_b16 v[186:187], v218 offset:16384
    s_add_u32 m0, s44, 46080
    v_mfma_f32_16x16x32_bf16 v[60:63], v[148:151], v[132:135], v[60:63]
    ds_read_b64_tr_b16 v[188:189], v219 offset:4096
    v_mfma_f32_16x16x32_bf16 v[56:59], v[148:151], v[128:131], v[56:59]
    buffer_load_dwordx4 v225, s[8:11], s39 offen lds
    v_mfma_f32_16x16x32_bf16 v[52:55], v[148:151], v[124:127], v[52:55]
    ds_read_b64_tr_b16 v[190:191], v219 offset:16384
    ds_read_b64_tr_b16 v[192:193], v218 offset:5120
    v_mfma_f32_16x16x32_bf16 v[48:51], v[148:151], v[120:123], v[48:51]
    buffer_load_dwordx4 v225, s[8:11], s40 offen offset:1024 lds
    v_mfma_f32_16x16x32_bf16 v[64:67], v[152:155], v[120:123], v[64:67]
    ds_read_b64_tr_b16 v[194:195], v218 offset:17408
    ds_read_b64_tr_b16 v[196:197], v219 offset:5120
    v_mfma_f32_16x16x32_bf16 v[68:71], v[152:155], v[124:127], v[68:71]
    buffer_load_dwordx4 v206, s[8:11], s41 offen offset:2048 lds
    v_mfma_f32_16x16x32_bf16 v[72:75], v[152:155], v[128:131], v[72:75]
    ds_read_b64_tr_b16 v[198:199], v219 offset:17408
    v_mfma_f32_16x16x32_bf16 v[76:79], v[152:155], v[132:135], v[76:79]
    v_add_u32 v225, s46, v225
    v_mfma_f32_16x16x32_bf16 v[92:95], v[156:159], v[132:135], v[92:95]
    v_mfma_f32_16x16x32_bf16 v[88:91], v[156:159], v[128:131], v[88:91]
    v_add_u32 v206, s46, v206
    v_mfma_f32_16x16x32_bf16 v[84:87], v[156:159], v[124:127], v[84:87]
    v_mfma_f32_16x16x32_bf16 v[80:83], v[156:159], v[120:123], v[80:83]
    s_add_u32 s42, s42, 128
    s_cmp_lg_u32 s100, 0
    s_cbranch_scc1 L_nos_10
    v_mfma_f32_16x16x32_bf16 v[96:99], v[136:139], v[212:215], v[96:99]
    v_mfma_f32_16x16x32_bf16 v[100:103], v[140:143], v[212:215], v[100:103]
    v_mfma_f32_16x16x32_bf16 v[104:107], v[144:147], v[212:215], v[104:107]
    v_mfma_f32_16x16x32_bf16 v[108:111], v[148:151], v[212:215], v[108:111]
    v_mfma_f32_16x16x32_bf16 v[112:115], v[152:155], v[212:215], v[112:115]
    v_mfma_f32_16x16x32_bf16 v[116:119], v[156:159], v[212:215], v[116:119]
L_nos_10:
    s_waitcnt lgkmcnt(0)
    s_waitcnt vmcnt(13)
    s_barrier
    v_mfma_f32_16x16x32_bf16 v[0:3], v[176:179], v[160:163], v[0:3]
    v_add_u32 v218, 0xfffeb000, v218
    s_lshl_b32 s55, s68, 2
    v_mfma_f32_16x16x32_bf16 v[4:7], v[176:179], v[164:167], v[4:7]
    v_add_u32 v216, 0xfffeb000, v216
    s_add_u32 m0, s43, 86016
    v_mfma_f32_16x16x32_bf16 v[8:11], v[176:179], v[168:171], v[8:11]
    ds_read_b64_tr_b16 v[136:137], v218 offset:0
    v_and_b32 v250, 3, v239
    v_mfma_f32_16x16x32_bf16 v[12:15], v[176:179], v[172:175], v[12:15]
    ds_read_b64_tr_b16 v[138:139], v218 offset:12288
    s_add_u32 s70, s32, 0
    v_mfma_f32_16x16x32_bf16 v[28:31], v[180:183], v[172:175], v[28:31]
    ds_read_b128 v[120:123], v216 offset:0
    v_add_u32 v219, 0xfffeb000, v219
    v_mfma_f32_16x16x32_bf16 v[24:27], v[180:183], v[168:171], v[24:27]
    buffer_load_dwordx4 v220, s[4:7], s42 offen lds
    v_mfma_f32_16x16x32_bf16 v[20:23], v[180:183], v[164:167], v[20:23]
    v_add_u32 v217, 0xfffeb000, v217
    s_and_b32 s70, s70, 3
    v_mfma_f32_16x16x32_bf16 v[16:19], v[180:183], v[160:163], v[16:19]
    ds_read_b128 v[124:127], v216 offset:2048
    ds_read_b128 v[128:131], v216 offset:4096
    v_mfma_f32_16x16x32_bf16 v[32:35], v[184:187], v[160:163], v[32:35]
    buffer_load_dwordx4 v221, s[4:7], s42 offen offset:1024 lds
    v_mfma_f32_16x16x32_bf16 v[36:39], v[184:187], v[164:167], v[36:39]
    ds_read_b128 v[132:135], v216 offset:6144
    ds_read_b64_tr_b16 v[140:141], v219 offset:0
    v_mfma_f32_16x16x32_bf16 v[40:43], v[184:187], v[168:171], v[40:43]
    ds_read_b64_tr_b16 v[142:143], v219 offset:12288
    s_add_u32 s70, s70, s55
    v_mfma_f32_16x16x32_bf16 v[44:47], v[184:187], v[172:175], v[44:47]
    buffer_load_dwordx4 v222, s[4:7], s42 offen offset:2048 lds
    v_mfma_f32_16x16x32_bf16 v[60:63], v[188:191], v[172:175], v[60:63]
    ds_read_b64_tr_b16 v[144:145], v218 offset:1024
    ds_read_b64_tr_b16 v[146:147], v218 offset:13312
    v_mfma_f32_16x16x32_bf16 v[56:59], v[188:191], v[168:171], v[56:59]
    ds_read_b64_tr_b16 v[148:149], v219 offset:1024
    s_mul_i32 s70, s70, 60416
    v_mfma_f32_16x16x32_bf16 v[52:55], v[188:191], v[164:167], v[52:55]
    ds_read_b64_tr_b16 v[150:151], v219 offset:13312
    s_add_u32 s70, s70, 131072
    v_mfma_f32_16x16x32_bf16 v[48:51], v[188:191], v[160:163], v[48:51]
    buffer_load_dwordx4 v223, s[4:7], s42 offen offset:3072 lds
    v_mfma_f32_16x16x32_bf16 v[64:67], v[192:195], v[160:163], v[64:67]
    ds_read_b64_tr_b16 v[152:153], v218 offset:2048
    ds_read_b64_tr_b16 v[154:155], v218 offset:14336
    v_mfma_f32_16x16x32_bf16 v[68:71], v[192:195], v[164:167], v[68:71]
    ds_read_b64_tr_b16 v[156:157], v219 offset:2048
    s_add_u32 s71, s32, 1
    v_mfma_f32_16x16x32_bf16 v[72:75], v[192:195], v[168:171], v[72:75]
    ds_read_b64_tr_b16 v[158:159], v219 offset:14336
    s_add_u32 m0, s44, 86016
    v_mfma_f32_16x16x32_bf16 v[76:79], v[192:195], v[172:175], v[76:79]
    s_and_b32 s71, s71, 3
    v_lshlrev_b32 v250, 2, v250
    v_mfma_f32_16x16x32_bf16 v[92:95], v[196:199], v[172:175], v[92:95]
    v_mfma_f32_16x16x32_bf16 v[88:91], v[196:199], v[168:171], v[88:91]
    v_mfma_f32_16x16x32_bf16 v[84:87], v[196:199], v[164:167], v[84:87]
    buffer_load_dwordx4 v225, s[8:11], s36 offen lds
    v_mfma_f32_16x16x32_bf16 v[80:83], v[196:199], v[160:163], v[80:83]
    s_add_u32 s71, s71, s55
    s_cmp_lg_u32 s100, 1
    s_cbranch_scc1 L_nos_11
    v_mfma_f32_16x16x32_bf16 v[96:99], v[176:179], v[212:215], v[96:99]
    v_mfma_f32_16x16x32_bf16 v[100:103], v[180:183], v[212:215], v[100:103]
    v_mfma_f32_16x16x32_bf16 v[104:107], v[184:187], v[212:215], v[104:107]
    v_mfma_f32_16x16x32_bf16 v[108:111], v[188:191], v[212:215], v[108:111]
    v_mfma_f32_16x16x32_bf16 v[112:115], v[192:195], v[212:215], v[112:115]
    v_mfma_f32_16x16x32_bf16 v[116:119], v[196:199], v[212:215], v[116:119]
L_nos_11:
    s_waitcnt lgkmcnt(0)
    v_mfma_f32_16x16x32_bf16 v[0:3], v[136:139], v[120:123], v[0:3]
    s_add_u32 s53, s63, 65536
    s_add_u32 m0, s64, 2048
    v_mfma_f32_16x16x32_bf16 v[4:7], v[136:139], v[124:127], v[4:7]
    ds_read_b64_tr_b16 v[176:177], v218 offset:3072
    ds_read_b64_tr_b16 v[178:179], v218 offset:15360
    s_mul_i32 s71, s71, 60416
    v_mfma_f32_16x16x32_bf16 v[8:11], v[136:139], v[128:131], v[8:11]
    buffer_load_dwordx4 v204, s[24:27], s53 offen lds
    v_mfma_f32_16x16x32_bf16 v[12:15], v[136:139], v[132:135], v[12:15]
    ds_read_b128 v[160:163], v217 offset:0
    ds_read_b128 v[164:167], v217 offset:2048
    v_mfma_f32_16x16x32_bf16 v[28:31], v[140:143], v[132:135], v[28:31]
    buffer_load_dwordx4 v205, s[24:27], s53 offen offset:1024 lds
    v_mfma_f32_16x16x32_bf16 v[24:27], v[140:143], v[128:131], v[24:27]
    ds_read_b128 v[168:171], v217 offset:4096
    s_add_u32 s71, s71, 131072
    v_lshlrev_b32 v250, v250, s52
    v_mfma_f32_16x16x32_bf16 v[20:23], v[140:143], v[124:127], v[20:23]
    ds_read_b128 v[172:175], v217 offset:6144
    s_add_u32 m0, s44, 86016
    v_mfma_f32_16x16x32_bf16 v[16:19], v[140:143], v[120:123], v[16:19]
    ds_read_b64_tr_b16 v[180:181], v219 offset:3072
    s_add_u32 s72, s32, 2
    v_mfma_f32_16x16x32_bf16 v[32:35], v[144:147], v[120:123], v[32:35]
    buffer_load_dwordx4 v225, s[8:11], s37 offen offset:1024 lds
    v_mfma_f32_16x16x32_bf16 v[36:39], v[144:147], v[124:127], v[36:39]
    ds_read_b64_tr_b16 v[182:183], v219 offset:15360
    ds_read_b64_tr_b16 v[184:185], v218 offset:4096
    v_mfma_f32_16x16x32_bf16 v[40:43], v[144:147], v[128:131], v[40:43]
    buffer_load_dwordx4 v206, s[8:11], s38 offen offset:2048 lds
    v_mfma_f32_16x16x32_bf16 v[44:47], v[144:147], v[132:135], v[44:47]
    ds_read_b64_tr_b16 v[186:187], v218 offset:16384
    s_add_u32 m0, s44, 89088
    v_mfma_f32_16x16x32_bf16 v[60:63], v[148:151], v[132:135], v[60:63]
    ds_read_b64_tr_b16 v[188:189], v219 offset:4096
    s_and_b32 s72, s72, 3
    s_add_u32 s72, s72, s55
    v_mfma_f32_16x16x32_bf16 v[56:59], v[148:151], v[128:131], v[56:59]
    buffer_load_dwordx4 v225, s[8:11], s39 offen lds
    v_mfma_f32_16x16x32_bf16 v[52:55], v[148:151], v[124:127], v[52:55]
    ds_read_b64_tr_b16 v[190:191], v219 offset:16384
    ds_read_b64_tr_b16 v[192:193], v218 offset:5120
    v_mfma_f32_16x16x32_bf16 v[48:51], v[148:151], v[120:123], v[48:51]
    buffer_load_dwordx4 v225, s[8:11], s40 offen offset:1024 lds
    v_mfma_f32_16x16x32_bf16 v[64:67], v[152:155], v[120:123], v[64:67]
    ds_read_b64_tr_b16 v[194:195], v218 offset:17408
    ds_read_b64_tr_b16 v[196:197], v219 offset:5120
    v_mfma_f32_16x16x32_bf16 v[68:71], v[152:155], v[124:127], v[68:71]
    buffer_load_dwordx4 v206, s[8:11], s41 offen offset:2048 lds
    v_mfma_f32_16x16x32_bf16 v[72:75], v[152:155], v[128:131], v[72:75]
    ds_read_b64_tr_b16 v[198:199], v219 offset:17408
    s_mul_i32 s72, s72, 60416
    v_mfma_f32_16x16x32_bf16 v[76:79], v[152:155], v[132:135], v[76:79]
    s_add_u32 s72, s72, 131072
    v_add_u32 v225, s46, v225
    v_mfma_f32_16x16x32_bf16 v[92:95], v[156:159], v[132:135], v[92:95]
    s_add_u32 s73, s32, 3
    v_and_b32 v200, s3, v250
    v_mfma_f32_16x16x32_bf16 v[88:91], v[156:159], v[128:131], v[88:91]
    v_add_u32 v206, s46, v206
    v_mfma_f32_16x16x32_bf16 v[84:87], v[156:159], v[124:127], v[84:87]
    s_and_b32 s73, s73, 3
    v_mfma_f32_16x16x32_bf16 v[80:83], v[156:159], v[120:123], v[80:83]
    s_add_u32 s42, s42, 128
    s_cmp_lg_u32 s100, 0
    s_cbranch_scc1 L_nos_12
    v_mfma_f32_16x16x32_bf16 v[96:99], v[136:139], v[212:215], v[96:99]
    v_mfma_f32_16x16x32_bf16 v[100:103], v[140:143], v[212:215], v[100:103]
    v_mfma_f32_16x16x32_bf16 v[104:107], v[144:147], v[212:215], v[104:107]
    v_mfma_f32_16x16x32_bf16 v[108:111], v[148:151], v[212:215], v[108:111]
    v_mfma_f32_16x16x32_bf16 v[112:115], v[152:155], v[212:215], v[112:115]
    v_mfma_f32_16x16x32_bf16 v[116:119], v[156:159], v[212:215], v[116:119]
L_nos_12:
    s_waitcnt lgkmcnt(0)
    s_waitcnt vmcnt(12)
    s_barrier
    v_mfma_f32_16x16x32_bf16 v[0:3], v[176:179], v[160:163], v[0:3]
    v_add_u32 v218, 0xa800, v218
    s_add_u32 s73, s73, s55
    v_mfma_f32_16x16x32_bf16 v[4:7], v[176:179], v[164:167], v[4:7]
    v_add_u32 v216, 0xa800, v216
    s_add_u32 m0, s43, 0
    v_mfma_f32_16x16x32_bf16 v[8:11], v[176:179], v[168:171], v[8:11]
    ds_read_b64_tr_b16 v[136:137], v218 offset:0
    v_lshlrev_b32 v250, 1, v250
    v_mfma_f32_16x16x32_bf16 v[12:15], v[176:179], v[172:175], v[12:15]
    ds_read_b64_tr_b16 v[138:139], v218 offset:12288
    s_mul_i32 s73, s73, 60416
    v_mfma_f32_16x16x32_bf16 v[28:31], v[180:183], v[172:175], v[28:31]
    ds_read_b128 v[120:123], v216 offset:0
    v_add_u32 v219, 0xa800, v219
    v_mfma_f32_16x16x32_bf16 v[24:27], v[180:183], v[168:171], v[24:27]
    buffer_load_dwordx4 v220, s[4:7], s42 offen lds
    v_mfma_f32_16x16x32_bf16 v[20:23], v[180:183], v[164:167], v[20:23]
    v_add_u32 v217, 0xa800, v217
    s_add_u32 s73, s73, 131072
    v_mfma_f32_16x16x32_bf16 v[16:19], v[180:183], v[160:163], v[16:19]
    ds_read_b128 v[124:127], v216 offset:2048
    ds_read_b128 v[128:131], v216 offset:4096
    v_mfma_f32_16x16x32_bf16 v[32:35], v[184:187], v[160:163], v[32:35]
    buffer_load_dwordx4 v221, s[4:7], s42 offen offset:1024 lds
    v_mfma_f32_16x16x32_bf16 v[36:39], v[184:187], v[164:167], v[36:39]
    ds_read_b128 v[132:135], v216 offset:6144
    ds_read_b64_tr_b16 v[140:141], v219 offset:0
    v_mfma_f32_16x16x32_bf16 v[40:43], v[184:187], v[168:171], v[40:43]
    ds_read_b64_tr_b16 v[142:143], v219 offset:12288
    s_mul_i32 s54, s32, 11264
    v_mfma_f32_16x16x32_bf16 v[44:47], v[184:187], v[172:175], v[44:47]
    buffer_load_dwordx4 v222, s[4:7], s42 offen offset:2048 lds
    v_mfma_f32_16x16x32_bf16 v[60:63], v[188:191], v[172:175], v[60:63]
    ds_read_b64_tr_b16 v[144:145], v218 offset:1024
    ds_read_b64_tr_b16 v[146:147], v218 offset:13312
    v_mfma_f32_16x16x32_bf16 v[56:59], v[188:191], v[168:171], v[56:59]
    ds_read_b64_tr_b16 v[148:149], v219 offset:1024
    v_add_u32 v241, s54, v240
    v_mfma_f32_16x16x32_bf16 v[52:55], v[188:191], v[164:167], v[52:55]
    ds_read_b64_tr_b16 v[150:151], v219 offset:13312
    s_cmp_eq_u32 s32, 3
    s_cselect_b32 s54, 5, 6
    v_mfma_f32_16x16x32_bf16 v[48:51], v[188:191], v[160:163], v[48:51]
    buffer_load_dwordx4 v223, s[4:7], s42 offen offset:3072 lds
    v_mfma_f32_16x16x32_bf16 v[64:67], v[192:195], v[160:163], v[64:67]
    ds_read_b64_tr_b16 v[152:153], v218 offset:2048
    ds_read_b64_tr_b16 v[154:155], v218 offset:14336
    v_mfma_f32_16x16x32_bf16 v[68:71], v[192:195], v[164:167], v[68:71]
    ds_read_b64_tr_b16 v[156:157], v219 offset:2048
    ds_read_b64_tr_b16 a[194:195], v208 offset:0
    v_mfma_f32_16x16x32_bf16 v[72:75], v[192:195], v[168:171], v[72:75]
    ds_read_b64_tr_b16 v[158:159], v219 offset:14336
    s_add_u32 m0, s44, 0
    v_mfma_f32_16x16x32_bf16 v[76:79], v[192:195], v[172:175], v[76:79]
    ds_read_b64_tr_b16 a[198:199], v209 offset:0
    v_lshl_add_u32 v242, s54, 10, v241
    v_mfma_f32_16x16x32_bf16 v[92:95], v[196:199], v[172:175], v[92:95]
    ds_read_b64_tr_b16 a[202:203], v210 offset:0
    v_and_b32 v201, s3, v250
    v_mfma_f32_16x16x32_bf16 v[88:91], v[196:199], v[168:171], v[88:91]
    ds_read_b64_tr_b16 a[206:207], v211 offset:0
    v_and_b32 v252, 15, v239
    v_mfma_f32_16x16x32_bf16 v[84:87], v[196:199], v[164:167], v[84:87]
    buffer_load_dwordx4 v225, s[8:11], s36 offen lds
    v_mfma_f32_16x16x32_bf16 v[80:83], v[196:199], v[160:163], v[80:83]
    s_cmp_lg_u32 s100, 1
    s_cbranch_scc1 L_nos_13
    v_mfma_f32_16x16x32_bf16 v[96:99], v[176:179], v[212:215], v[96:99]
    v_mfma_f32_16x16x32_bf16 v[100:103], v[180:183], v[212:215], v[100:103]
    v_mfma_f32_16x16x32_bf16 v[104:107], v[184:187], v[212:215], v[104:107]
    v_mfma_f32_16x16x32_bf16 v[108:111], v[188:191], v[212:215], v[108:111]
    v_mfma_f32_16x16x32_bf16 v[112:115], v[192:195], v[212:215], v[112:115]
    v_mfma_f32_16x16x32_bf16 v[116:119], v[196:199], v[212:215], v[116:119]
L_nos_13:
    s_waitcnt lgkmcnt(0)
    v_mfma_f32_16x16x32_bf16 v[0:3], v[136:139], v[120:123], v[0:3]
    s_add_u32 s53, s63, 81920
    s_add_u32 m0, s64, 4096
    v_mfma_f32_16x16x32_bf16 v[4:7], v[136:139], v[124:127], v[4:7]
    ds_read_b64_tr_b16 v[176:177], v218 offset:3072
    ds_read_b64_tr_b16 v[178:179], v218 offset:15360
    s_lshl_b32 s54, s68, 6
    v_mfma_f32_16x16x32_bf16 v[8:11], v[136:139], v[128:131], v[8:11]
    buffer_load_dwordx4 v204, s[24:27], s53 offen lds
    v_mfma_f32_16x16x32_bf16 v[12:15], v[136:139], v[132:135], v[12:15]
    ds_read_b128 v[160:163], v217 offset:0
    ds_read_b128 v[164:167], v217 offset:2048
    v_mfma_f32_16x16x32_bf16 v[28:31], v[140:143], v[132:135], v[28:31]
    buffer_load_dwordx4 v205, s[24:27], s53 offen offset:1024 lds
    v_mfma_f32_16x16x32_bf16 v[24:27], v[140:143], v[128:131], v[24:27]
    ds_read_b128 v[168:171], v217 offset:4096
    s_lshl_b32 s55, s32, 4
    v_lshlrev_b32 v250, 1, v250
    v_mfma_f32_16x16x32_bf16 v[20:23], v[140:143], v[124:127], v[20:23]
    ds_read_b128 v[172:175], v217 offset:6144
    s_add_u32 m0, s44, 0
    v_mfma_f32_16x16x32_bf16 v[16:19], v[140:143], v[120:123], v[16:19]
    ds_read_b64_tr_b16 v[180:181], v219 offset:3072
    s_add_u32 s54, s54, s55
    v_mfma_f32_16x16x32_bf16 v[32:35], v[144:147], v[120:123], v[32:35]
    buffer_load_dwordx4 v225, s[8:11], s37 offen offset:1024 lds
    v_mfma_f32_16x16x32_bf16 v[36:39], v[144:147], v[124:127], v[36:39]
    ds_read_b64_tr_b16 v[182:183], v219 offset:15360
    ds_read_b64_tr_b16 v[184:185], v218 offset:4096
    v_mfma_f32_16x16x32_bf16 v[40:43], v[144:147], v[128:131], v[40:43]
    buffer_load_dwordx4 v206, s[8:11], s38 offen offset:2048 lds
    v_mfma_f32_16x16x32_bf16 v[44:47], v[144:147], v[132:135], v[44:47]
    ds_read_b64_tr_b16 v[186:187], v218 offset:16384
    s_add_u32 m0, s44, 3072
    v_mfma_f32_16x16x32_bf16 v[60:63], v[148:151], v[132:135], v[60:63]
    ds_read_b64_tr_b16 v[188:189], v219 offset:4096
    v_add_u32 v252, s54, v252
    v_mfma_f32_16x16x32_bf16 v[56:59], v[148:151], v[128:131], v[56:59]
    v_lshlrev_b32 v252, 10, v252
    buffer_load_dwordx4 v225, s[8:11], s39 offen lds
    v_mfma_f32_16x16x32_bf16 v[52:55], v[148:151], v[124:127], v[52:55]
    ds_read_b64_tr_b16 v[190:191], v219 offset:16384
    ds_read_b64_tr_b16 v[192:193], v218 offset:5120
    v_mfma_f32_16x16x32_bf16 v[48:51], v[148:151], v[120:123], v[48:51]
    buffer_load_dwordx4 v225, s[8:11], s40 offen offset:1024 lds
    v_mfma_f32_16x16x32_bf16 v[64:67], v[152:155], v[120:123], v[64:67]
    ds_read_b64_tr_b16 v[194:195], v218 offset:17408
    ds_read_b64_tr_b16 v[196:197], v219 offset:5120
    v_mfma_f32_16x16x32_bf16 v[68:71], v[152:155], v[124:127], v[68:71]
    buffer_load_dwordx4 v206, s[8:11], s41 offen offset:2048 lds
    v_mfma_f32_16x16x32_bf16 v[72:75], v[152:155], v[128:131], v[72:75]
    ds_read_b64_tr_b16 v[198:199], v219 offset:17408
    v_lshrrev_b32 v253, 4, v239
    v_mfma_f32_16x16x32_bf16 v[76:79], v[152:155], v[132:135], v[76:79]
    s_lshl_b32 s55, s69, 7
    v_add_u32 v225, s46, v225
    v_mfma_f32_16x16x32_bf16 v[92:95], v[156:159], v[132:135], v[92:95]
    v_and_b32 v202, s3, v250
    v_mfma_f32_16x16x32_bf16 v[88:91], v[156:159], v[128:131], v[88:91]
    v_add_u32 v206, s46, v206
    v_mfma_f32_16x16x32_bf16 v[84:87], v[156:159], v[124:127], v[84:87]
    v_lshl_add_u32 v226, v253, 3, v252
    v_mfma_f32_16x16x32_bf16 v[80:83], v[156:159], v[120:123], v[80:83]
    s_add_u32 s42, s42, 128
    s_cmp_lg_u32 s100, 0
    s_cbranch_scc1 L_nos_14
    v_mfma_f32_16x16x32_bf16 v[96:99], v[136:139], v[212:215], v[96:99]
    v_mfma_f32_16x16x32_bf16 v[100:103], v[140:143], v[212:215], v[100:103]
    v_mfma_f32_16x16x32_bf16 v[104:107], v[144:147], v[212:215], v[104:107]
    v_mfma_f32_16x16x32_bf16 v[108:111], v[148:151], v[212:215], v[108:111]
    v_mfma_f32_16x16x32_bf16 v[112:115], v[152:155], v[212:215], v[112:115]
    v_mfma_f32_16x16x32_bf16 v[116:119], v[156:159], v[212:215], v[116:119]
L_nos_14:
    s_waitcnt lgkmcnt(0)
    s_waitcnt vmcnt(12)
    s_barrier
    v_mfma_f32_16x16x32_bf16 v[0:3], v[176:179], v[160:163], v[0:3]
    v_add_u32 v218, 0xa800, v218
    v_add_u32 v226, s55, v226
    v_mfma_f32_16x16x32_bf16 v[4:7], v[176:179], v[164:167], v[4:7]
    v_add_u32 v216, 0xa800, v216
    s_add_u32 m0, s43, 43008
    v_mfma_f32_16x16x32_bf16 v[8:11], v[176:179], v[168:171], v[8:11]
    ds_read_b64_tr_b16 v[136:137], v218 offset:0
    v_lshlrev_b32 v250, 1, v250
    v_mfma_f32_16x16x32_bf16 v[12:15], v[176:179], v[172:175], v[12:15]
    ds_read_b64_tr_b16 v[138:139], v218 offset:12288
    v_and_b32 v237, 1, v253
    v_mfma_f32_16x16x32_bf16 v[28:31], v[180:183], v[172:175], v[28:31]
    ds_read_b128 v[120:123], v216 offset:0
    v_add_u32 v219, 0xa800, v219
    v_mfma_f32_16x16x32_bf16 v[24:27], v[180:183], v[168:171], v[24:27]
    buffer_load_dwordx4 v220, s[4:7], s42 offen lds
    v_mfma_f32_16x16x32_bf16 v[20:23], v[180:183], v[164:167], v[20:23]
    v_add_u32 v217, 0xa800, v217
    v_lshlrev_b32 v237, 5, v237
    v_mfma_f32_16x16x32_bf16 v[16:19], v[180:183], v[160:163], v[16:19]
    ds_read_b128 v[124:127], v216 offset:2048
    ds_read_b128 v[128:131], v216 offset:4096
    v_mfma_f32_16x16x32_bf16 v[32:35], v[184:187], v[160:163], v[32:35]
    buffer_load_dwordx4 v221, s[4:7], s42 offen offset:1024 lds
    v_mfma_f32_16x16x32_bf16 v[36:39], v[184:187], v[164:167], v[36:39]
    ds_read_b128 v[132:135], v216 offset:6144
    ds_read_b64_tr_b16 v[140:141], v219 offset:0
    v_mfma_f32_16x16x32_bf16 v[40:43], v[184:187], v[168:171], v[40:43]
    ds_read_b64_tr_b16 v[142:143], v219 offset:12288
    v_lshrrev_b32 v253, 1, v253
    v_mfma_f32_16x16x32_bf16 v[44:47], v[184:187], v[172:175], v[44:47]
    buffer_load_dwordx4 v222, s[4:7], s42 offen offset:2048 lds
    v_mfma_f32_16x16x32_bf16 v[60:63], v[188:191], v[172:175], v[60:63]
    ds_read_b64_tr_b16 v[144:145], v218 offset:1024
    ds_read_b64_tr_b16 v[146:147], v218 offset:13312
    v_mfma_f32_16x16x32_bf16 v[56:59], v[188:191], v[168:171], v[56:59]
    ds_read_b64_tr_b16 v[148:149], v219 offset:1024
    v_lshl_add_u32 v237, v253, 4, v237
    v_mfma_f32_16x16x32_bf16 v[52:55], v[188:191], v[164:167], v[52:55]
    ds_read_b64_tr_b16 v[150:151], v219 offset:13312
    v_add3_u32 v237, v237, v252, s55
    v_mfma_f32_16x16x32_bf16 v[48:51], v[188:191], v[160:163], v[48:51]
    buffer_load_dwordx4 v223, s[4:7], s42 offen offset:3072 lds
    v_mfma_f32_16x16x32_bf16 v[64:67], v[192:195], v[160:163], v[64:67]
    ds_read_b64_tr_b16 v[152:153], v218 offset:2048
    ds_read_b64_tr_b16 v[154:155], v218 offset:14336
    v_mfma_f32_16x16x32_bf16 v[68:71], v[192:195], v[164:167], v[68:71]
    ds_read_b64_tr_b16 v[156:157], v219 offset:2048
    ds_read_b64_tr_b16 a[208:209], v208 offset:2048
    v_mfma_f32_16x16x32_bf16 v[72:75], v[192:195], v[168:171], v[72:75]
    ds_read_b64_tr_b16 v[158:159], v219 offset:14336
    s_add_u32 m0, s44, 43008
    v_mfma_f32_16x16x32_bf16 v[76:79], v[192:195], v[172:175], v[76:79]
    ds_read_b64_tr_b16 a[212:213], v209 offset:2048
    v_and_b32 v236, 3, v239
    v_mfma_f32_16x16x32_bf16 v[92:95], v[196:199], v[172:175], v[92:95]
    ds_read_b64_tr_b16 a[216:217], v210 offset:2048
    v_and_b32 v203, s3, v250
    v_mfma_f32_16x16x32_bf16 v[88:91], v[196:199], v[168:171], v[88:91]
    ds_read_b64_tr_b16 a[220:221], v211 offset:2048
    v_lshlrev_b32 v236, 3, v236
    v_mfma_f32_16x16x32_bf16 v[84:87], v[196:199], v[164:167], v[84:87]
    buffer_load_dwordx4 v225, s[8:11], s36 offen lds
    v_mfma_f32_16x16x32_bf16 v[80:83], v[196:199], v[160:163], v[80:83]
    s_cmp_lg_u32 s100, 1
    s_cbranch_scc1 L_nos_15
    v_mfma_f32_16x16x32_bf16 v[96:99], v[176:179], v[212:215], v[96:99]
    v_mfma_f32_16x16x32_bf16 v[100:103], v[180:183], v[212:215], v[100:103]
    v_mfma_f32_16x16x32_bf16 v[104:107], v[184:187], v[212:215], v[104:107]
    v_mfma_f32_16x16x32_bf16 v[108:111], v[188:191], v[212:215], v[108:111]
    v_mfma_f32_16x16x32_bf16 v[112:115], v[192:195], v[212:215], v[112:115]
    v_mfma_f32_16x16x32_bf16 v[116:119], v[196:199], v[212:215], v[116:119]
L_nos_15:
    s_waitcnt lgkmcnt(0)
    v_mfma_f32_16x16x32_bf16 v[0:3], v[136:139], v[120:123], v[0:3]
    s_add_u32 s53, s63, 98304
    s_add_u32 m0, s64, 6144
    v_mfma_f32_16x16x32_bf16 v[4:7], v[136:139], v[124:127], v[4:7]
    ds_read_b64_tr_b16 v[176:177], v218 offset:3072
    ds_read_b64_tr_b16 v[178:179], v218 offset:15360
    v_lshrrev_b32 v252, 4, v239
    v_mfma_f32_16x16x32_bf16 v[8:11], v[136:139], v[128:131], v[8:11]
    buffer_load_dwordx4 v204, s[24:27], s53 offen lds
    v_mfma_f32_16x16x32_bf16 v[12:15], v[136:139], v[132:135], v[12:15]
    ds_read_b128 v[160:163], v217 offset:0
    ds_read_b128 v[164:167], v217 offset:2048
    v_mfma_f32_16x16x32_bf16 v[28:31], v[140:143], v[132:135], v[28:31]
    buffer_load_dwordx4 v205, s[24:27], s53 offen offset:1024 lds
    v_mfma_f32_16x16x32_bf16 v[24:27], v[140:143], v[128:131], v[24:27]
    ds_read_b128 v[168:171], v217 offset:4096
    v_lshlrev_b32 v252, 1, v252
    v_mfma_f32_16x16x32_bf16 v[20:23], v[140:143], v[124:127], v[20:23]
    ds_read_b128 v[172:175], v217 offset:6144
    s_add_u32 m0, s44, 43008
    v_mfma_f32_16x16x32_bf16 v[16:19], v[140:143], v[120:123], v[16:19]
    ds_read_b64_tr_b16 v[180:181], v219 offset:3072
    v_and_b32 v253, 7, v239
    v_mfma_f32_16x16x32_bf16 v[32:35], v[144:147], v[120:123], v[32:35]
    v_xor_b32 v252, v252, v253
    buffer_load_dwordx4 v225, s[8:11], s37 offen offset:1024 lds
    v_mfma_f32_16x16x32_bf16 v[36:39], v[144:147], v[124:127], v[36:39]
    ds_read_b64_tr_b16 v[182:183], v219 offset:15360
    ds_read_b64_tr_b16 v[184:185], v218 offset:4096
    v_mfma_f32_16x16x32_bf16 v[40:43], v[144:147], v[128:131], v[40:43]
    buffer_load_dwordx4 v206, s[8:11], s38 offen offset:2048 lds
    v_mfma_f32_16x16x32_bf16 v[44:47], v[144:147], v[132:135], v[44:47]
    ds_read_b64_tr_b16 v[186:187], v218 offset:16384
    s_add_u32 m0, s44, 46080
    v_mfma_f32_16x16x32_bf16 v[60:63], v[148:151], v[132:135], v[60:63]
    ds_read_b64_tr_b16 v[188:189], v219 offset:4096
    v_lshlrev_b32 v252, 4, v252
    v_mfma_f32_16x16x32_bf16 v[56:59], v[148:151], v[128:131], v[56:59]
    v_lshrrev_b32 v253, 3, v239
    buffer_load_dwordx4 v225, s[8:11], s39 offen lds
    v_mfma_f32_16x16x32_bf16 v[52:55], v[148:151], v[124:127], v[52:55]
    ds_read_b64_tr_b16 v[190:191], v219 offset:16384
    ds_read_b64_tr_b16 v[192:193], v218 offset:5120
    v_mfma_f32_16x16x32_bf16 v[48:51], v[148:151], v[120:123], v[48:51]
    buffer_load_dwordx4 v225, s[8:11], s40 offen offset:1024 lds
    v_mfma_f32_16x16x32_bf16 v[64:67], v[152:155], v[120:123], v[64:67]
    ds_read_b64_tr_b16 v[194:195], v218 offset:17408
    ds_read_b64_tr_b16 v[196:197], v219 offset:5120
    v_mfma_f32_16x16x32_bf16 v[68:71], v[152:155], v[124:127], v[68:71]
    buffer_load_dwordx4 v206, s[8:11], s41 offen offset:2048 lds
    v_mfma_f32_16x16x32_bf16 v[72:75], v[152:155], v[128:131], v[72:75]
    ds_read_b64_tr_b16 v[198:199], v219 offset:17408
    v_lshl_add_u32 v252, v253, 10, v252
    v_mfma_f32_16x16x32_bf16 v[76:79], v[152:155], v[132:135], v[76:79]
    s_lshl_b32 s54, s69, 7
    v_add_u32 v225, s46, v225
    v_mfma_f32_16x16x32_bf16 v[92:95], v[156:159], v[132:135], v[92:95]
    v_add_u32 v220, s54, v252
    v_mfma_f32_16x16x32_bf16 v[88:91], v[156:159], v[128:131], v[88:91]
    v_add_u32 v206, s46, v206
    v_mfma_f32_16x16x32_bf16 v[84:87], v[156:159], v[124:127], v[84:87]
    v_add_u32 v221, 7168, v220
    v_mfma_f32_16x16x32_bf16 v[80:83], v[156:159], v[120:123], v[80:83]
    s_add_u32 s42, s42, 128
    s_cmp_lg_u32 s100, 0
    s_cbranch_scc1 L_nos_16
    v_mfma_f32_16x16x32_bf16 v[96:99], v[136:139], v[212:215], v[96:99]
    v_mfma_f32_16x16x32_bf16 v[100:103], v[140:143], v[212:215], v[100:103]
    v_mfma_f32_16x16x32_bf16 v[104:107], v[144:147], v[212:215], v[104:107]
    v_mfma_f32_16x16x32_bf16 v[108:111], v[148:151], v[212:215], v[108:111]
    v_mfma_f32_16x16x32_bf16 v[112:115], v[152:155], v[212:215], v[112:115]
    v_mfma_f32_16x16x32_bf16 v[116:119], v[156:159], v[212:215], v[116:119]
L_nos_16:
    s_waitcnt lgkmcnt(0)
    s_waitcnt vmcnt(12)
    s_barrier
    v_mfma_f32_16x16x32_bf16 v[0:3], v[176:179], v[160:163], v[0:3]
    v_add_u32 v218, 0xfffeb000, v218
    s_mul_i32 s36, s32, 360448
    v_mfma_f32_16x16x32_bf16 v[4:7], v[176:179], v[164:167], v[4:7]
    v_add_u32 v216, 0xfffeb000, v216
    s_mul_i32 s55, s32, 10752
    v_mfma_f32_16x16x32_bf16 v[8:11], v[176:179], v[168:171], v[8:11]
    ds_read_b64_tr_b16 v[136:137], v218 offset:0
    s_add_u32 s44, s55, 0
    v_mfma_f32_16x16x32_bf16 v[12:15], v[176:179], v[172:175], v[12:15]
    s_cmp_eq_u32 s32, 3
    s_cselect_b32 s37, 5, 6
    s_cselect_b32 s38, 1073741824, s36
    v_mfma_f32_16x16x32_bf16 v[28:31], v[180:183], v[172:175], v[28:31]
    ds_read_b64_tr_b16 v[138:139], v218 offset:12288
    ds_read_b128 v[120:123], v216 offset:0
    v_mfma_f32_16x16x32_bf16 v[24:27], v[180:183], v[168:171], v[24:27]
    v_add_u32 v219, 0xfffeb000, v219
    s_lshl_b32 s37, s37, 15
    v_mfma_f32_16x16x32_bf16 v[20:23], v[180:183], v[164:167], v[20:23]
    v_add_u32 v217, 0xfffeb000, v217
    s_add_u32 s37, s37, s36
    v_mfma_f32_16x16x32_bf16 v[16:19], v[180:183], v[160:163], v[16:19]
    ds_read_b128 v[124:127], v216 offset:2048
    s_lshl_b32 s39, s32, 17
    v_mfma_f32_16x16x32_bf16 v[32:35], v[184:187], v[160:163], v[32:35]
    ds_read_b128 v[128:131], v216 offset:4096
    s_lshl_b32 s55, s68, 2
    v_mfma_f32_16x16x32_bf16 v[36:39], v[184:187], v[164:167], v[36:39]
    ds_read_b128 v[132:135], v216 offset:6144
    s_add_u32 s55, s55, s32
    v_mfma_f32_16x16x32_bf16 v[40:43], v[184:187], v[168:171], v[40:43]
    ds_read_b64_tr_b16 v[140:141], v219 offset:0
    s_lshl_b32 s55, s55, 7
    v_mfma_f32_16x16x32_bf16 v[44:47], v[184:187], v[172:175], v[44:47]
    ds_read_b64_tr_b16 v[142:143], v219 offset:12288
    s_add_u32 s41, s55, 32768
    v_mfma_f32_16x16x32_bf16 v[60:63], v[188:191], v[172:175], v[60:63]
    ds_read_b64_tr_b16 v[144:145], v218 offset:1024
    ds_read_b64_tr_b16 v[146:147], v218 offset:13312
    v_mfma_f32_16x16x32_bf16 v[56:59], v[188:191], v[168:171], v[56:59]
    ds_read_b64_tr_b16 v[148:149], v219 offset:1024
    s_add_u32 s53, s36, 0
    s_add_u32 m0, s44, 86016
    v_mfma_f32_16x16x32_bf16 v[52:55], v[188:191], v[164:167], v[52:55]
    ds_read_b64_tr_b16 v[150:151], v219 offset:13312
    buffer_load_dwordx4 v220, s[20:23], s53 offen lds
    v_mfma_f32_16x16x32_bf16 v[48:51], v[188:191], v[160:163], v[48:51]
L_pad_m2:
    s_cmp_eq_u32 s99, 1
    s_cbranch_scc1 L_padback_m
    ds_read_b64_tr_b16 v[152:153], v218 offset:2048
    buffer_load_dwordx4 v221, s[20:23], s53 offen offset:1024 lds
    v_mfma_f32_16x16x32_bf16 v[64:67], v[192:195], v[160:163], v[64:67]
    ds_read_b64_tr_b16 v[154:155], v218 offset:14336
    s_add_u32 s53, s36, 16384
    s_add_u32 m0, s44, 88064
    v_mfma_f32_16x16x32_bf16 v[68:71], v[192:195], v[164:167], v[68:71]
    ds_read_b64_tr_b16 v[156:157], v219 offset:2048
    buffer_load_dwordx4 v220, s[20:23], s53 offen lds
    v_mfma_f32_16x16x32_bf16 v[72:75], v[192:195], v[168:171], v[72:75]
    ds_read_b64_tr_b16 v[158:159], v219 offset:14336
    buffer_load_dwordx4 v[232:235], v227, s[12:15], 0 offen sc1
    v_mfma_f32_16x16x32_bf16 v[76:79], v[192:195], v[172:175], v[76:79]
    buffer_load_dwordx4 v221, s[20:23], s53 offen offset:1024 lds
    v_mfma_f32_16x16x32_bf16 v[92:95], v[196:199], v[172:175], v[92:95]
    ds_read_b64_tr_b16 a[210:211], v208 offset:4096
    ds_read_b64_tr_b16 a[214:215], v209 offset:4096
    ds_read_b64_tr_b16 a[218:219], v210 offset:4096
    v_mfma_f32_16x16x32_bf16 v[88:91], v[196:199], v[168:171], v[88:91]
    ds_read_b64_tr_b16 a[222:223], v211 offset:4096
    s_add_u32 s53, s36, 32768
    s_add_u32 m0, s44, 90112
    v_mfma_f32_16x16x32_bf16 v[84:87], v[196:199], v[164:167], v[84:87]
    buffer_load_dwordx4 v220, s[20:23], s53 offen lds
    v_mfma_f32_16x16x32_bf16 v[80:83], v[196:199], v[160:163], v[80:83]
    buffer_load_dwordx4 v221, s[20:23], s53 offen offset:1024 lds
    s_cmp_lg_u32 s100, 1
    s_cbranch_scc1 L_nos_17
    v_mfma_f32_16x16x32_bf16 v[96:99], v[176:179], v[212:215], v[96:99]
    v_mfma_f32_16x16x32_bf16 v[100:103], v[180:183], v[212:215], v[100:103]
    v_mfma_f32_16x16x32_bf16 v[104:107], v[184:187], v[212:215], v[104:107]
    v_mfma_f32_16x16x32_bf16 v[108:111], v[188:191], v[212:215], v[108:111]
    v_mfma_f32_16x16x32_bf16 v[112:115], v[192:195], v[212:215], v[112:115]
    v_mfma_f32_16x16x32_bf16 v[116:119], v[196:199], v[212:215], v[116:119]
L_nos_17:
    s_waitcnt lgkmcnt(0)
    v_mfma_f32_16x16x32_bf16 v[0:3], v[136:139], v[120:123], v[0:3]
    ds_read_b64_tr_b16 v[176:177], v218 offset:3072
    v_bfe_u32 v252, v239, 2, 2
    v_mfma_f32_16x16x32_bf16 v[4:7], v[136:139], v[124:127], v[4:7]
    ds_read_b64_tr_b16 v[178:179], v218 offset:15360
    v_mfma_f32_16x16x32_bf16 v[8:11], v[136:139], v[128:131], v[8:11]
    ds_read_b128 v[160:163], v217 offset:0
    v_lshrrev_b32 v253, 4, v239
    v_mfma_f32_16x16x32_bf16 v[12:15], v[136:139], v[132:135], v[12:15]
    s_add_u32 s53, s63, 114688
    s_add_u32 m0, s64, 0
    v_mfma_f32_16x16x32_bf16 v[28:31], v[140:143], v[132:135], v[28:31]
    ds_read_b128 v[164:167], v217 offset:2048
    ds_read_b128 v[168:171], v217 offset:4096
    v_mfma_f32_16x16x32_bf16 v[24:27], v[140:143], v[128:131], v[24:27]
    buffer_load_dwordx4 v204, s[24:27], s53 offen lds
    v_mfma_f32_16x16x32_bf16 v[20:23], v[140:143], v[124:127], v[20:23]
    ds_read_b128 v[172:175], v217 offset:6144
    v_lshl_add_u32 v254, v253, 2, v252
    v_mfma_f32_16x16x32_bf16 v[16:19], v[140:143], v[120:123], v[16:19]
    ds_read_b64_tr_b16 v[180:181], v219 offset:3072
    v_bfe_u32 v255, v254, 1, 2
    v_mfma_f32_16x16x32_bf16 v[32:35], v[144:147], v[120:123], v[32:35]
    buffer_load_dwordx4 v205, s[24:27], s53 offen offset:1024 lds
    v_mfma_f32_16x16x32_bf16 v[36:39], v[144:147], v[124:127], v[36:39]
    ds_read_b64_tr_b16 v[182:183], v219 offset:15360
    ds_read_b64_tr_b16 v[184:185], v218 offset:4096
    v_mfma_f32_16x16x32_bf16 v[40:43], v[144:147], v[128:131], v[40:43]
    s_add_u32 s53, s36, 49152
    s_add_u32 m0, s44, 92160
    v_mfma_f32_16x16x32_bf16 v[44:47], v[144:147], v[132:135], v[44:47]
    ds_read_b64_tr_b16 v[186:187], v218 offset:16384
    v_lshlrev_b32 v255, 5, v255
    v_mfma_f32_16x16x32_bf16 v[60:63], v[148:151], v[132:135], v[60:63]
    ds_read_b64_tr_b16 v[188:189], v219 offset:4096
    v_lshl_add_u32 v255, v254, 7, v255
    v_and_b32 v252, 3, v239
    v_lshl_add_u32 v255, v252, 3, v255
    v_mfma_f32_16x16x32_bf16 v[56:59], v[148:151], v[128:131], v[56:59]
    buffer_load_dwordx4 v220, s[20:23], s53 offen lds
    v_mfma_f32_16x16x32_bf16 v[52:55], v[148:151], v[124:127], v[52:55]
    ds_read_b64_tr_b16 v[190:191], v219 offset:16384
    ds_read_b64_tr_b16 v[192:193], v218 offset:5120
    v_mfma_f32_16x16x32_bf16 v[48:51], v[148:151], v[120:123], v[48:51]
    buffer_load_dwordx4 v221, s[20:23], s53 offen offset:1024 lds
    v_mfma_f32_16x16x32_bf16 v[64:67], v[152:155], v[120:123], v[64:67]
    ds_read_b64_tr_b16 v[194:195], v218 offset:17408
    ds_read_b64_tr_b16 v[196:197], v219 offset:5120
    v_mfma_f32_16x16x32_bf16 v[68:71], v[152:155], v[124:127], v[68:71]
    s_add_u32 s53, s37, 0
    s_add_u32 m0, s44, 94208
    v_mfma_f32_16x16x32_bf16 v[72:75], v[152:155], v[128:131], v[72:75]
    ds_read_b64_tr_b16 v[198:199], v219 offset:17408
    s_mul_i32 s54, s32, 10752
    v_mfma_f32_16x16x32_bf16 v[76:79], v[152:155], v[132:135], v[76:79]
    s_add_u32 s54, s54, 86016
    v_add_u32 v228, s54, v255
    v_mfma_f32_16x16x32_bf16 v[92:95], v[156:159], v[132:135], v[92:95]
    buffer_load_dwordx4 v220, s[20:23], s53 offen lds
    v_mfma_f32_16x16x32_bf16 v[88:91], v[156:159], v[128:131], v[88:91]
    v_xor_b32 v229, 32, v228
    v_xor_b32 v230, 64, v228
    v_mfma_f32_16x16x32_bf16 v[84:87], v[156:159], v[124:127], v[84:87]
    buffer_load_dwordx4 v221, s[20:23], s53 offen offset:1024 lds
    v_mfma_f32_16x16x32_bf16 v[80:83], v[156:159], v[120:123], v[80:83]
    v_xor_b32 v231, 96, v228
    s_cmp_lg_u32 s100, 0
    s_cbranch_scc1 L_nos_18
    v_mfma_f32_16x16x32_bf16 v[96:99], v[136:139], v[212:215], v[96:99]
    v_mfma_f32_16x16x32_bf16 v[100:103], v[140:143], v[212:215], v[100:103]
    v_mfma_f32_16x16x32_bf16 v[104:107], v[144:147], v[212:215], v[104:107]
    v_mfma_f32_16x16x32_bf16 v[108:111], v[148:151], v[212:215], v[108:111]
    v_mfma_f32_16x16x32_bf16 v[112:115], v[152:155], v[212:215], v[112:115]
    v_mfma_f32_16x16x32_bf16 v[116:119], v[156:159], v[212:215], v[116:119]
L_nos_18:
    s_waitcnt lgkmcnt(0)
    s_waitcnt vmcnt(13)
    s_barrier
    v_mfma_f32_16x16x32_bf16 v[0:3], v[176:179], v[160:163], v[0:3]
    v_add_u32 v218, 0xa800, v218
    v_add_u32 v216, 0xa800, v216
    v_mfma_f32_16x16x32_bf16 v[4:7], v[176:179], v[164:167], v[4:7]
    s_add_u32 s53, s37, 16384
    s_add_u32 m0, s44, 0
    v_mfma_f32_16x16x32_bf16 v[8:11], v[176:179], v[168:171], v[8:11]
    ds_read_b64_tr_b16 v[136:137], v218 offset:0
    ds_read_b64_tr_b16 v[138:139], v218 offset:12288
    v_mfma_f32_16x16x32_bf16 v[12:15], v[176:179], v[172:175], v[12:15]
    buffer_load_dwordx4 v220, s[20:23], s53 offen lds
    v_mfma_f32_16x16x32_bf16 v[28:31], v[180:183], v[172:175], v[28:31]
    ds_read_b128 v[120:123], v216 offset:0
    v_mfma_f32_16x16x32_bf16 v[24:27], v[180:183], v[168:171], v[24:27]
    v_add_u32 v219, 0xa800, v219
    v_add_u32 v217, 0xa800, v217
    v_mfma_f32_16x16x32_bf16 v[20:23], v[180:183], v[164:167], v[20:23]
    buffer_load_dwordx4 v221, s[20:23], s53 offen offset:1024 lds
    v_mfma_f32_16x16x32_bf16 v[16:19], v[180:183], v[160:163], v[16:19]
    ds_read_b128 v[124:127], v216 offset:2048
    v_mfma_f32_16x16x32_bf16 v[32:35], v[184:187], v[160:163], v[32:35]
    ds_read_b128 v[128:131], v216 offset:4096
    ds_read_b128 v[132:135], v216 offset:6144
    v_mfma_f32_16x16x32_bf16 v[36:39], v[184:187], v[164:167], v[36:39]
    s_add_u32 s53, s37, 32768
    s_add_u32 m0, s44, 2048
    v_mfma_f32_16x16x32_bf16 v[40:43], v[184:187], v[168:171], v[40:43]
    ds_read_b64_tr_b16 v[140:141], v219 offset:0
    ds_read_b64_tr_b16 v[142:143], v219 offset:12288
    v_mfma_f32_16x16x32_bf16 v[44:47], v[184:187], v[172:175], v[44:47]
    buffer_load_dwordx4 v220, s[20:23], s53 offen lds
    v_mfma_f32_16x16x32_bf16 v[60:63], v[188:191], v[172:175], v[60:63]
    ds_read_b64_tr_b16 v[144:145], v218 offset:1024
    ds_read_b64_tr_b16 v[146:147], v218 offset:13312
    v_mfma_f32_16x16x32_bf16 v[56:59], v[188:191], v[168:171], v[56:59]
    ds_read_b64_tr_b16 v[148:149], v219 offset:1024
    v_mfma_f32_16x16x32_bf16 v[52:55], v[188:191], v[164:167], v[52:55]
    buffer_load_dwordx4 v221, s[20:23], s53 offen offset:1024 lds
    v_mfma_f32_16x16x32_bf16 v[48:51], v[188:191], v[160:163], v[48:51]
    ds_read_b64_tr_b16 v[150:151], v219 offset:13312
    ds_read_b64_tr_b16 v[152:153], v218 offset:2048
    v_mfma_f32_16x16x32_bf16 v[64:67], v[192:195], v[160:163], v[64:67]
    ds_read_b64_tr_b16 v[154:155], v218 offset:14336
    ds_read_b64_tr_b16 a[224:225], v208 offset:6144
    v_mfma_f32_16x16x32_bf16 v[68:71], v[192:195], v[164:167], v[68:71]
    s_add_u32 s53, s37, 49152
    s_add_u32 m0, s44, 4096
    v_mfma_f32_16x16x32_bf16 v[72:75], v[192:195], v[168:171], v[72:75]
    ds_read_b64_tr_b16 v[156:157], v219 offset:2048
    ds_read_b64_tr_b16 v[158:159], v219 offset:14336
    v_mfma_f32_16x16x32_bf16 v[76:79], v[192:195], v[172:175], v[76:79]
    buffer_load_dwordx4 v220, s[20:23], s53 offen lds
    v_mfma_f32_16x16x32_bf16 v[92:95], v[196:199], v[172:175], v[92:95]
    ds_read_b64_tr_b16 a[228:229], v209 offset:6144
    ds_read_b64_tr_b16 a[232:233], v210 offset:6144
    v_mfma_f32_16x16x32_bf16 v[88:91], v[196:199], v[168:171], v[88:91]
    ds_read_b64_tr_b16 a[236:237], v211 offset:6144
    v_mfma_f32_16x16x32_bf16 v[84:87], v[196:199], v[164:167], v[84:87]
    buffer_load_dwordx4 v221, s[20:23], s53 offen offset:1024 lds
    v_mfma_f32_16x16x32_bf16 v[80:83], v[196:199], v[160:163], v[80:83]
    s_cmp_lg_u32 s100, 1
    s_cbranch_scc1 L_nos_19
    v_mfma_f32_16x16x32_bf16 v[96:99], v[176:179], v[212:215], v[96:99]
    v_mfma_f32_16x16x32_bf16 v[100:103], v[180:183], v[212:215], v[100:103]
    v_mfma_f32_16x16x32_bf16 v[104:107], v[184:187], v[212:215], v[104:107]
    v_mfma_f32_16x16x32_bf16 v[108:111], v[188:191], v[212:215], v[108:111]
    v_mfma_f32_16x16x32_bf16 v[112:115], v[192:195], v[212:215], v[112:115]
    v_mfma_f32_16x16x32_bf16 v[116:119], v[196:199], v[212:215], v[116:119]
L_nos_19:
    s_waitcnt lgkmcnt(0)
    v_mfma_f32_16x16x32_bf16 v[0:3], v[136:139], v[120:123], v[0:3]
    ds_read_b64_tr_b16 v[176:177], v218 offset:3072
    v_mfma_f32_16x16x32_bf16 v[4:7], v[136:139], v[124:127], v[4:7]
    s_add_u32 s53, s36, 65536
    s_add_u32 m0, s44, 6144
    v_mfma_f32_16x16x32_bf16 v[8:11], v[136:139], v[128:131], v[8:11]
    ds_read_b64_tr_b16 v[178:179], v218 offset:15360
    ds_read_b128 v[160:163], v217 offset:0
    v_mfma_f32_16x16x32_bf16 v[12:15], v[136:139], v[132:135], v[12:15]
    s_waitcnt vmcnt(15)
    v_cmp_ne_u32 vcc, s58, v234
    v_cmp_ne_u32 s[66:67], s59, v235
    s_or_b64 vcc, vcc, s[66:67]
    s_cmp_eq_u64 vcc, 0
    s_cbranch_scc1 L_gat_ok_20
    s_mov_b32 s75, 0
L_gat_again_21:
    s_sleep 1
    buffer_load_dwordx4 v[232:235], v227, s[12:15], 0 offen sc1
    s_waitcnt vmcnt(0)
    v_cmp_ne_u32 vcc, s58, v234
    v_cmp_ne_u32 s[66:67], s59, v235
    s_or_b64 vcc, vcc, s[66:67]
    s_cmp_eq_u64 vcc, 0
    s_cbranch_scc1 L_gat_ok_20
    s_add_u32 s75, s75, 1
    s_cmp_lt_u32 s75, 4000
    s_cbranch_scc1 L_gat_again_21
L_gat_ok_20:
    ds_write_b32 v238, v232
    ds_write_b32 v238, v233 offset:576
    v_mfma_f32_16x16x32_bf16 v[28:31], v[140:143], v[132:135], v[28:31]
    ds_read_b128 v[164:167], v217 offset:2048
    ds_read_b128 v[168:171], v217 offset:4096
    v_mfma_f32_16x16x32_bf16 v[24:27], v[140:143], v[128:131], v[24:27]
    buffer_load_dwordx4 v220, s[20:23], s53 offen lds
    v_mfma_f32_16x16x32_bf16 v[20:23], v[140:143], v[124:127], v[20:23]
    ds_read_b128 v[172:175], v217 offset:6144
    v_mfma_f32_16x16x32_bf16 v[16:19], v[140:143], v[120:123], v[16:19]
    ds_read_b64_tr_b16 v[180:181], v219 offset:3072
    v_mfma_f32_16x16x32_bf16 v[32:35], v[144:147], v[120:123], v[32:35]
    ds_read_b64_tr_b16 v[182:183], v219 offset:15360
    v_mfma_f32_16x16x32_bf16 v[36:39], v[144:147], v[124:127], v[36:39]
    buffer_load_dwordx4 v221, s[20:23], s53 offen offset:1024 lds
    v_mfma_f32_16x16x32_bf16 v[40:43], v[144:147], v[128:131], v[40:43]
    ds_read_b64_tr_b16 v[184:185], v218 offset:4096
    v_mfma_f32_16x16x32_bf16 v[44:47], v[144:147], v[132:135], v[44:47]
    ds_read_b64_tr_b16 v[186:187], v218 offset:16384
    v_mfma_f32_16x16x32_bf16 v[60:63], v[148:151], v[132:135], v[60:63]
    ds_read_b64_tr_b16 v[188:189], v219 offset:4096
    v_mfma_f32_16x16x32_bf16 v[56:59], v[148:151], v[128:131], v[56:59]
    s_add_u32 s53, s36, 81920
    s_add_u32 m0, s44, 8192
    v_mfma_f32_16x16x32_bf16 v[52:55], v[148:151], v[124:127], v[52:55]
    ds_read_b64_tr_b16 v[190:191], v219 offset:16384
    ds_read_b64_tr_b16 v[192:193], v218 offset:5120
    v_mfma_f32_16x16x32_bf16 v[48:51], v[148:151], v[120:123], v[48:51]
    v_mfma_f32_16x16x32_bf16 v[64:67], v[152:155], v[120:123], v[64:67]
    ds_read_b64_tr_b16 v[194:195], v218 offset:17408
    ds_read_b64_tr_b16 v[196:197], v219 offset:5120
    v_mfma_f32_16x16x32_bf16 v[68:71], v[152:155], v[124:127], v[68:71]
    buffer_load_dwordx4 v220, s[20:23], s53 offen lds
    v_mfma_f32_16x16x32_bf16 v[72:75], v[152:155], v[128:131], v[72:75]
    ds_read_b64_tr_b16 v[198:199], v219 offset:17408
    v_mfma_f32_16x16x32_bf16 v[76:79], v[152:155], v[132:135], v[76:79]
    v_mfma_f32_16x16x32_bf16 v[92:95], v[156:159], v[132:135], v[92:95]
    v_mfma_f32_16x16x32_bf16 v[88:91], v[156:159], v[128:131], v[88:91]
    buffer_load_dwordx4 v221, s[20:23], s53 offen offset:1024 lds
    v_mfma_f32_16x16x32_bf16 v[84:87], v[156:159], v[124:127], v[84:87]
    v_mfma_f32_16x16x32_bf16 v[80:83], v[156:159], v[120:123], v[80:83]
    s_cmp_lg_u32 s100, 0
    s_cbranch_scc1 L_nos_22
    v_mfma_f32_16x16x32_bf16 v[96:99], v[136:139], v[212:215], v[96:99]
    v_mfma_f32_16x16x32_bf16 v[100:103], v[140:143], v[212:215], v[100:103]
    v_mfma_f32_16x16x32_bf16 v[104:107], v[144:147], v[212:215], v[104:107]
    v_mfma_f32_16x16x32_bf16 v[108:111], v[148:151], v[212:215], v[108:111]
    v_mfma_f32_16x16x32_bf16 v[112:115], v[152:155], v[212:215], v[112:115]
    v_mfma_f32_16x16x32_bf16 v[116:119], v[156:159], v[212:215], v[116:119]
L_nos_22:
    s_waitcnt lgkmcnt(0)
    s_barrier
    v_mfma_f32_16x16x32_bf16 v[0:3], v[176:179], v[160:163], v[0:3]
    v_mfma_f32_16x16x32_bf16 v[4:7], v[176:179], v[164:167], v[4:7]
    s_add_u32 s53, s36, 98304
    s_add_u32 m0, s44, 43008
    v_mfma_f32_16x16x32_bf16 v[8:11], v[176:179], v[168:171], v[8:11]
    v_add_u32 v232, 0xfffeb000, v228
    v_mfma_f32_16x16x32_bf16 v[12:15], v[176:179], v[172:175], v[12:15]
    buffer_load_dwordx4 v220, s[20:23], s53 offen lds
    v_mfma_f32_16x16x32_bf16 v[28:31], v[180:183], v[172:175], v[28:31]
    v_mfma_f32_16x16x32_bf16 v[24:27], v[180:183], v[168:171], v[24:27]
    v_mfma_f32_16x16x32_bf16 v[20:23], v[180:183], v[164:167], v[20:23]
    buffer_load_dwordx4 v221, s[20:23], s53 offen offset:1024 lds
    v_mfma_f32_16x16x32_bf16 v[16:19], v[180:183], v[160:163], v[16:19]
    v_mfma_f32_16x16x32_bf16 v[32:35], v[184:187], v[160:163], v[32:35]
    v_add_u32 v233, 0xfffeb000, v229
    s_waitcnt vmcnt(12)
    ds_read_b64_tr_b16 a[0:1], v228 offset:0
    v_mfma_f32_16x16x32_bf16 v[36:39], v[184:187], v[164:167], v[36:39]
    s_add_u32 s53, s36, 114688
    s_add_u32 m0, s44, 45056
    v_mfma_f32_16x16x32_bf16 v[40:43], v[184:187], v[168:171], v[40:43]
    ds_read_b64_tr_b16 a[4:5], v229 offset:0
    ds_read_b64_tr_b16 a[8:9], v230 offset:0
    v_mfma_f32_16x16x32_bf16 v[44:47], v[184:187], v[172:175], v[44:47]
    buffer_load_dwordx4 v220, s[20:23], s53 offen lds
    v_mfma_f32_16x16x32_bf16 v[60:63], v[188:191], v[172:175], v[60:63]
    ds_read_b64_tr_b16 a[12:13], v231 offset:0
    ds_read_b64_tr_b16 a[2:3], v228 offset:2048
    v_mfma_f32_16x16x32_bf16 v[56:59], v[188:191], v[168:171], v[56:59]
    ds_read_b64_tr_b16 a[6:7], v229 offset:2048
    ds_read_b64_tr_b16 a[10:11], v230 offset:2048
    v_mfma_f32_16x16x32_bf16 v[52:55], v[188:191], v[164:167], v[52:55]
    buffer_load_dwordx4 v221, s[20:23], s53 offen offset:1024 lds
    v_mfma_f32_16x16x32_bf16 v[48:51], v[188:191], v[160:163], v[48:51]
    v_add_u32 v234, 0xfffeb000, v230
    ds_read_b64_tr_b16 a[14:15], v231 offset:2048
    v_mfma_f32_16x16x32_bf16 v[64:67], v[192:195], v[160:163], v[64:67]
    ds_read_b64_tr_b16 a[16:17], v228 offset:4096
    ds_read_b64_tr_b16 a[20:21], v229 offset:4096
    ds_read_b64_tr_b16 a[24:25], v230 offset:4096
    v_mfma_f32_16x16x32_bf16 v[68:71], v[192:195], v[164:167], v[68:71]
    s_add_u32 s53, s37, 65536
    s_add_u32 m0, s44, 47104
    v_mfma_f32_16x16x32_bf16 v[72:75], v[192:195], v[168:171], v[72:75]
    ds_read_b64_tr_b16 a[226:227], v208 offset:0
    ds_read_b64_tr_b16 a[230:231], v209 offset:0
    v_mfma_f32_16x16x32_bf16 v[76:79], v[192:195], v[172:175], v[76:79]
    buffer_load_dwordx4 v220, s[20:23], s53 offen lds
    v_mfma_f32_16x16x32_bf16 v[92:95], v[196:199], v[172:175], v[92:95]
    ds_read_b64_tr_b16 a[234:235], v210 offset:0
    v_add_u32 v235, 0xfffeb000, v231
    v_mfma_f32_16x16x32_bf16 v[88:91], v[196:199], v[168:171], v[88:91]
    ds_read_b64_tr_b16 a[238:239], v211 offset:0
    ds_read_b64_tr_b16 a[28:29], v231 offset:4096
    v_mfma_f32_16x16x32_bf16 v[84:87], v[196:199], v[164:167], v[84:87]
    buffer_load_dwordx4 v221, s[20:23], s53 offen offset:1024 lds
    v_mfma_f32_16x16x32_bf16 v[80:83], v[196:199], v[160:163], v[80:83]
    ds_read_b64_tr_b16 a[18:19], v228 offset:6144
    ds_read_b64_tr_b16 a[22:23], v229 offset:6144
    ds_read_b64_tr_b16 a[26:27], v230 offset:6144
    ds_read_b64_tr_b16 a[30:31], v231 offset:6144
    ds_read_b64_tr_b16 a[32:33], v228 offset:8192
    ds_read_b64_tr_b16 a[36:37], v229 offset:8192
    ds_read_b64_tr_b16 a[40:41], v230 offset:8192
    ds_read_b64_tr_b16 a[44:45], v231 offset:8192
    s_cmp_lg_u32 s100, 1
    s_cbranch_scc1 L_nos_23
    v_mfma_f32_16x16x32_bf16 v[96:99], v[176:179], v[212:215], v[96:99]
    v_mfma_f32_16x16x32_bf16 v[100:103], v[180:183], v[212:215], v[100:103]
    v_mfma_f32_16x16x32_bf16 v[104:107], v[184:187], v[212:215], v[104:107]
    v_mfma_f32_16x16x32_bf16 v[108:111], v[188:191], v[212:215], v[108:111]
    v_mfma_f32_16x16x32_bf16 v[112:115], v[192:195], v[212:215], v[112:115]
    v_mfma_f32_16x16x32_bf16 v[116:119], v[196:199], v[212:215], v[116:119]
L_nos_23:
    v_lshrrev_b32 v245, 4, v239
    v_lshlrev_b32 v245, 4, v245
    s_mul_i32 s54, s32, 10752
    s_add_u32 s55, s54, 96256
    v_add_u32 v246, s55, v245
    s_xor_b32 s54, s32, 1
    s_mul_i32 s54, s54, 10752
    s_add_u32 s55, s54, 96256
    v_add_u32 v245, s55, v245
    s_mov_b32 exec_lo, 0x00010001
    s_mov_b32 exec_hi, 0x00010001
    ds_write_b128 v246, v[96:99] offset:0
    ds_write_b128 v246, v[100:103] offset:64
    ds_write_b128 v246, v[104:107] offset:128
    ds_write_b128 v246, v[108:111] offset:192
    ds_write_b128 v246, v[112:115] offset:256
    ds_write_b128 v246, v[116:119] offset:320
    s_mov_b64 exec, -1
    v_and_b32 v244, 15, v239
    s_lshl_b32 s54, s100, 6
    s_add_u32 s54, s54, 16
    v_add_u32 v244, s54, v244
    v_lshlrev_b32 v244, 2, v244
    v_add_u32 v244, 161792, v244
    ds_read2_b32 v[120:121], v244 offset0:0 offset1:144
    ds_read2_b32 v[122:123], v244 offset0:16 offset1:160
    ds_read2_b32 v[124:125], v244 offset0:32 offset1:176
    ds_read2_b32 v[126:127], v244 offset0:48 offset1:192
    s_add_u32 s53, s37, 81920
    s_add_u32 m0, s44, 49152
    s_nop 0
    buffer_load_dwordx4 v220, s[20:23], s53 offen lds
    buffer_load_dwordx4 v221, s[20:23], s53 offen offset:1024 lds
    s_add_u32 s53, s37, 98304
    s_add_u32 m0, s44, 51200
    s_waitcnt lgkmcnt(4)
    s_barrier
    ds_read_b128 v[128:131], v245 offset:0
    ds_read_b128 v[132:135], v245 offset:64
    ds_read_b128 v[136:139], v245 offset:128
    ds_read_b128 v[140:143], v245 offset:192
    ds_read_b128 v[144:147], v245 offset:256
    ds_read_b128 v[148:151], v245 offset:320
    buffer_load_dwordx4 v220, s[20:23], s53 offen lds
    buffer_load_dwordx4 v221, s[20:23], s53 offen offset:1024 lds
    s_add_u32 s53, s37, 114688
    s_add_u32 m0, s44, 86016
    s_waitcnt lgkmcnt(5)
    v_pk_add_f32 v[96:97], v[96:97], v[128:129]
    v_pk_add_f32 v[98:99], v[98:99], v[130:131]
    s_waitcnt lgkmcnt(4)
    v_pk_add_f32 v[100:101], v[100:101], v[132:133]
    buffer_load_dwordx4 v220, s[20:23], s53 offen lds
    v_pk_add_f32 v[102:103], v[102:103], v[134:135]
    s_waitcnt lgkmcnt(3)
    v_pk_add_f32 v[104:105], v[104:105], v[136:137]
    v_pk_add_f32 v[106:107], v[106:107], v[138:139]
    s_waitcnt lgkmcnt(2)
    v_pk_add_f32 v[108:109], v[108:109], v[140:141]
    v_pk_add_f32 v[110:111], v[110:111], v[142:143]
    s_waitcnt lgkmcnt(1)
    v_pk_add_f32 v[112:113], v[112:113], v[144:145]
    v_pk_add_f32 v[114:115], v[114:115], v[146:147]
    buffer_load_dwordx4 v221, s[20:23], s53 offen offset:1024 lds
    s_waitcnt lgkmcnt(0)
    v_pk_add_f32 v[116:117], v[116:117], v[148:149]
    v_pk_add_f32 v[118:119], v[118:119], v[150:151]
    v_pk_fma_f32 v[0:1], v[96:97], v[120:121], v[0:1] op_sel:[0,0,0] op_sel_hi:[1,0,1]
    v_pk_fma_f32 v[2:3], v[98:99], v[120:121], v[2:3] op_sel:[0,0,0] op_sel_hi:[1,0,1]
    v_pk_mul_f32 v[0:1], v[0:1], v[120:121] op_sel:[0,1] op_sel_hi:[1,1]
    v_pk_mul_f32 v[2:3], v[2:3], v[120:121] op_sel:[0,1] op_sel_hi:[1,1]
    v_cvt_pk_bf16_f32 v152, v0, v1
    s_add_u32 s53, s36, 131072
    s_add_u32 m0, s44, 88064
    v_cvt_pk_bf16_f32 v153, v2, v3
    v_pk_fma_f32 v[16:17], v[100:101], v[120:121], v[16:17] op_sel:[0,0,0] op_sel_hi:[1,0,1]
    v_pk_fma_f32 v[18:19], v[102:103], v[120:121], v[18:19] op_sel:[0,0,0] op_sel_hi:[1,0,1]
    v_pk_mul_f32 v[16:17], v[16:17], v[120:121] op_sel:[0,1] op_sel_hi:[1,1]
    v_pk_mul_f32 v[18:19], v[18:19], v[120:121] op_sel:[0,1] op_sel_hi:[1,1]
    v_cvt_pk_bf16_f32 v154, v16, v17
    v_cvt_pk_bf16_f32 v155, v18, v19
    buffer_load_dwordx4 v220, s[20:23], s53 offen lds
    v_pk_max_i16 v152, v152, 0
    v_pk_max_i16 v153, v153, 0
    v_pk_max_i16 v154, v154, 0
    v_pk_max_i16 v155, v155, 0
    v_or_b32 v152, v200, v152
    v_or_b32 v153, v201, v153
    v_or_b32 v154, v202, v154
    buffer_load_dwordx4 v221, s[20:23], s53 offen offset:1024 lds
    v_or_b32 v155, v203, v155
    s_add_u32 s57, s50, 0
    buffer_store_dwordx4 v[152:155], v240, s[12:15], s57 offen sc1
    v_pk_fma_f32 v[4:5], v[96:97], v[122:123], v[4:5] op_sel:[0,0,0] op_sel_hi:[1,0,1]
    v_pk_fma_f32 v[6:7], v[98:99], v[122:123], v[6:7] op_sel:[0,0,0] op_sel_hi:[1,0,1]
    v_pk_mul_f32 v[4:5], v[4:5], v[122:123] op_sel:[0,1] op_sel_hi:[1,1]
    v_pk_mul_f32 v[6:7], v[6:7], v[122:123] op_sel:[0,1] op_sel_hi:[1,1]
    v_cvt_pk_bf16_f32 v156, v4, v5
    v_cvt_pk_bf16_f32 v157, v6, v7
    s_add_u32 s53, s36, 147456
    s_add_u32 m0, s44, 90112
    v_pk_fma_f32 v[20:21], v[100:101], v[122:123], v[20:21] op_sel:[0,0,0] op_sel_hi:[1,0,1]
    v_pk_fma_f32 v[22:23], v[102:103], v[122:123], v[22:23] op_sel:[0,0,0] op_sel_hi:[1,0,1]
    v_pk_mul_f32 v[20:21], v[20:21], v[122:123] op_sel:[0,1] op_sel_hi:[1,1]
    v_pk_mul_f32 v[22:23], v[22:23], v[122:123] op_sel:[0,1] op_sel_hi:[1,1]
    v_cvt_pk_bf16_f32 v158, v20, v21
    v_cvt_pk_bf16_f32 v159, v22, v23
    v_pk_max_i16 v156, v156, 0
    buffer_load_dwordx4 v220, s[20:23], s53 offen lds
    v_pk_max_i16 v157, v157, 0
    v_pk_max_i16 v158, v158, 0
    v_pk_max_i16 v159, v159, 0
    v_or_b32 v156, v200, v156
    v_or_b32 v157, v201, v157
    v_or_b32 v158, v202, v158
    v_or_b32 v159, v203, v159
    buffer_load_dwordx4 v221, s[20:23], s53 offen offset:1024 lds
    s_add_u32 s57, s50, 60416
    buffer_store_dwordx4 v[156:159], v240, s[12:15], s57 offen sc1
    v_pk_fma_f32 v[8:9], v[96:97], v[124:125], v[8:9] op_sel:[0,0,0] op_sel_hi:[1,0,1]
    v_pk_fma_f32 v[10:11], v[98:99], v[124:125], v[10:11] op_sel:[0,0,0] op_sel_hi:[1,0,1]
    v_pk_mul_f32 v[8:9], v[8:9], v[124:125] op_sel:[0,1] op_sel_hi:[1,1]
    v_pk_mul_f32 v[10:11], v[10:11], v[124:125] op_sel:[0,1] op_sel_hi:[1,1]
    v_cvt_pk_bf16_f32 v160, v8, v9
    v_cvt_pk_bf16_f32 v161, v10, v11
    v_pk_fma_f32 v[24:25], v[100:101], v[124:125], v[24:25] op_sel:[0,0,0] op_sel_hi:[1,0,1]
    s_add_u32 s53, s38, 163840
    s_add_u32 m0, s44, 92160
    v_pk_fma_f32 v[26:27], v[102:103], v[124:125], v[26:27] op_sel:[0,0,0] op_sel_hi:[1,0,1]
    v_pk_mul_f32 v[24:25], v[24:25], v[124:125] op_sel:[0,1] op_sel_hi:[1,1]
    v_pk_mul_f32 v[26:27], v[26:27], v[124:125] op_sel:[0,1] op_sel_hi:[1,1]
    v_cvt_pk_bf16_f32 v162, v24, v25
    v_cvt_pk_bf16_f32 v163, v26, v27
    v_pk_max_i16 v160, v160, 0
    v_pk_max_i16 v161, v161, 0
    buffer_load_dwordx4 v220, s[20:23], s53 offen lds
    v_pk_max_i16 v162, v162, 0
    v_pk_max_i16 v163, v163, 0
    v_or_b32 v160, v200, v160
    v_or_b32 v161, v201, v161
    v_or_b32 v162, v202, v162
    v_or_b32 v163, v203, v163
    s_add_u32 s57, s50, 120832
    buffer_store_dwordx4 v[160:163], v240, s[12:15], s57 offen sc1
    v_pk_fma_f32 v[12:13], v[96:97], v[126:127], v[12:13] op_sel:[0,0,0] op_sel_hi:[1,0,1]
    buffer_load_dwordx4 v221, s[20:23], s53 offen offset:1024 lds
    v_pk_fma_f32 v[14:15], v[98:99], v[126:127], v[14:15] op_sel:[0,0,0] op_sel_hi:[1,0,1]
    v_pk_mul_f32 v[12:13], v[12:13], v[126:127] op_sel:[0,1] op_sel_hi:[1,1]
    v_pk_mul_f32 v[14:15], v[14:15], v[126:127] op_sel:[0,1] op_sel_hi:[1,1]
    v_cvt_pk_bf16_f32 v164, v12, v13
    v_cvt_pk_bf16_f32 v165, v14, v15
    v_pk_fma_f32 v[28:29], v[100:101], v[126:127], v[28:29] op_sel:[0,0,0] op_sel_hi:[1,0,1]
    v_pk_fma_f32 v[30:31], v[102:103], v[126:127], v[30:31] op_sel:[0,0,0] op_sel_hi:[1,0,1]
    s_add_u32 s53, s38, 180224
    s_add_u32 m0, s44, 94208
    v_pk_mul_f32 v[28:29], v[28:29], v[126:127] op_sel:[0,1] op_sel_hi:[1,1]
    v_pk_mul_f32 v[30:31], v[30:31], v[126:127] op_sel:[0,1] op_sel_hi:[1,1]
    v_cvt_pk_bf16_f32 v166, v28, v29
    v_cvt_pk_bf16_f32 v167, v30, v31
    v_pk_max_i16 v164, v164, 0
    v_pk_max_i16 v165, v165, 0
    v_pk_max_i16 v166, v166, 0
    buffer_load_dwordx4 v220, s[20:23], s53 offen lds
    v_pk_max_i16 v167, v167, 0
    v_or_b32 v164, v200, v164
    v_or_b32 v165, v201, v165
    v_or_b32 v166, v202, v166
    v_or_b32 v167, v203, v167
    s_add_u32 s57, s50, 181248
    buffer_store_dwordx4 v[164:167], v240, s[12:15], s57 offen sc1
    v_pk_fma_f32 v[32:33], v[104:105], v[120:121], v[32:33] op_sel:[0,0,0] op_sel_hi:[1,0,1]
    v_pk_fma_f32 v[34:35], v[106:107], v[120:121], v[34:35] op_sel:[0,0,0] op_sel_hi:[1,0,1]
    buffer_load_dwordx4 v221, s[20:23], s53 offen offset:1024 lds
    v_pk_mul_f32 v[32:33], v[32:33], v[120:121] op_sel:[0,1] op_sel_hi:[1,1]
    v_pk_mul_f32 v[34:35], v[34:35], v[120:121] op_sel:[0,1] op_sel_hi:[1,1]
    v_cvt_pk_bf16_f32 v152, v32, v33
    v_cvt_pk_bf16_f32 v153, v34, v35
    v_pk_fma_f32 v[48:49], v[108:109], v[120:121], v[48:49] op_sel:[0,0,0] op_sel_hi:[1,0,1]
    v_pk_fma_f32 v[50:51], v[110:111], v[120:121], v[50:51] op_sel:[0,0,0] op_sel_hi:[1,0,1]
    v_pk_mul_f32 v[48:49], v[48:49], v[120:121] op_sel:[0,1] op_sel_hi:[1,1]
    s_waitcnt vmcnt(24)
    v_pk_mul_f32 v[50:51], v[50:51], v[120:121] op_sel:[0,1] op_sel_hi:[1,1]
    v_cvt_pk_bf16_f32 v154, v48, v49
    v_cvt_pk_bf16_f32 v155, v50, v51
    v_pk_max_i16 v152, v152, 0
    v_pk_max_i16 v153, v153, 0
    v_pk_max_i16 v154, v154, 0
    v_pk_max_i16 v155, v155, 0
    ds_read_b64_tr_b16 a[34:35], v232 offset:0
    ds_read_b64_tr_b16 a[38:39], v233 offset:0
    v_or_b32 v152, v200, v152
    v_or_b32 v153, v201, v153
    v_or_b32 v154, v202, v154
    v_or_b32 v155, v203, v155
    s_add_u32 s57, s50, 2048
    buffer_store_dwordx4 v[152:155], v240, s[12:15], s57 offen sc1
    v_pk_fma_f32 v[36:37], v[104:105], v[122:123], v[36:37] op_sel:[0,0,0] op_sel_hi:[1,0,1]
    v_pk_fma_f32 v[38:39], v[106:107], v[122:123], v[38:39] op_sel:[0,0,0] op_sel_hi:[1,0,1]
    v_pk_mul_f32 v[36:37], v[36:37], v[122:123] op_sel:[0,1] op_sel_hi:[1,1]
    ds_read_b64_tr_b16 a[42:43], v234 offset:0
    ds_read_b64_tr_b16 a[46:47], v235 offset:0
    v_pk_mul_f32 v[38:39], v[38:39], v[122:123] op_sel:[0,1] op_sel_hi:[1,1]
    v_cvt_pk_bf16_f32 v156, v36, v37
    v_cvt_pk_bf16_f32 v157, v38, v39
    v_pk_fma_f32 v[52:53], v[108:109], v[122:123], v[52:53] op_sel:[0,0,0] op_sel_hi:[1,0,1]
    v_pk_fma_f32 v[54:55], v[110:111], v[122:123], v[54:55] op_sel:[0,0,0] op_sel_hi:[1,0,1]
    v_pk_mul_f32 v[52:53], v[52:53], v[122:123] op_sel:[0,1] op_sel_hi:[1,1]
    v_pk_mul_f32 v[54:55], v[54:55], v[122:123] op_sel:[0,1] op_sel_hi:[1,1]
    ds_read_b64_tr_b16 a[48:49], v232 offset:2048
    ds_read_b64_tr_b16 a[52:53], v233 offset:2048
    v_cvt_pk_bf16_f32 v158, v52, v53
    v_cvt_pk_bf16_f32 v159, v54, v55
    v_pk_max_i16 v156, v156, 0
    v_pk_max_i16 v157, v157, 0
    v_pk_max_i16 v158, v158, 0
    v_pk_max_i16 v159, v159, 0
    v_or_b32 v156, v200, v156
    ds_read_b64_tr_b16 a[56:57], v234 offset:2048
    ds_read_b64_tr_b16 a[60:61], v235 offset:2048
    v_or_b32 v157, v201, v157
    v_or_b32 v158, v202, v158
    v_or_b32 v159, v203, v159
L_pad_m3:
    s_cmp_eq_u32 s99, 1
    s_cbranch_scc1 L_padback_m
    s_add_u32 s57, s50, 62464
    buffer_store_dwordx4 v[156:159], v240, s[12:15], s57 offen sc1
    v_pk_fma_f32 v[40:41], v[104:105], v[124:125], v[40:41] op_sel:[0,0,0] op_sel_hi:[1,0,1]
    v_pk_fma_f32 v[42:43], v[106:107], v[124:125], v[42:43] op_sel:[0,0,0] op_sel_hi:[1,0,1]
    v_pk_mul_f32 v[40:41], v[40:41], v[124:125] op_sel:[0,1] op_sel_hi:[1,1]
    v_pk_mul_f32 v[42:43], v[42:43], v[124:125] op_sel:[0,1] op_sel_hi:[1,1]
    ds_read_b64_tr_b16 a[50:51], v232 offset:4096
    ds_read_b64_tr_b16 a[54:55], v233 offset:4096
    v_cvt_pk_bf16_f32 v160, v40, v41
    v_cvt_pk_bf16_f32 v161, v42, v43
    v_pk_fma_f32 v[56:57], v[108:109], v[124:125], v[56:57] op_sel:[0,0,0] op_sel_hi:[1,0,1]
    v_pk_fma_f32 v[58:59], v[110:111], v[124:125], v[58:59] op_sel:[0,0,0] op_sel_hi:[1,0,1]
    v_pk_mul_f32 v[56:57], v[56:57], v[124:125] op_sel:[0,1] op_sel_hi:[1,1]
    v_pk_mul_f32 v[58:59], v[58:59], v[124:125] op_sel:[0,1] op_sel_hi:[1,1]
    v_cvt_pk_bf16_f32 v162, v56, v57
    ds_read_b64_tr_b16 a[58:59], v234 offset:4096
    ds_read_b64_tr_b16 a[62:63], v235 offset:4096
    v_cvt_pk_bf16_f32 v163, v58, v59
    v_pk_max_i16 v160, v160, 0
    v_pk_max_i16 v161, v161, 0
    v_pk_max_i16 v162, v162, 0
    v_pk_max_i16 v163, v163, 0
    v_or_b32 v160, v200, v160
    v_or_b32 v161, v201, v161
    ds_read_b64_tr_b16 a[64:65], v232 offset:6144
    ds_read_b64_tr_b16 a[68:69], v233 offset:6144
    v_or_b32 v162, v202, v162
    v_or_b32 v163, v203, v163
    s_add_u32 s57, s50, 122880
    buffer_store_dwordx4 v[160:163], v240, s[12:15], s57 offen sc1
    v_pk_fma_f32 v[44:45], v[104:105], v[126:127], v[44:45] op_sel:[0,0,0] op_sel_hi:[1,0,1]
    v_pk_fma_f32 v[46:47], v[106:107], v[126:127], v[46:47] op_sel:[0,0,0] op_sel_hi:[1,0,1]
    v_pk_mul_f32 v[44:45], v[44:45], v[126:127] op_sel:[0,1] op_sel_hi:[1,1]
    v_pk_mul_f32 v[46:47], v[46:47], v[126:127] op_sel:[0,1] op_sel_hi:[1,1]
    v_cvt_pk_bf16_f32 v164, v44, v45
    ds_read_b64_tr_b16 a[72:73], v234 offset:6144
    ds_read_b64_tr_b16 a[76:77], v235 offset:6144
    v_cvt_pk_bf16_f32 v165, v46, v47
    v_pk_fma_f32 v[60:61], v[108:109], v[126:127], v[60:61] op_sel:[0,0,0] op_sel_hi:[1,0,1]
    v_pk_fma_f32 v[62:63], v[110:111], v[126:127], v[62:63] op_sel:[0,0,0] op_sel_hi:[1,0,1]
    v_pk_mul_f32 v[60:61], v[60:61], v[126:127] op_sel:[0,1] op_sel_hi:[1,1]
    v_pk_mul_f32 v[62:63], v[62:63], v[126:127] op_sel:[0,1] op_sel_hi:[1,1]
    v_cvt_pk_bf16_f32 v166, v60, v61
    v_cvt_pk_bf16_f32 v167, v62, v63
    ds_read_b64_tr_b16 a[66:67], v232 offset:8192
    ds_read_b64_tr_b16 a[70:71], v233 offset:8192
    v_pk_max_i16 v164, v164, 0
    v_pk_max_i16 v165, v165, 0
    v_pk_max_i16 v166, v166, 0
    v_pk_max_i16 v167, v167, 0
    v_or_b32 v164, v200, v164
    v_or_b32 v165, v201, v165
    v_or_b32 v166, v202, v166
    ds_read_b64_tr_b16 a[74:75], v234 offset:8192
    ds_read_b64_tr_b16 a[78:79], v235 offset:8192
    v_or_b32 v167, v203, v167
    s_add_u32 s57, s50, 183296
    buffer_store_dwordx4 v[164:167], v240, s[12:15], s57 offen sc1
    buffer_load_dwordx2 v[222:223], v236, s[12:15], s41 offen sc1
    s_waitcnt lgkmcnt(0)
    s_add_u32 s53, s37, 131072
    s_add_u32 m0, s44, 0
    s_nop 0
    buffer_load_dwordx4 v220, s[20:23], s53 offen lds
    buffer_load_dwordx4 v221, s[20:23], s53 offen offset:1024 lds
    s_add_u32 s53, s37, 147456
    s_add_u32 m0, s44, 2048
    s_nop 0
    buffer_load_dwordx4 v220, s[20:23], s53 offen lds
    buffer_load_dwordx4 v221, s[20:23], s53 offen offset:1024 lds
    s_add_u32 s53, s39, 0
    s_add_u32 m0, s44, 4096
    s_nop 0
    buffer_load_dwordx4 v220, s[24:27], s53 offen lds
    buffer_load_dwordx4 v221, s[24:27], s53 offen offset:1024 lds
    s_add_u32 s53, s39, 16384
    s_add_u32 m0, s44, 6144
    s_nop 0
    buffer_load_dwordx4 v220, s[24:27], s53 offen lds
    buffer_load_dwordx4 v221, s[24:27], s53 offen offset:1024 lds
    s_add_u32 s53, s39, 32768
    s_add_u32 m0, s44, 8192
    s_nop 0
    buffer_load_dwordx4 v220, s[24:27], s53 offen lds
    buffer_load_dwordx4 v221, s[24:27], s53 offen offset:1024 lds
    s_waitcnt vmcnt(29)
    ds_read_b64_tr_b16 a[80:81], v232 offset:43008
    ds_read_b64_tr_b16 a[84:85], v233 offset:43008
    ds_read_b64_tr_b16 a[88:89], v234 offset:43008
    ds_read_b64_tr_b16 a[92:93], v235 offset:43008
    ds_read_b64_tr_b16 a[82:83], v232 offset:45056
    ds_read_b64_tr_b16 a[86:87], v233 offset:45056
    ds_read_b64_tr_b16 a[90:91], v234 offset:45056
    ds_read_b64_tr_b16 a[94:95], v235 offset:45056
    ds_read_b64_tr_b16 a[96:97], v232 offset:47104
    ds_read_b64_tr_b16 a[100:101], v233 offset:47104
    ds_read_b64_tr_b16 a[104:105], v234 offset:47104
    ds_read_b64_tr_b16 a[108:109], v235 offset:47104
    ds_read_b64_tr_b16 a[98:99], v232 offset:49152
    ds_read_b64_tr_b16 a[102:103], v233 offset:49152
    ds_read_b64_tr_b16 a[106:107], v234 offset:49152
    ds_read_b64_tr_b16 a[110:111], v235 offset:49152
    ds_read_b64_tr_b16 a[112:113], v232 offset:51200
    ds_read_b64_tr_b16 a[116:117], v233 offset:51200
    ds_read_b64_tr_b16 a[120:121], v234 offset:51200
    ds_read_b64_tr_b16 a[124:125], v235 offset:51200
    s_lshr_b32 s55, s32, 1
    s_add_u32 s55, s55, 4
    s_cmp_ge_u32 s55, s101
    s_cbranch_scc1 L_nopair_24
    v_pk_fma_f32 v[64:65], v[112:113], v[120:121], v[64:65] op_sel:[0,0,0] op_sel_hi:[1,0,1]
    v_pk_fma_f32 v[66:67], v[114:115], v[120:121], v[66:67] op_sel:[0,0,0] op_sel_hi:[1,0,1]
    v_pk_mul_f32 v[64:65], v[64:65], v[120:121] op_sel:[0,1] op_sel_hi:[1,1]
    v_pk_mul_f32 v[66:67], v[66:67], v[120:121] op_sel:[0,1] op_sel_hi:[1,1]
    v_cvt_pk_bf16_f32 v152, v64, v65
    v_cvt_pk_bf16_f32 v153, v66, v67
    v_pk_fma_f32 v[80:81], v[116:117], v[120:121], v[80:81] op_sel:[0,0,0] op_sel_hi:[1,0,1]
    v_pk_fma_f32 v[82:83], v[118:119], v[120:121], v[82:83] op_sel:[0,0,0] op_sel_hi:[1,0,1]
    v_pk_mul_f32 v[80:81], v[80:81], v[120:121] op_sel:[0,1] op_sel_hi:[1,1]
    v_pk_mul_f32 v[82:83], v[82:83], v[120:121] op_sel:[0,1] op_sel_hi:[1,1]
    v_cvt_pk_bf16_f32 v154, v80, v81
    v_cvt_pk_bf16_f32 v155, v82, v83
    v_pk_max_i16 v152, v152, 0
    v_pk_max_i16 v153, v153, 0
    v_pk_max_i16 v154, v154, 0
    v_pk_max_i16 v155, v155, 0
    v_or_b32 v152, v200, v152
    v_or_b32 v153, v201, v153
    v_or_b32 v154, v202, v154
    v_or_b32 v155, v203, v155
    s_add_u32 s57, s50, 4096
    buffer_store_dwordx4 v[152:155], v240, s[12:15], s57 offen sc1
    v_pk_fma_f32 v[68:69], v[112:113], v[122:123], v[68:69] op_sel:[0,0,0] op_sel_hi:[1,0,1]
    v_pk_fma_f32 v[70:71], v[114:115], v[122:123], v[70:71] op_sel:[0,0,0] op_sel_hi:[1,0,1]
    v_pk_mul_f32 v[68:69], v[68:69], v[122:123] op_sel:[0,1] op_sel_hi:[1,1]
    v_pk_mul_f32 v[70:71], v[70:71], v[122:123] op_sel:[0,1] op_sel_hi:[1,1]
    v_cvt_pk_bf16_f32 v156, v68, v69
    v_cvt_pk_bf16_f32 v157, v70, v71
    v_pk_fma_f32 v[84:85], v[116:117], v[122:123], v[84:85] op_sel:[0,0,0] op_sel_hi:[1,0,1]
    v_pk_fma_f32 v[86:87], v[118:119], v[122:123], v[86:87] op_sel:[0,0,0] op_sel_hi:[1,0,1]
    v_pk_mul_f32 v[84:85], v[84:85], v[122:123] op_sel:[0,1] op_sel_hi:[1,1]
    v_pk_mul_f32 v[86:87], v[86:87], v[122:123] op_sel:[0,1] op_sel_hi:[1,1]
    v_cvt_pk_bf16_f32 v158, v84, v85
    v_cvt_pk_bf16_f32 v159, v86, v87
    v_pk_max_i16 v156, v156, 0
    v_pk_max_i16 v157, v157, 0
    v_pk_max_i16 v158, v158, 0
    v_pk_max_i16 v159, v159, 0
    v_or_b32 v156, v200, v156
    v_or_b32 v157, v201, v157
    v_or_b32 v158, v202, v158
    v_or_b32 v159, v203, v159
    s_add_u32 s57, s50, 64512
    buffer_store_dwordx4 v[156:159], v240, s[12:15], s57 offen sc1
    v_pk_fma_f32 v[72:73], v[112:113], v[124:125], v[72:73] op_sel:[0,0,0] op_sel_hi:[1,0,1]
    v_pk_fma_f32 v[74:75], v[114:115], v[124:125], v[74:75] op_sel:[0,0,0] op_sel_hi:[1,0,1]
    v_pk_mul_f32 v[72:73], v[72:73], v[124:125] op_sel:[0,1] op_sel_hi:[1,1]
    v_pk_mul_f32 v[74:75], v[74:75], v[124:125] op_sel:[0,1] op_sel_hi:[1,1]
    v_cvt_pk_bf16_f32 v160, v72, v73
    v_cvt_pk_bf16_f32 v161, v74, v75
    v_pk_fma_f32 v[88:89], v[116:117], v[124:125], v[88:89] op_sel:[0,0,0] op_sel_hi:[1,0,1]
    v_pk_fma_f32 v[90:91], v[118:119], v[124:125], v[90:91] op_sel:[0,0,0] op_sel_hi:[1,0,1]
    v_pk_mul_f32 v[88:89], v[88:89], v[124:125] op_sel:[0,1] op_sel_hi:[1,1]
    v_pk_mul_f32 v[90:91], v[90:91], v[124:125] op_sel:[0,1] op_sel_hi:[1,1]
    v_cvt_pk_bf16_f32 v162, v88, v89
    v_cvt_pk_bf16_f32 v163, v90, v91
    v_pk_max_i16 v160, v160, 0
    v_pk_max_i16 v161, v161, 0
    v_pk_max_i16 v162, v162, 0
    v_pk_max_i16 v163, v163, 0
    v_or_b32 v160, v200, v160
    v_or_b32 v161, v201, v161
    v_or_b32 v162, v202, v162
    v_or_b32 v163, v203, v163
    s_add_u32 s57, s50, 124928
    buffer_store_dwordx4 v[160:163], v240, s[12:15], s57 offen sc1
    v_pk_fma_f32 v[76:77], v[112:113], v[126:127], v[76:77] op_sel:[0,0,0] op_sel_hi:[1,0,1]
    v_pk_fma_f32 v[78:79], v[114:115], v[126:127], v[78:79] op_sel:[0,0,0] op_sel_hi:[1,0,1]
    v_pk_mul_f32 v[76:77], v[76:77], v[126:127] op_sel:[0,1] op_sel_hi:[1,1]
    v_pk_mul_f32 v[78:79], v[78:79], v[126:127] op_sel:[0,1] op_sel_hi:[1,1]
    v_cvt_pk_bf16_f32 v164, v76, v77
    v_cvt_pk_bf16_f32 v165, v78, v79
    v_pk_fma_f32 v[92:93], v[116:117], v[126:127], v[92:93] op_sel:[0,0,0] op_sel_hi:[1,0,1]
    v_pk_fma_f32 v[94:95], v[118:119], v[126:127], v[94:95] op_sel:[0,0,0] op_sel_hi:[1,0,1]
    v_pk_mul_f32 v[92:93], v[92:93], v[126:127] op_sel:[0,1] op_sel_hi:[1,1]
    v_pk_mul_f32 v[94:95], v[94:95], v[126:127] op_sel:[0,1] op_sel_hi:[1,1]
    v_cvt_pk_bf16_f32 v166, v92, v93
    v_cvt_pk_bf16_f32 v167, v94, v95
    v_pk_max_i16 v164, v164, 0
    v_pk_max_i16 v165, v165, 0
    v_pk_max_i16 v166, v166, 0
    v_pk_max_i16 v167, v167, 0
    v_or_b32 v164, v200, v164
    v_or_b32 v165, v201, v165
    v_or_b32 v166, v202, v166
    v_or_b32 v167, v203, v167
    s_add_u32 s57, s50, 185344
    buffer_store_dwordx4 v[164:167], v240, s[12:15], s57 offen sc1
L_nopair_24:
    s_barrier
    buffer_load_dwordx4 v[132:135], v241, s[12:15], s71 offen offset:0 sc1
    buffer_load_dwordx4 v[136:139], v241, s[12:15], s72 offen offset:0 sc1
    buffer_load_dwordx4 v[140:143], v241, s[12:15], s73 offen offset:0 sc1
    buffer_load_dwordx4 v[128:131], v241, s[12:15], s70 offen offset:0 sc1
    buffer_load_dwordx4 v[148:151], v241, s[12:15], s71 offen offset:1024 sc1
    buffer_load_dwordx4 v[152:155], v241, s[12:15], s72 offen offset:1024 sc1
    buffer_load_dwordx4 v[156:159], v241, s[12:15], s73 offen offset:1024 sc1
    buffer_load_dwordx4 v[144:147], v241, s[12:15], s70 offen offset:1024 sc1
    s_waitcnt vmcnt(4)
    v_xor_b32 v132, v200, v132
    v_xor_b32 v133, v201, v133
    v_xor_b32 v134, v202, v134
    v_or3_b32 v248, v132, v133, v134
    v_xor_b32 v135, v203, v135
    v_xor_b32 v136, v200, v136
    v_or3_b32 v248, v248, v135, v136
    v_xor_b32 v137, v201, v137
    v_xor_b32 v138, v202, v138
    v_or3_b32 v248, v248, v137, v138
    v_xor_b32 v139, v203, v139
    v_xor_b32 v140, v200, v140
    v_or3_b32 v248, v248, v139, v140
    v_xor_b32 v141, v201, v141
    v_xor_b32 v142, v202, v142
    v_or3_b32 v248, v248, v141, v142
    v_xor_b32 v143, v203, v143
    v_xor_b32 v128, v200, v128
    v_or3_b32 v248, v248, v143, v128
    v_xor_b32 v129, v201, v129
    v_xor_b32 v130, v202, v130
    v_or3_b32 v248, v248, v129, v130
    v_xor_b32 v131, v203, v131
    v_bitop3_b32 v248, v248, v131, s3 bitop3:0xa8
    v_cmp_ne_u32 vcc, 0, v248
    s_cbranch_vccnz L_slow_m_0_1
L_back_m_0_1:
    v_mfma_f32_16x16x32_bf16 v[16:19], a[0:3], v[132:135], 0
    v_add_u32 v244, 0x1000, v241
    v_mfma_f32_16x16x32_bf16 v[20:23], a[4:7], v[132:135], 0
    buffer_load_dwordx4 v[164:167], v242, s[12:15], s71 offen offset:0 sc1
    v_mfma_f32_16x16x32_bf16 v[24:27], a[8:11], v[132:135], 0
    s_waitcnt vmcnt(1)
    v_xor_b32 v148, v200, v148
    v_mfma_f32_16x16x32_bf16 v[28:31], a[12:15], v[132:135], 0
    buffer_load_dwordx4 v[168:171], v242, s[12:15], s72 offen offset:0 sc1
    v_mfma_f32_16x16x32_bf16 v[44:47], a[12:15], v[136:139], 0
    v_xor_b32 v149, v201, v149
    v_xor_b32 v150, v202, v150
    v_mfma_f32_16x16x32_bf16 v[40:43], a[8:11], v[136:139], 0
    v_add_u32 v246, 0x1000, v242
    buffer_load_dwordx4 v[172:175], v242, s[12:15], s73 offen offset:0 sc1
    v_mfma_f32_16x16x32_bf16 v[36:39], a[4:7], v[136:139], 0
    v_or3_b32 v248, v148, v149, v150
    v_xor_b32 v151, v203, v151
    v_mfma_f32_16x16x32_bf16 v[32:35], a[0:3], v[136:139], 0
    buffer_load_dwordx4 v[160:163], v242, s[12:15], s70 offen offset:0 sc1
    v_mfma_f32_16x16x32_bf16 v[48:51], a[0:3], v[140:143], 0
    v_xor_b32 v152, v200, v152
    v_or3_b32 v248, v248, v151, v152
    v_mfma_f32_16x16x32_bf16 v[52:55], a[4:7], v[140:143], 0
    s_cmp_eq_u32 s32, 3
    s_cselect_b32 s54, 0, 1024
    v_add_u32 v245, s54, v244
    buffer_load_dwordx4 v[180:183], v242, s[12:15], s71 offen offset:1024 sc1
    v_mfma_f32_16x16x32_bf16 v[56:59], a[8:11], v[140:143], 0
    v_xor_b32 v153, v201, v153
    v_xor_b32 v154, v202, v154
    v_mfma_f32_16x16x32_bf16 v[60:63], a[12:15], v[140:143], 0
    buffer_load_dwordx4 v[184:187], v242, s[12:15], s72 offen offset:1024 sc1
    v_mfma_f32_16x16x32_bf16 v[12:15], a[12:15], v[128:131], 0
    v_or3_b32 v248, v248, v153, v154
    v_xor_b32 v155, v203, v155
    v_mfma_f32_16x16x32_bf16 v[8:11], a[8:11], v[128:131], 0
    s_lshl_b32 s54, s32, 12
    s_add_u32 s54, s54, 44032
    v_add_u32 v243, s54, v240
    buffer_load_dwordx4 v[188:191], v242, s[12:15], s73 offen offset:1024 sc1
    v_mfma_f32_16x16x32_bf16 v[4:7], a[4:7], v[128:131], 0
    v_xor_b32 v156, v200, v156
    v_or3_b32 v248, v248, v155, v156
    v_xor_b32 v157, v201, v157
    v_xor_b32 v158, v202, v158
    v_or3_b32 v248, v248, v157, v158
    v_xor_b32 v159, v203, v159
    v_xor_b32 v144, v200, v144
    v_or3_b32 v248, v248, v159, v144
    v_xor_b32 v145, v201, v145
    v_xor_b32 v146, v202, v146
    v_or3_b32 v248, v248, v145, v146
    v_xor_b32 v147, v203, v147
    v_bitop3_b32 v248, v248, v147, s3 bitop3:0xa8
    v_cmp_ne_u32 vcc, 0, v248
    s_cbranch_vccnz L_slow_m_1_1
L_back_m_1_1:
    v_mfma_f32_16x16x32_bf16 v[0:3], a[0:3], v[128:131], 0
    buffer_load_dwordx4 v[176:179], v242, s[12:15], s70 offen offset:1024 sc1
    v_mfma_f32_16x16x32_bf16 v[16:19], a[16:19], v[148:151], v[16:19]
    ds_read_b64_tr_b16 a[114:115], v228 offset:0
    v_mfma_f32_16x16x32_bf16 v[20:23], a[20:23], v[148:151], v[20:23]
    buffer_load_dwordx4 v[68:71], v241, s[12:15], s71 offen offset:2048 sc1
    v_mfma_f32_16x16x32_bf16 v[24:27], a[24:27], v[148:151], v[24:27]
    s_waitcnt vmcnt(5)
    v_xor_b32 v164, v200, v164
    v_mfma_f32_16x16x32_bf16 v[28:31], a[28:31], v[148:151], v[28:31]
    buffer_load_dwordx4 v[72:75], v241, s[12:15], s72 offen offset:2048 sc1
    v_mfma_f32_16x16x32_bf16 v[44:47], a[28:31], v[152:155], v[44:47]
    v_xor_b32 v165, v201, v165
    v_xor_b32 v166, v202, v166
    v_mfma_f32_16x16x32_bf16 v[40:43], a[24:27], v[152:155], v[40:43]
    buffer_load_dwordx4 v[76:79], v241, s[12:15], s73 offen offset:2048 sc1
    v_mfma_f32_16x16x32_bf16 v[36:39], a[20:23], v[152:155], v[36:39]
    v_or3_b32 v248, v164, v165, v166
    v_xor_b32 v167, v203, v167
    ds_read_b64_tr_b16 a[118:119], v229 offset:0
    v_mfma_f32_16x16x32_bf16 v[32:35], a[16:19], v[152:155], v[32:35]
    buffer_load_dwordx4 v[64:67], v241, s[12:15], s70 offen offset:2048 sc1
    v_mfma_f32_16x16x32_bf16 v[48:51], a[16:19], v[156:159], v[48:51]
    v_xor_b32 v168, v200, v168
    v_or3_b32 v248, v248, v167, v168
    v_mfma_f32_16x16x32_bf16 v[52:55], a[20:23], v[156:159], v[52:55]
    buffer_load_dwordx4 v[84:87], v241, s[12:15], s71 offen offset:3072 sc1
    v_mfma_f32_16x16x32_bf16 v[56:59], a[24:27], v[156:159], v[56:59]
    v_xor_b32 v169, v201, v169
    v_xor_b32 v170, v202, v170
    v_mfma_f32_16x16x32_bf16 v[60:63], a[28:31], v[156:159], v[60:63]
    ds_read_b64_tr_b16 a[122:123], v230 offset:0
    buffer_load_dwordx4 v[88:91], v241, s[12:15], s72 offen offset:3072 sc1
    v_mfma_f32_16x16x32_bf16 v[12:15], a[28:31], v[144:147], v[12:15]
    v_or3_b32 v248, v248, v169, v170
    v_xor_b32 v171, v203, v171
    v_mfma_f32_16x16x32_bf16 v[8:11], a[24:27], v[144:147], v[8:11]
    buffer_load_dwordx4 v[92:95], v241, s[12:15], s73 offen offset:3072 sc1
    v_mfma_f32_16x16x32_bf16 v[4:7], a[20:23], v[144:147], v[4:7]
    v_xor_b32 v172, v200, v172
    v_or3_b32 v248, v248, v171, v172
    v_xor_b32 v173, v201, v173
    v_xor_b32 v174, v202, v174
    v_or3_b32 v248, v248, v173, v174
    v_xor_b32 v175, v203, v175
    v_xor_b32 v160, v200, v160
    v_or3_b32 v248, v248, v175, v160
    v_xor_b32 v161, v201, v161
    v_xor_b32 v162, v202, v162
    v_or3_b32 v248, v248, v161, v162
    v_xor_b32 v163, v203, v163
    v_bitop3_b32 v248, v248, v163, s3 bitop3:0xa8
    v_cmp_ne_u32 vcc, 0, v248
    s_cbranch_vccnz L_slow_m_2_1
L_back_m_2_1:
    v_mfma_f32_16x16x32_bf16 v[0:3], a[16:19], v[144:147], v[0:3]
    buffer_load_dwordx4 v[80:83], v241, s[12:15], s70 offen offset:3072 sc1
    v_mfma_f32_16x16x32_bf16 v[16:19], a[32:35], v[164:167], v[16:19]
    ds_read_b64_tr_b16 a[126:127], v231 offset:0
    v_mfma_f32_16x16x32_bf16 v[20:23], a[36:39], v[164:167], v[20:23]
    buffer_load_dwordx4 v[100:103], v242, s[12:15], s71 offen offset:2048 sc1
    v_mfma_f32_16x16x32_bf16 v[24:27], a[40:43], v[164:167], v[24:27]
    s_waitcnt vmcnt(9)
    v_xor_b32 v180, v200, v180
    v_mfma_f32_16x16x32_bf16 v[28:31], a[44:47], v[164:167], v[28:31]
    buffer_load_dwordx4 v[104:107], v242, s[12:15], s72 offen offset:2048 sc1
    v_mfma_f32_16x16x32_bf16 v[44:47], a[44:47], v[168:171], v[44:47]
    v_xor_b32 v181, v201, v181
    v_xor_b32 v182, v202, v182
    v_mfma_f32_16x16x32_bf16 v[40:43], a[40:43], v[168:171], v[40:43]
    ds_read_b64_tr_b16 a[128:129], v228 offset:2048
    buffer_load_dwordx4 v[108:111], v242, s[12:15], s73 offen offset:2048 sc1
    v_mfma_f32_16x16x32_bf16 v[36:39], a[36:39], v[168:171], v[36:39]
    v_or3_b32 v248, v180, v181, v182
    v_xor_b32 v183, v203, v183
    v_mfma_f32_16x16x32_bf16 v[32:35], a[32:35], v[168:171], v[32:35]
    buffer_load_dwordx4 v[96:99], v242, s[12:15], s70 offen offset:2048 sc1
    v_mfma_f32_16x16x32_bf16 v[48:51], a[32:35], v[172:175], v[48:51]
    v_xor_b32 v184, v200, v184
    v_or3_b32 v248, v248, v183, v184
    ds_read_b64_tr_b16 a[132:133], v229 offset:2048
    v_mfma_f32_16x16x32_bf16 v[52:55], a[36:39], v[172:175], v[52:55]
    buffer_load_dwordx4 v[116:119], v242, s[12:15], s71 offen offset:3072 sc1
    v_mfma_f32_16x16x32_bf16 v[56:59], a[40:43], v[172:175], v[56:59]
    v_xor_b32 v185, v201, v185
    v_xor_b32 v186, v202, v186
    v_mfma_f32_16x16x32_bf16 v[60:63], a[44:47], v[172:175], v[60:63]
    buffer_load_dwordx4 v[120:123], v242, s[12:15], s72 offen offset:3072 sc1
    v_mfma_f32_16x16x32_bf16 v[12:15], a[44:47], v[160:163], v[12:15]
    v_or3_b32 v248, v248, v185, v186
    v_xor_b32 v187, v203, v187
    ds_read_b64_tr_b16 a[136:137], v230 offset:2048
    v_mfma_f32_16x16x32_bf16 v[8:11], a[40:43], v[160:163], v[8:11]
    buffer_load_dwordx4 v[124:127], v242, s[12:15], s73 offen offset:3072 sc1
    v_mfma_f32_16x16x32_bf16 v[4:7], a[36:39], v[160:163], v[4:7]
    v_xor_b32 v188, v200, v188
    v_or3_b32 v248, v248, v187, v188
    v_xor_b32 v189, v201, v189
    v_xor_b32 v190, v202, v190
    v_or3_b32 v248, v248, v189, v190
    v_xor_b32 v191, v203, v191
    v_xor_b32 v176, v200, v176
    v_or3_b32 v248, v248, v191, v176
    v_xor_b32 v177, v201, v177
    v_xor_b32 v178, v202, v178
    v_or3_b32 v248, v248, v177, v178
    v_xor_b32 v179, v203, v179
    v_bitop3_b32 v248, v248, v179, s3 bitop3:0xa8
    v_cmp_ne_u32 vcc, 0, v248
    s_cbranch_vccnz L_slow_m_3_1
L_back_m_3_1:
    v_mfma_f32_16x16x32_bf16 v[0:3], a[32:35], v[160:163], v[0:3]
    buffer_load_dwordx4 v[112:115], v242, s[12:15], s70 offen offset:3072 sc1
    v_mfma_f32_16x16x32_bf16 v[16:19], a[48:51], v[180:183], v[16:19]
    ds_read_b64_tr_b16 a[140:141], v231 offset:2048
    v_mfma_f32_16x16x32_bf16 v[20:23], a[52:55], v[180:183], v[20:23]
    s_waitcnt vmcnt(12)
    v_xor_b32 v68, v200, v68
    v_mfma_f32_16x16x32_bf16 v[24:27], a[56:59], v[180:183], v[24:27]
    buffer_load_dwordx4 v[132:135], v244, s[12:15], s71 offen offset:0 sc1
    v_mfma_f32_16x16x32_bf16 v[28:31], a[60:63], v[180:183], v[28:31]
    v_xor_b32 v69, v201, v69
    v_xor_b32 v70, v202, v70
    v_mfma_f32_16x16x32_bf16 v[44:47], a[60:63], v[184:187], v[44:47]
    v_or3_b32 v248, v68, v69, v70
    v_xor_b32 v71, v203, v71
    v_mfma_f32_16x16x32_bf16 v[40:43], a[56:59], v[184:187], v[40:43]
    v_xor_b32 v72, v200, v72
    v_or3_b32 v248, v248, v71, v72
    v_mfma_f32_16x16x32_bf16 v[36:39], a[52:55], v[184:187], v[36:39]
    ds_read_b64_tr_b16 a[130:131], v228 offset:4096
    buffer_load_dwordx4 v[136:139], v244, s[12:15], s72 offen offset:0 sc1
    v_mfma_f32_16x16x32_bf16 v[32:35], a[48:51], v[184:187], v[32:35]
    v_xor_b32 v73, v201, v73
    v_xor_b32 v74, v202, v74
    v_mfma_f32_16x16x32_bf16 v[48:51], a[48:51], v[188:191], v[48:51]
    v_or3_b32 v248, v248, v73, v74
    v_xor_b32 v75, v203, v75
    v_mfma_f32_16x16x32_bf16 v[52:55], a[52:55], v[188:191], v[52:55]
    v_xor_b32 v76, v200, v76
    v_or3_b32 v248, v248, v75, v76
    v_mfma_f32_16x16x32_bf16 v[56:59], a[56:59], v[188:191], v[56:59]
    buffer_load_dwordx4 v[140:143], v244, s[12:15], s73 offen offset:0 sc1
    v_mfma_f32_16x16x32_bf16 v[60:63], a[60:63], v[188:191], v[60:63]
    v_xor_b32 v77, v201, v77
    v_xor_b32 v78, v202, v78
    ds_read_b64_tr_b16 a[134:135], v229 offset:4096
    v_mfma_f32_16x16x32_bf16 v[12:15], a[60:63], v[176:179], v[12:15]
    v_or3_b32 v248, v248, v77, v78
    v_xor_b32 v79, v203, v79
    v_mfma_f32_16x16x32_bf16 v[8:11], a[56:59], v[176:179], v[8:11]
    v_xor_b32 v64, v200, v64
    v_or3_b32 v248, v248, v79, v64
    v_xor_b32 v65, v201, v65
    v_xor_b32 v66, v202, v66
    v_or3_b32 v248, v248, v65, v66
    v_xor_b32 v67, v203, v67
    v_mfma_f32_16x16x32_bf16 v[4:7], a[52:55], v[176:179], v[4:7]
    v_bitop3_b32 v248, v248, v67, s3 bitop3:0xa8
    buffer_load_dwordx4 v[128:131], v244, s[12:15], s70 offen offset:0 sc1
    v_mfma_f32_16x16x32_bf16 v[0:3], a[48:51], v[176:179], v[0:3]
    v_cmp_ne_u32 vcc, 0, v248
    s_cbranch_vccnz L_slow_m_4_1
L_back_m_4_1:
    v_mfma_f32_16x16x32_bf16 v[16:19], a[64:67], v[68:71], v[16:19]
    ds_read_b64_tr_b16 a[138:139], v230 offset:4096
    v_mfma_f32_16x16x32_bf16 v[20:23], a[68:71], v[68:71], v[20:23]
    s_waitcnt vmcnt(12)
    v_xor_b32 v84, v200, v84
    v_mfma_f32_16x16x32_bf16 v[24:27], a[72:75], v[68:71], v[24:27]
    buffer_load_dwordx4 v[148:151], v245, s[12:15], s71 offen offset:0 sc1
    v_mfma_f32_16x16x32_bf16 v[28:31], a[76:79], v[68:71], v[28:31]
    v_xor_b32 v85, v201, v85
    v_xor_b32 v86, v202, v86
    v_mfma_f32_16x16x32_bf16 v[44:47], a[76:79], v[72:75], v[44:47]
    v_or3_b32 v248, v84, v85, v86
    v_xor_b32 v87, v203, v87
    v_mfma_f32_16x16x32_bf16 v[40:43], a[72:75], v[72:75], v[40:43]
    v_xor_b32 v88, v200, v88
    v_or3_b32 v248, v248, v87, v88
    v_mfma_f32_16x16x32_bf16 v[36:39], a[68:71], v[72:75], v[36:39]
    ds_read_b64_tr_b16 a[142:143], v231 offset:4096
    buffer_load_dwordx4 v[152:155], v245, s[12:15], s72 offen offset:0 sc1
    v_mfma_f32_16x16x32_bf16 v[32:35], a[64:67], v[72:75], v[32:35]
    v_xor_b32 v89, v201, v89
    v_xor_b32 v90, v202, v90
    v_mfma_f32_16x16x32_bf16 v[48:51], a[64:67], v[76:79], v[48:51]
    v_or3_b32 v248, v248, v89, v90
    v_xor_b32 v91, v203, v91
    v_mfma_f32_16x16x32_bf16 v[52:55], a[68:71], v[76:79], v[52:55]
    v_xor_b32 v92, v200, v92
    v_or3_b32 v248, v248, v91, v92
    v_mfma_f32_16x16x32_bf16 v[56:59], a[72:75], v[76:79], v[56:59]
    buffer_load_dwordx4 v[156:159], v245, s[12:15], s73 offen offset:0 sc1
    v_mfma_f32_16x16x32_bf16 v[60:63], a[76:79], v[76:79], v[60:63]
    v_xor_b32 v93, v201, v93
    v_xor_b32 v94, v202, v94
    ds_read_b64_tr_b16 a[144:145], v228 offset:6144
    v_mfma_f32_16x16x32_bf16 v[12:15], a[76:79], v[64:67], v[12:15]
    v_or3_b32 v248, v248, v93, v94
    v_xor_b32 v95, v203, v95
    v_mfma_f32_16x16x32_bf16 v[8:11], a[72:75], v[64:67], v[8:11]
    v_xor_b32 v80, v200, v80
    v_or3_b32 v248, v248, v95, v80
    v_xor_b32 v81, v201, v81
    v_xor_b32 v82, v202, v82
    v_or3_b32 v248, v248, v81, v82
    v_xor_b32 v83, v203, v83
    v_mfma_f32_16x16x32_bf16 v[4:7], a[68:71], v[64:67], v[4:7]
    v_bitop3_b32 v248, v248, v83, s3 bitop3:0xa8
    buffer_load_dwordx4 v[144:147], v245, s[12:15], s70 offen offset:0 sc1
    v_mfma_f32_16x16x32_bf16 v[0:3], a[64:67], v[64:67], v[0:3]
    v_cmp_ne_u32 vcc, 0, v248
    s_cbranch_vccnz L_slow_m_5_1
L_back_m_5_1:
    s_waitcnt lgkmcnt(15)
    v_mfma_f32_16x16x32_bf16 v[16:19], a[80:83], v[84:87], v[16:19]
    ds_read_b64_tr_b16 a[148:149], v229 offset:6144
    s_waitcnt lgkmcnt(15)
    v_mfma_f32_16x16x32_bf16 v[20:23], a[84:87], v[84:87], v[20:23]
    s_waitcnt vmcnt(12)
    v_xor_b32 v100, v200, v100
    s_waitcnt lgkmcnt(15)
    v_mfma_f32_16x16x32_bf16 v[24:27], a[88:91], v[84:87], v[24:27]
    buffer_load_dwordx4 v[164:167], v246, s[12:15], s71 offen offset:0 sc1
    s_waitcnt lgkmcnt(15)
    v_mfma_f32_16x16x32_bf16 v[28:31], a[92:95], v[84:87], v[28:31]
    v_xor_b32 v101, v201, v101
    v_xor_b32 v102, v202, v102
    v_mfma_f32_16x16x32_bf16 v[44:47], a[92:95], v[88:91], v[44:47]
    v_or3_b32 v248, v100, v101, v102
    v_xor_b32 v103, v203, v103
    v_mfma_f32_16x16x32_bf16 v[40:43], a[88:91], v[88:91], v[40:43]
    v_xor_b32 v104, v200, v104
    v_or3_b32 v248, v248, v103, v104
    v_mfma_f32_16x16x32_bf16 v[36:39], a[84:87], v[88:91], v[36:39]
    ds_read_b64_tr_b16 a[152:153], v230 offset:6144
    buffer_load_dwordx4 v[168:171], v246, s[12:15], s72 offen offset:0 sc1
    v_mfma_f32_16x16x32_bf16 v[32:35], a[80:83], v[88:91], v[32:35]
    v_xor_b32 v105, v201, v105
    v_xor_b32 v106, v202, v106
    v_mfma_f32_16x16x32_bf16 v[48:51], a[80:83], v[92:95], v[48:51]
    v_or3_b32 v248, v248, v105, v106
    v_xor_b32 v107, v203, v107
    v_mfma_f32_16x16x32_bf16 v[52:55], a[84:87], v[92:95], v[52:55]
    v_xor_b32 v108, v200, v108
    v_or3_b32 v248, v248, v107, v108
    v_mfma_f32_16x16x32_bf16 v[56:59], a[88:91], v[92:95], v[56:59]
    buffer_load_dwordx4 v[172:175], v246, s[12:15], s73 offen offset:0 sc1
    v_mfma_f32_16x16x32_bf16 v[60:63], a[92:95], v[92:95], v[60:63]
    v_xor_b32 v109, v201, v109
    v_xor_b32 v110, v202, v110
    ds_read_b64_tr_b16 a[156:157], v231 offset:6144
    v_mfma_f32_16x16x32_bf16 v[12:15], a[92:95], v[80:83], v[12:15]
    v_or3_b32 v248, v248, v109, v110
    v_xor_b32 v111, v203, v111
    v_mfma_f32_16x16x32_bf16 v[8:11], a[88:91], v[80:83], v[8:11]
    v_xor_b32 v96, v200, v96
    v_or3_b32 v248, v248, v111, v96
    v_xor_b32 v97, v201, v97
    v_xor_b32 v98, v202, v98
    v_or3_b32 v248, v248, v97, v98
    v_xor_b32 v99, v203, v99
    v_mfma_f32_16x16x32_bf16 v[4:7], a[84:87], v[80:83], v[4:7]
    v_bitop3_b32 v248, v248, v99, s3 bitop3:0xa8
    buffer_load_dwordx4 v[160:163], v246, s[12:15], s70 offen offset:0 sc1
    v_mfma_f32_16x16x32_bf16 v[0:3], a[80:83], v[80:83], v[0:3]
    v_cmp_ne_u32 vcc, 0, v248
    s_cbranch_vccnz L_slow_m_6_1
L_back_m_6_1:
    s_waitcnt lgkmcnt(15)
    v_mfma_f32_16x16x32_bf16 v[16:19], a[96:99], v[100:103], v[16:19]
    v_cmp_ne_u32 vcc, s58, v222
    v_cmp_ne_u32 s[54:55], s59, v223
    s_or_b64 vcc, vcc, s[54:55]
    s_cmp_eq_u64 vcc, 0
    s_cbranch_scc1 L_flg_ok_25
    s_mov_b32 s75, 0
L_flg_again_26:
    s_sleep 1
    buffer_load_dwordx2 v[222:223], v236, s[12:15], s41 offen sc1
    s_waitcnt vmcnt(0)
    v_cmp_ne_u32 vcc, s58, v222
    v_cmp_ne_u32 s[54:55], s59, v223
    s_or_b64 vcc, vcc, s[54:55]
    s_cmp_eq_u64 vcc, 0
    s_cbranch_scc1 L_flg_ok_25
    s_add_u32 s75, s75, 1
    s_cmp_lt_u32 s75, 4000
    s_cbranch_scc1 L_flg_again_26
L_flg_ok_25:
    s_waitcnt lgkmcnt(15)
    v_mfma_f32_16x16x32_bf16 v[20:23], a[100:103], v[100:103], v[20:23]
    s_waitcnt vmcnt(12)
    v_xor_b32 v116, v200, v116
    s_waitcnt lgkmcnt(15)
    v_mfma_f32_16x16x32_bf16 v[24:27], a[104:107], v[100:103], v[24:27]
    ds_read_b64_tr_b16 a[146:147], v228 offset:8192
    buffer_load_dwordx4 v[180:183], v243, s[12:15], s71 offen offset:0 sc1
    s_waitcnt lgkmcnt(15)
    v_mfma_f32_16x16x32_bf16 v[28:31], a[108:111], v[100:103], v[28:31]
    v_xor_b32 v117, v201, v117
    v_xor_b32 v118, v202, v118
    v_mfma_f32_16x16x32_bf16 v[44:47], a[108:111], v[104:107], v[44:47]
    v_or3_b32 v248, v116, v117, v118
    v_xor_b32 v119, v203, v119
    v_mfma_f32_16x16x32_bf16 v[40:43], a[104:107], v[104:107], v[40:43]
    v_xor_b32 v120, v200, v120
    v_or3_b32 v248, v248, v119, v120
    v_mfma_f32_16x16x32_bf16 v[36:39], a[100:103], v[104:107], v[36:39]
    ds_read_b64_tr_b16 a[150:151], v229 offset:8192
    buffer_load_dwordx4 v[184:187], v243, s[12:15], s72 offen offset:0 sc1
    v_mfma_f32_16x16x32_bf16 v[32:35], a[96:99], v[104:107], v[32:35]
    v_xor_b32 v121, v201, v121
    v_xor_b32 v122, v202, v122
    v_mfma_f32_16x16x32_bf16 v[48:51], a[96:99], v[108:111], v[48:51]
    v_or3_b32 v248, v248, v121, v122
    v_xor_b32 v123, v203, v123
    v_mfma_f32_16x16x32_bf16 v[52:55], a[100:103], v[108:111], v[52:55]
    v_xor_b32 v124, v200, v124
    v_or3_b32 v248, v248, v123, v124
    v_mfma_f32_16x16x32_bf16 v[56:59], a[104:107], v[108:111], v[56:59]
    buffer_load_dwordx4 v[188:191], v243, s[12:15], s73 offen offset:0 sc1
    v_mfma_f32_16x16x32_bf16 v[60:63], a[108:111], v[108:111], v[60:63]
    v_xor_b32 v125, v201, v125
    v_xor_b32 v126, v202, v126
    ds_read_b64_tr_b16 a[154:155], v230 offset:8192
    v_mfma_f32_16x16x32_bf16 v[12:15], a[108:111], v[96:99], v[12:15]
    v_or3_b32 v248, v248, v125, v126
    v_xor_b32 v127, v203, v127
    v_mfma_f32_16x16x32_bf16 v[8:11], a[104:107], v[96:99], v[8:11]
    v_xor_b32 v112, v200, v112
L_pad_m4:
    s_cmp_eq_u32 s99, 1
    s_cbranch_scc1 L_padback_m
    v_or3_b32 v248, v248, v127, v112
    v_xor_b32 v113, v201, v113
    v_xor_b32 v114, v202, v114
    v_or3_b32 v248, v248, v113, v114
    v_xor_b32 v115, v203, v115
    v_mfma_f32_16x16x32_bf16 v[4:7], a[100:103], v[96:99], v[4:7]
    v_bitop3_b32 v248, v248, v115, s3 bitop3:0xa8
    buffer_load_dwordx4 v[176:179], v243, s[12:15], s70 offen offset:0 sc1
    v_mfma_f32_16x16x32_bf16 v[0:3], a[96:99], v[96:99], v[0:3]
    v_cmp_ne_u32 vcc, 0, v248
    s_cbranch_vccnz L_slow_m_7_1
L_back_m_7_1:
    s_waitcnt lgkmcnt(15)
    v_mfma_f32_16x16x32_bf16 v[16:19], a[112:115], v[116:119], v[16:19]
    ds_read_b64_tr_b16 a[158:159], v231 offset:8192
    s_waitcnt lgkmcnt(15)
    v_mfma_f32_16x16x32_bf16 v[20:23], a[116:119], v[116:119], v[20:23]
    s_waitcnt vmcnt(12)
    v_xor_b32 v132, v200, v132
    s_waitcnt lgkmcnt(15)
    v_mfma_f32_16x16x32_bf16 v[24:27], a[120:123], v[116:119], v[24:27]
    buffer_load_dwordx4 v[68:71], v243, s[12:15], s71 offen offset:1024 sc1
    s_waitcnt lgkmcnt(15)
    v_mfma_f32_16x16x32_bf16 v[28:31], a[124:127], v[116:119], v[28:31]
    v_xor_b32 v133, v201, v133
    v_xor_b32 v134, v202, v134
    v_mfma_f32_16x16x32_bf16 v[44:47], a[124:127], v[120:123], v[44:47]
    v_or3_b32 v248, v132, v133, v134
    v_xor_b32 v135, v203, v135
    v_mfma_f32_16x16x32_bf16 v[40:43], a[120:123], v[120:123], v[40:43]
    v_xor_b32 v136, v200, v136
    v_or3_b32 v248, v248, v135, v136
    v_mfma_f32_16x16x32_bf16 v[36:39], a[116:119], v[120:123], v[36:39]
    ds_read_b64_tr_b16 a[160:161], v232 offset:0
    buffer_load_dwordx4 v[84:87], v243, s[12:15], s71 offen offset:2048 sc1
    v_mfma_f32_16x16x32_bf16 v[32:35], a[112:115], v[120:123], v[32:35]
    v_xor_b32 v137, v201, v137
    v_xor_b32 v138, v202, v138
    v_mfma_f32_16x16x32_bf16 v[48:51], a[112:115], v[124:127], v[48:51]
    v_or3_b32 v248, v248, v137, v138
    v_xor_b32 v139, v203, v139
    v_mfma_f32_16x16x32_bf16 v[52:55], a[116:119], v[124:127], v[52:55]
    v_xor_b32 v140, v200, v140
    v_or3_b32 v248, v248, v139, v140
    v_mfma_f32_16x16x32_bf16 v[56:59], a[120:123], v[124:127], v[56:59]
    buffer_load_dwordx4 v[100:103], v243, s[12:15], s71 offen offset:3072 sc1
    v_mfma_f32_16x16x32_bf16 v[60:63], a[124:127], v[124:127], v[60:63]
    v_xor_b32 v141, v201, v141
    v_xor_b32 v142, v202, v142
    ds_read_b64_tr_b16 a[164:165], v233 offset:0
    v_mfma_f32_16x16x32_bf16 v[12:15], a[124:127], v[112:115], v[12:15]
    v_or3_b32 v248, v248, v141, v142
    v_xor_b32 v143, v203, v143
    v_mfma_f32_16x16x32_bf16 v[8:11], a[120:123], v[112:115], v[8:11]
    v_xor_b32 v128, v200, v128
    v_or3_b32 v248, v248, v143, v128
    v_xor_b32 v129, v201, v129
    v_xor_b32 v130, v202, v130
    v_or3_b32 v248, v248, v129, v130
    v_xor_b32 v131, v203, v131
    v_mfma_f32_16x16x32_bf16 v[4:7], a[116:119], v[112:115], v[4:7]
    v_bitop3_b32 v248, v248, v131, s3 bitop3:0xa8
    buffer_load_dwordx4 v[72:75], v243, s[12:15], s72 offen offset:1024 sc1
    v_mfma_f32_16x16x32_bf16 v[0:3], a[112:115], v[112:115], v[0:3]
    v_cmp_ne_u32 vcc, 0, v248
    s_cbranch_vccnz L_slow_m_8_1
L_back_m_8_1:
    s_waitcnt lgkmcnt(13)
    v_mfma_f32_16x16x32_bf16 v[16:19], a[128:131], v[132:135], v[16:19]
    ds_read_b64_tr_b16 a[168:169], v234 offset:0
    s_waitcnt lgkmcnt(13)
    v_mfma_f32_16x16x32_bf16 v[20:23], a[132:135], v[132:135], v[20:23]
    s_waitcnt vmcnt(12)
    v_xor_b32 v148, v200, v148
    s_waitcnt lgkmcnt(12)
    v_mfma_f32_16x16x32_bf16 v[24:27], a[136:139], v[132:135], v[24:27]
    buffer_load_dwordx4 v[88:91], v243, s[12:15], s72 offen offset:2048 sc1
    s_waitcnt lgkmcnt(11)
    v_mfma_f32_16x16x32_bf16 v[28:31], a[140:143], v[132:135], v[28:31]
    v_xor_b32 v149, v201, v149
    v_xor_b32 v150, v202, v150
    v_mfma_f32_16x16x32_bf16 v[44:47], a[140:143], v[136:139], v[44:47]
    v_or3_b32 v248, v148, v149, v150
    v_xor_b32 v151, v203, v151
    v_mfma_f32_16x16x32_bf16 v[40:43], a[136:139], v[136:139], v[40:43]
    v_xor_b32 v152, v200, v152
    v_or3_b32 v248, v248, v151, v152
    v_mfma_f32_16x16x32_bf16 v[36:39], a[132:135], v[136:139], v[36:39]
    ds_read_b64_tr_b16 a[172:173], v235 offset:0
    buffer_load_dwordx4 v[104:107], v243, s[12:15], s72 offen offset:3072 sc1
    v_mfma_f32_16x16x32_bf16 v[32:35], a[128:131], v[136:139], v[32:35]
    v_xor_b32 v153, v201, v153
    v_xor_b32 v154, v202, v154
    v_mfma_f32_16x16x32_bf16 v[48:51], a[128:131], v[140:143], v[48:51]
    v_or3_b32 v248, v248, v153, v154
    v_xor_b32 v155, v203, v155
    v_mfma_f32_16x16x32_bf16 v[52:55], a[132:135], v[140:143], v[52:55]
    v_xor_b32 v156, v200, v156
    v_or3_b32 v248, v248, v155, v156
    v_mfma_f32_16x16x32_bf16 v[56:59], a[136:139], v[140:143], v[56:59]
    buffer_load_dwordx4 v[76:79], v243, s[12:15], s73 offen offset:1024 sc1
    v_mfma_f32_16x16x32_bf16 v[60:63], a[140:143], v[140:143], v[60:63]
    v_xor_b32 v157, v201, v157
    v_xor_b32 v158, v202, v158
    ds_read_b64_tr_b16 a[162:163], v232 offset:2048
    v_mfma_f32_16x16x32_bf16 v[12:15], a[140:143], v[128:131], v[12:15]
    v_or3_b32 v248, v248, v157, v158
    v_xor_b32 v159, v203, v159
    v_mfma_f32_16x16x32_bf16 v[8:11], a[136:139], v[128:131], v[8:11]
    v_xor_b32 v144, v200, v144
    v_or3_b32 v248, v248, v159, v144
    v_xor_b32 v145, v201, v145
    v_xor_b32 v146, v202, v146
    v_or3_b32 v248, v248, v145, v146
    v_xor_b32 v147, v203, v147
    v_mfma_f32_16x16x32_bf16 v[4:7], a[132:135], v[128:131], v[4:7]
    v_bitop3_b32 v248, v248, v147, s3 bitop3:0xa8
    buffer_load_dwordx4 v[92:95], v243, s[12:15], s73 offen offset:2048 sc1
    v_mfma_f32_16x16x32_bf16 v[0:3], a[128:131], v[128:131], v[0:3]
    v_cmp_ne_u32 vcc, 0, v248
    s_cbranch_vccnz L_slow_m_9_1
L_back_m_9_1:
    s_waitcnt lgkmcnt(8)
    v_mfma_f32_16x16x32_bf16 v[16:19], a[144:147], v[148:151], v[16:19]
    ds_read_b64_tr_b16 a[166:167], v233 offset:2048
    s_waitcnt lgkmcnt(8)
    v_mfma_f32_16x16x32_bf16 v[20:23], a[148:151], v[148:151], v[20:23]
    s_waitcnt vmcnt(12)
    v_xor_b32 v164, v200, v164
    s_waitcnt lgkmcnt(7)
    v_mfma_f32_16x16x32_bf16 v[24:27], a[152:155], v[148:151], v[24:27]
    buffer_load_dwordx4 v[108:111], v243, s[12:15], s73 offen offset:3072 sc1
    s_waitcnt lgkmcnt(6)
    v_mfma_f32_16x16x32_bf16 v[28:31], a[156:159], v[148:151], v[28:31]
    v_xor_b32 v165, v201, v165
    v_xor_b32 v166, v202, v166
    v_mfma_f32_16x16x32_bf16 v[44:47], a[156:159], v[152:155], v[44:47]
    v_or3_b32 v248, v164, v165, v166
    v_xor_b32 v167, v203, v167
    v_mfma_f32_16x16x32_bf16 v[40:43], a[152:155], v[152:155], v[40:43]
    v_xor_b32 v168, v200, v168
    v_or3_b32 v248, v248, v167, v168
    v_mfma_f32_16x16x32_bf16 v[36:39], a[148:151], v[152:155], v[36:39]
    ds_read_b64_tr_b16 a[170:171], v234 offset:2048
    buffer_load_dwordx4 v[64:67], v243, s[12:15], s70 offen offset:1024 sc1
    v_mfma_f32_16x16x32_bf16 v[32:35], a[144:147], v[152:155], v[32:35]
    v_xor_b32 v169, v201, v169
    v_xor_b32 v170, v202, v170
    v_mfma_f32_16x16x32_bf16 v[48:51], a[144:147], v[156:159], v[48:51]
    v_or3_b32 v248, v248, v169, v170
    v_xor_b32 v171, v203, v171
    v_mfma_f32_16x16x32_bf16 v[52:55], a[148:151], v[156:159], v[52:55]
    v_xor_b32 v172, v200, v172
    v_or3_b32 v248, v248, v171, v172
    v_mfma_f32_16x16x32_bf16 v[56:59], a[152:155], v[156:159], v[56:59]
    buffer_load_dwordx4 v[80:83], v243, s[12:15], s70 offen offset:2048 sc1
    v_mfma_f32_16x16x32_bf16 v[60:63], a[156:159], v[156:159], v[60:63]
    v_xor_b32 v173, v201, v173
    v_xor_b32 v174, v202, v174
    ds_read_b64_tr_b16 a[174:175], v235 offset:2048
    v_mfma_f32_16x16x32_bf16 v[12:15], a[156:159], v[144:147], v[12:15]
    v_or3_b32 v248, v248, v173, v174
    v_xor_b32 v175, v203, v175
    v_mfma_f32_16x16x32_bf16 v[8:11], a[152:155], v[144:147], v[8:11]
    v_xor_b32 v160, v200, v160
    v_or3_b32 v248, v248, v175, v160
    v_xor_b32 v161, v201, v161
    v_xor_b32 v162, v202, v162
    v_or3_b32 v248, v248, v161, v162
    v_xor_b32 v163, v203, v163
    v_mfma_f32_16x16x32_bf16 v[4:7], a[148:151], v[144:147], v[4:7]
    v_bitop3_b32 v248, v248, v163, s3 bitop3:0xa8
    buffer_load_dwordx4 v[96:99], v243, s[12:15], s70 offen offset:3072 sc1
    v_mfma_f32_16x16x32_bf16 v[0:3], a[144:147], v[144:147], v[0:3]
    v_cmp_ne_u32 vcc, 0, v248
    s_cbranch_vccnz L_slow_m_10_1
L_back_m_10_1:
    s_waitcnt lgkmcnt(3)
    v_mfma_f32_16x16x32_bf16 v[16:19], a[160:163], v[164:167], v[16:19]
    ds_read_b64_tr_b16 a[176:177], v232 offset:4096
    s_waitcnt lgkmcnt(3)
    v_mfma_f32_16x16x32_bf16 v[20:23], a[164:167], v[164:167], v[20:23]
    s_waitcnt lgkmcnt(2)
    v_mfma_f32_16x16x32_bf16 v[24:27], a[168:171], v[164:167], v[24:27]
    buffer_load_dwordx2 v[192:193], v226, s[4:7], 0 offen offset:0
    s_waitcnt lgkmcnt(1)
    v_mfma_f32_16x16x32_bf16 v[28:31], a[172:175], v[164:167], v[28:31]
    ds_read_b64_tr_b16 a[180:181], v233 offset:4096
    v_mfma_f32_16x16x32_bf16 v[44:47], a[172:175], v[168:171], v[44:47]
    ds_read_b64_tr_b16 a[184:185], v234 offset:4096
    v_mfma_f32_16x16x32_bf16 v[40:43], a[168:171], v[168:171], v[40:43]
    ds_read_b64_tr_b16 a[188:189], v235 offset:4096
    v_mfma_f32_16x16x32_bf16 v[36:39], a[164:167], v[168:171], v[36:39]
    buffer_load_dwordx2 v[194:195], v226, s[4:7], 0 offen offset:32
    v_mfma_f32_16x16x32_bf16 v[32:35], a[160:163], v[168:171], v[32:35]
    ds_read_b64_tr_b16 a[178:179], v232 offset:6144
    v_mfma_f32_16x16x32_bf16 v[48:51], a[160:163], v[172:175], v[48:51]
    v_mfma_f32_16x16x32_bf16 v[52:55], a[164:167], v[172:175], v[52:55]
    ds_read_b64_tr_b16 a[182:183], v233 offset:6144
    v_mfma_f32_16x16x32_bf16 v[56:59], a[168:171], v[172:175], v[56:59]
    buffer_load_dwordx2 v[196:197], v226, s[4:7], 0 offen offset:64
    v_mfma_f32_16x16x32_bf16 v[60:63], a[172:175], v[172:175], v[60:63]
    s_waitcnt vmcnt(15)
    v_max3_u32 v248, v180, v184, v188
    v_mfma_f32_16x16x32_bf16 v[12:15], a[172:175], v[160:163], v[12:15]
    ds_read_b64_tr_b16 a[186:187], v234 offset:6144
    v_mfma_f32_16x16x32_bf16 v[8:11], a[168:171], v[160:163], v[8:11]
    v_max_u32 v248, v248, v176
    ds_read_b64_tr_b16 a[190:191], v235 offset:6144
    v_mfma_f32_16x16x32_bf16 v[4:7], a[164:167], v[160:163], v[4:7]
    buffer_load_dwordx2 v[198:199], v226, s[4:7], 0 offen offset:96
    v_mfma_f32_16x16x32_bf16 v[0:3], a[160:163], v[160:163], v[0:3]
    v_cmp_eq_u32 vcc, -1, v248
    s_cbranch_vccnz L_slow_m_11_1
L_back_m_11_1:
    s_waitcnt lgkmcnt(3)
    v_mfma_f32_16x16x32_bf16 v[16:19], a[176:179], v[180:183], v[16:19]
    s_waitcnt lgkmcnt(2)
    v_mfma_f32_16x16x32_bf16 v[20:23], a[180:183], v[180:183], v[20:23]
    ds_read_b64_tr_b16 a[192:193], v232 offset:8192
    s_waitcnt lgkmcnt(2)
    v_mfma_f32_16x16x32_bf16 v[24:27], a[184:187], v[180:183], v[24:27]
    s_waitcnt lgkmcnt(1)
    v_mfma_f32_16x16x32_bf16 v[28:31], a[188:191], v[180:183], v[28:31]
    v_add_u32 v253, s44, v240
    v_mfma_f32_16x16x32_bf16 v[44:47], a[188:191], v[184:187], v[44:47]
    v_mfma_f32_16x16x32_bf16 v[40:43], a[184:187], v[184:187], v[40:43]
    ds_read_b64_tr_b16 a[196:197], v233 offset:8192
    v_mfma_f32_16x16x32_bf16 v[36:39], a[180:183], v[184:187], v[36:39]
    v_mfma_f32_16x16x32_bf16 v[32:35], a[176:179], v[184:187], v[32:35]
    v_mfma_f32_16x16x32_bf16 v[48:51], a[176:179], v[188:191], v[48:51]
    ds_read_b64_tr_b16 a[200:201], v234 offset:8192
    v_mfma_f32_16x16x32_bf16 v[52:55], a[180:183], v[188:191], v[52:55]
    v_mfma_f32_16x16x32_bf16 v[56:59], a[184:187], v[188:191], v[56:59]
    s_waitcnt vmcnt(13)
    v_mfma_f32_16x16x32_bf16 v[60:63], a[188:191], v[188:191], v[60:63]
    v_add_u32 v254, 86016, v253
    v_mfma_f32_16x16x32_bf16 v[12:15], a[188:191], v[176:179], v[12:15]
    v_max3_u32 v248, v68, v84, v100
    ds_read_b64_tr_b16 a[204:205], v235 offset:8192
    v_mfma_f32_16x16x32_bf16 v[8:11], a[184:187], v[176:179], v[8:11]
    v_mfma_f32_16x16x32_bf16 v[4:7], a[180:183], v[176:179], v[4:7]
    v_cmp_eq_u32 vcc, -1, v248
    s_cbranch_vccnz L_slow_m_12_1
L_back_m_12_1:
    v_mfma_f32_16x16x32_bf16 v[0:3], a[176:179], v[176:179], v[0:3]
    s_waitcnt lgkmcnt(3)
    v_mfma_f32_16x16x32_bf16 v[16:19], a[192:195], v[68:71], v[16:19]
    s_waitcnt lgkmcnt(2)
    v_mfma_f32_16x16x32_bf16 v[20:23], a[196:199], v[68:71], v[20:23]
    s_waitcnt lgkmcnt(1)
    v_mfma_f32_16x16x32_bf16 v[24:27], a[200:203], v[68:71], v[24:27]
    s_waitcnt lgkmcnt(0)
    v_mfma_f32_16x16x32_bf16 v[28:31], a[204:207], v[68:71], v[28:31]
    s_sub_u32 s54, s32, 1
    s_and_b32 s54, s54, 3
    s_mul_i32 s54, s54, 10752
    s_add_u32 s54, s54, 0
    v_add_u32 v249, s54, v240
    v_mfma_f32_16x16x32_bf16 v[16:19], a[208:211], v[84:87], v[16:19]
    v_mfma_f32_16x16x32_bf16 v[20:23], a[212:215], v[84:87], v[20:23]
    v_mfma_f32_16x16x32_bf16 v[24:27], a[216:219], v[84:87], v[24:27]
    v_mfma_f32_16x16x32_bf16 v[28:31], a[220:223], v[84:87], v[28:31]
    s_waitcnt vmcnt(10)
    v_mfma_f32_16x16x32_bf16 v[16:19], a[224:227], v[100:103], v[16:19]
    v_mfma_f32_16x16x32_bf16 v[20:23], a[228:231], v[100:103], v[20:23]
    v_max3_u32 v248, v72, v88, v104
    v_mfma_f32_16x16x32_bf16 v[24:27], a[232:235], v[100:103], v[24:27]
    v_mfma_f32_16x16x32_bf16 v[28:31], a[236:239], v[100:103], v[28:31]
    v_cmp_eq_u32 vcc, -1, v248
    s_cbranch_vccnz L_slow_m_12_2
L_back_m_12_2:
    v_mfma_f32_16x16x32_bf16 v[32:35], a[192:195], v[72:75], v[32:35]
    v_mfma_f32_16x16x32_bf16 v[36:39], a[196:199], v[72:75], v[36:39]
    v_mfma_f32_16x16x32_bf16 v[40:43], a[200:203], v[72:75], v[40:43]
    ds_write_b128 v253, v[16:19] offset:0
    v_mfma_f32_16x16x32_bf16 v[44:47], a[204:207], v[72:75], v[44:47]
    s_sub_u32 s54, s32, 2
    s_and_b32 s54, s54, 3
    s_mul_i32 s54, s54, 10752
    s_add_u32 s54, s54, 43008
    v_add_u32 v250, s54, v240
    v_mfma_f32_16x16x32_bf16 v[32:35], a[208:211], v[88:91], v[32:35]
    ds_write_b128 v253, v[20:23] offset:1024
    v_mfma_f32_16x16x32_bf16 v[36:39], a[212:215], v[88:91], v[36:39]
    v_mfma_f32_16x16x32_bf16 v[40:43], a[216:219], v[88:91], v[40:43]
    v_mfma_f32_16x16x32_bf16 v[44:47], a[220:223], v[88:91], v[44:47]
    s_waitcnt vmcnt(7)
    ds_write_b128 v253, v[24:27] offset:2048
    v_mfma_f32_16x16x32_bf16 v[32:35], a[224:227], v[104:107], v[32:35]
    v_mfma_f32_16x16x32_bf16 v[36:39], a[228:231], v[104:107], v[36:39]
    v_max3_u32 v248, v76, v92, v108
    ds_write_b128 v253, v[28:31] offset:3072
    v_mfma_f32_16x16x32_bf16 v[40:43], a[232:235], v[104:107], v[40:43]
    v_mfma_f32_16x16x32_bf16 v[44:47], a[236:239], v[104:107], v[44:47]
    v_cmp_eq_u32 vcc, -1, v248
    s_cbranch_vccnz L_slow_m_12_3
L_back_m_12_3:
    v_mfma_f32_16x16x32_bf16 v[48:51], a[192:195], v[76:79], v[48:51]
    v_mfma_f32_16x16x32_bf16 v[52:55], a[196:199], v[76:79], v[52:55]
    v_mfma_f32_16x16x32_bf16 v[56:59], a[200:203], v[76:79], v[56:59]
    ds_write_b128 v253, v[32:35] offset:43008
    v_mfma_f32_16x16x32_bf16 v[60:63], a[204:207], v[76:79], v[60:63]
    s_sub_u32 s54, s32, 3
    s_and_b32 s54, s54, 3
    s_mul_i32 s54, s54, 10752
    s_add_u32 s54, s54, 86016
    v_add_u32 v251, s54, v240
    v_mfma_f32_16x16x32_bf16 v[48:51], a[208:211], v[92:95], v[48:51]
    ds_write_b128 v253, v[36:39] offset:44032
    v_mfma_f32_16x16x32_bf16 v[52:55], a[212:215], v[92:95], v[52:55]
    v_mfma_f32_16x16x32_bf16 v[56:59], a[216:219], v[92:95], v[56:59]
    v_mfma_f32_16x16x32_bf16 v[60:63], a[220:223], v[92:95], v[60:63]
    s_waitcnt vmcnt(4)
    ds_write_b128 v253, v[40:43] offset:45056
    v_mfma_f32_16x16x32_bf16 v[48:51], a[224:227], v[108:111], v[48:51]
    v_mfma_f32_16x16x32_bf16 v[52:55], a[228:231], v[108:111], v[52:55]
    v_max3_u32 v248, v64, v80, v96
    ds_write_b128 v253, v[44:47] offset:46080
    v_mfma_f32_16x16x32_bf16 v[56:59], a[232:235], v[108:111], v[56:59]
    v_mfma_f32_16x16x32_bf16 v[60:63], a[236:239], v[108:111], v[60:63]
    v_cmp_eq_u32 vcc, -1, v248
    s_cbranch_vccnz L_slow_m_12_0
L_back_m_12_0:
    v_mfma_f32_16x16x32_bf16 v[0:3], a[192:195], v[64:67], v[0:3]
    s_waitcnt vmcnt(3)
    v_lshlrev_b32 v112, 16, v192
    v_mfma_f32_16x16x32_bf16 v[4:7], a[196:199], v[64:67], v[4:7]
    v_and_b32 v113, 0xffff0000, v192
    v_lshlrev_b32 v114, 16, v193
    v_mfma_f32_16x16x32_bf16 v[8:11], a[200:203], v[64:67], v[8:11]
    v_and_b32 v115, 0xffff0000, v193
    ds_write_b128 v254, v[48:51] offset:0
    v_mfma_f32_16x16x32_bf16 v[12:15], a[204:207], v[64:67], v[12:15]
    s_waitcnt vmcnt(2)
    v_lshlrev_b32 v116, 16, v194
    v_mfma_f32_16x16x32_bf16 v[0:3], a[208:211], v[80:83], v[0:3]
    v_and_b32 v117, 0xffff0000, v194
    ds_write_b128 v254, v[52:55] offset:1024
    v_mfma_f32_16x16x32_bf16 v[4:7], a[212:215], v[80:83], v[4:7]
    v_lshlrev_b32 v118, 16, v195
    v_and_b32 v119, 0xffff0000, v195
    v_mfma_f32_16x16x32_bf16 v[8:11], a[216:219], v[80:83], v[8:11]
    s_waitcnt vmcnt(1)
    v_lshlrev_b32 v120, 16, v196
    v_mfma_f32_16x16x32_bf16 v[12:15], a[220:223], v[80:83], v[12:15]
    v_and_b32 v121, 0xffff0000, v196
    ds_write_b128 v254, v[56:59] offset:2048
    v_mfma_f32_16x16x32_bf16 v[0:3], a[224:227], v[96:99], v[0:3]
    v_lshlrev_b32 v122, 16, v197
    v_and_b32 v123, 0xffff0000, v197
    v_mfma_f32_16x16x32_bf16 v[4:7], a[228:231], v[96:99], v[4:7]
    s_waitcnt vmcnt(0)
    v_lshlrev_b32 v124, 16, v198
    ds_write_b128 v254, v[60:63] offset:3072
    v_mfma_f32_16x16x32_bf16 v[8:11], a[232:235], v[96:99], v[8:11]
    v_and_b32 v125, 0xffff0000, v198
    v_lshlrev_b32 v126, 16, v199
    v_mfma_f32_16x16x32_bf16 v[12:15], a[236:239], v[96:99], v[12:15]
    v_and_b32 v127, 0xffff0000, v199
    v_pk_add_f32 v[0:1], v[0:1], v[112:113]
    v_pk_add_f32 v[2:3], v[2:3], v[114:115]
    v_pk_add_f32 v[4:5], v[4:5], v[116:117]
    v_pk_add_f32 v[6:7], v[6:7], v[118:119]
    v_pk_add_f32 v[8:9], v[8:9], v[120:121]
    v_pk_add_f32 v[10:11], v[10:11], v[122:123]
    s_nop 0
    v_pk_add_f32 v[12:13], v[12:13], v[124:125]
    v_pk_add_f32 v[14:15], v[14:15], v[126:127]
    s_waitcnt lgkmcnt(0)
    s_barrier
    ds_read_b128 v[64:67], v249 offset:0
    ds_read_b128 v[68:71], v249 offset:1024
    ds_read_b128 v[72:75], v249 offset:2048
    ds_read_b128 v[76:79], v249 offset:3072
    ds_read_b128 v[80:83], v250 offset:0
    ds_read_b128 v[84:87], v250 offset:1024
    ds_read_b128 v[88:91], v250 offset:2048
    ds_read_b128 v[92:95], v250 offset:3072
    ds_read_b128 v[96:99], v251 offset:0
    ds_read_b128 v[100:103], v251 offset:1024
    ds_read_b128 v[104:107], v251 offset:2048
    ds_read_b128 v[108:111], v251 offset:3072
    s_waitcnt lgkmcnt(11)
    v_pk_add_f32 v[0:1], v[0:1], v[64:65]
    v_pk_add_f32 v[2:3], v[2:3], v[66:67]
    s_waitcnt lgkmcnt(10)
    v_pk_add_f32 v[4:5], v[4:5], v[68:69]
    v_pk_add_f32 v[6:7], v[6:7], v[70:71]
    s_waitcnt lgkmcnt(9)
    v_pk_add_f32 v[8:9], v[8:9], v[72:73]
    v_pk_add_f32 v[10:11], v[10:11], v[74:75]
    s_waitcnt lgkmcnt(8)
    v_pk_add_f32 v[12:13], v[12:13], v[76:77]
    v_pk_add_f32 v[14:15], v[14:15], v[78:79]
    s_waitcnt lgkmcnt(7)
    v_pk_add_f32 v[0:1], v[0:1], v[80:81]
    v_pk_add_f32 v[2:3], v[2:3], v[82:83]
    s_waitcnt lgkmcnt(6)
    v_pk_add_f32 v[4:5], v[4:5], v[84:85]
    v_pk_add_f32 v[6:7], v[6:7], v[86:87]
    s_waitcnt lgkmcnt(5)
    v_pk_add_f32 v[8:9], v[8:9], v[88:89]
    v_pk_add_f32 v[10:11], v[10:11], v[90:91]
    s_waitcnt lgkmcnt(4)
    v_pk_add_f32 v[12:13], v[12:13], v[92:93]
    v_pk_add_f32 v[14:15], v[14:15], v[94:95]
    s_waitcnt lgkmcnt(3)
    v_pk_add_f32 v[0:1], v[0:1], v[96:97]
    v_pk_add_f32 v[2:3], v[2:3], v[98:99]
    s_waitcnt lgkmcnt(2)
    v_pk_add_f32 v[4:5], v[4:5], v[100:101]
    v_pk_add_f32 v[6:7], v[6:7], v[102:103]
    s_waitcnt lgkmcnt(1)
    v_pk_add_f32 v[8:9], v[8:9], v[104:105]
    v_pk_add_f32 v[10:11], v[10:11], v[106:107]
    s_waitcnt lgkmcnt(0)
    v_pk_add_f32 v[12:13], v[12:13], v[108:109]
    v_pk_add_f32 v[14:15], v[14:15], v[110:111]
    v_cvt_pk_bf16_f32 v16, v0, v1
    v_cvt_pk_bf16_f32 v17, v2, v3
    v_cvt_pk_bf16_f32 v18, v4, v5
    v_cvt_pk_bf16_f32 v19, v6, v7
    v_cvt_pk_bf16_f32 v20, v8, v9
    v_cvt_pk_bf16_f32 v21, v10, v11
    v_cvt_pk_bf16_f32 v22, v12, v13
    v_cvt_pk_bf16_f32 v23, v14, v15
    v_permlane16_swap_b32 v16, v18
    v_permlane16_swap_b32 v17, v19
    v_permlane16_swap_b32 v20, v22
    v_permlane16_swap_b32 v21, v23
    buffer_store_dwordx4 v[16:19], v237, s[28:31], 0 offen offset:0
    buffer_store_dwordx4 v[20:23], v237, s[28:31], 0 offen offset:64
    s_endpgm
    s_nop 0
L_slow_m_0_1:
    s_mov_b32 s75, 0
L_slow_m_0_1_a:
    buffer_load_dwordx4 v[132:135], v241, s[12:15], s71 offen offset:0 sc1
    buffer_load_dwordx4 v[136:139], v241, s[12:15], s72 offen offset:0 sc1
    buffer_load_dwordx4 v[140:143], v241, s[12:15], s73 offen offset:0 sc1
    buffer_load_dwordx4 v[128:131], v241, s[12:15], s70 offen offset:0 sc1
    s_waitcnt vmcnt(0)
    v_xor_b32 v132, v200, v132
    v_xor_b32 v133, v201, v133
    v_xor_b32 v134, v202, v134
    v_or3_b32 v248, v132, v133, v134
    v_xor_b32 v135, v203, v135
    v_xor_b32 v136, v200, v136
    v_or3_b32 v248, v248, v135, v136
    v_xor_b32 v137, v201, v137
    v_xor_b32 v138, v202, v138
    v_or3_b32 v248, v248, v137, v138
    v_xor_b32 v139, v203, v139
    v_xor_b32 v140, v200, v140
    v_or3_b32 v248, v248, v139, v140
    v_xor_b32 v141, v201, v141
    v_xor_b32 v142, v202, v142
    v_or3_b32 v248, v248, v141, v142
    v_xor_b32 v143, v203, v143
    v_xor_b32 v128, v200, v128
    v_or3_b32 v248, v248, v143, v128
    v_xor_b32 v129, v201, v129
    v_xor_b32 v130, v202, v130
    v_or3_b32 v248, v248, v129, v130
    v_xor_b32 v131, v203, v131
    v_bitop3_b32 v248, v248, v131, s3 bitop3:0xa8
    v_cmp_ne_u32 vcc, 0, v248
    s_cbranch_vccz L_slow_m_0_1_r
    s_add_u32 s75, s75, 1
    s_cmp_lt_u32 s75, 4000
    s_cbranch_scc1 L_slow_m_0_1_a
L_slow_m_0_1_r:
    buffer_load_dwordx4 v[148:151], v241, s[12:15], s71 offen offset:1024 sc1
    buffer_load_dwordx4 v[152:155], v241, s[12:15], s72 offen offset:1024 sc1
    buffer_load_dwordx4 v[156:159], v241, s[12:15], s73 offen offset:1024 sc1
    buffer_load_dwordx4 v[144:147], v241, s[12:15], s70 offen offset:1024 sc1
    s_branch L_back_m_0_1
    s_nop 0
L_slow_m_1_1:
    s_mov_b32 s75, 0
L_slow_m_1_1_a:
    buffer_load_dwordx4 v[148:151], v241, s[12:15], s71 offen offset:1024 sc1
    buffer_load_dwordx4 v[152:155], v241, s[12:15], s72 offen offset:1024 sc1
    buffer_load_dwordx4 v[156:159], v241, s[12:15], s73 offen offset:1024 sc1
    buffer_load_dwordx4 v[144:147], v241, s[12:15], s70 offen offset:1024 sc1
    s_waitcnt vmcnt(0)
    v_xor_b32 v148, v200, v148
    v_xor_b32 v149, v201, v149
    v_xor_b32 v150, v202, v150
    v_or3_b32 v248, v148, v149, v150
    v_xor_b32 v151, v203, v151
    v_xor_b32 v152, v200, v152
    v_or3_b32 v248, v248, v151, v152
    v_xor_b32 v153, v201, v153
    v_xor_b32 v154, v202, v154
    v_or3_b32 v248, v248, v153, v154
    v_xor_b32 v155, v203, v155
    v_xor_b32 v156, v200, v156
    v_or3_b32 v248, v248, v155, v156
    v_xor_b32 v157, v201, v157
    v_xor_b32 v158, v202, v158
    v_or3_b32 v248, v248, v157, v158
    v_xor_b32 v159, v203, v159
    v_xor_b32 v144, v200, v144
    v_or3_b32 v248, v248, v159, v144
    v_xor_b32 v145, v201, v145
    v_xor_b32 v146, v202, v146
    v_or3_b32 v248, v248, v145, v146
    v_xor_b32 v147, v203, v147
    v_bitop3_b32 v248, v248, v147, s3 bitop3:0xa8
    v_cmp_ne_u32 vcc, 0, v248
    s_cbranch_vccz L_slow_m_1_1_r
    s_add_u32 s75, s75, 1
    s_cmp_lt_u32 s75, 4000
    s_cbranch_scc1 L_slow_m_1_1_a
L_slow_m_1_1_r:
    buffer_load_dwordx4 v[164:167], v242, s[12:15], s71 offen offset:0 sc1
    buffer_load_dwordx4 v[168:171], v242, s[12:15], s72 offen offset:0 sc1
    buffer_load_dwordx4 v[172:175], v242, s[12:15], s73 offen offset:0 sc1
    buffer_load_dwordx4 v[160:163], v242, s[12:15], s70 offen offset:0 sc1
    buffer_load_dwordx4 v[180:183], v242, s[12:15], s71 offen offset:1024 sc1
    buffer_load_dwordx4 v[184:187], v242, s[12:15], s72 offen offset:1024 sc1
    buffer_load_dwordx4 v[188:191], v242, s[12:15], s73 offen offset:1024 sc1
    s_branch L_back_m_1_1
    s_nop 0
L_slow_m_2_1:
    s_mov_b32 s75, 0
L_slow_m_2_1_a:
    buffer_load_dwordx4 v[164:167], v242, s[12:15], s71 offen offset:0 sc1
    buffer_load_dwordx4 v[168:171], v242, s[12:15], s72 offen offset:0 sc1
    buffer_load_dwordx4 v[172:175], v242, s[12:15], s73 offen offset:0 sc1
    buffer_load_dwordx4 v[160:163], v242, s[12:15], s70 offen offset:0 sc1
    s_waitcnt vmcnt(0)
    v_xor_b32 v164, v200, v164
    v_xor_b32 v165, v201, v165
    v_xor_b32 v166, v202, v166
    v_or3_b32 v248, v164, v165, v166
    v_xor_b32 v167, v203, v167
    v_xor_b32 v168, v200, v168
    v_or3_b32 v248, v248, v167, v168
    v_xor_b32 v169, v201, v169
    v_xor_b32 v170, v202, v170
    v_or3_b32 v248, v248, v169, v170
    v_xor_b32 v171, v203, v171
    v_xor_b32 v172, v200, v172
    v_or3_b32 v248, v248, v171, v172
    v_xor_b32 v173, v201, v173
    v_xor_b32 v174, v202, v174
    v_or3_b32 v248, v248, v173, v174
    v_xor_b32 v175, v203, v175
    v_xor_b32 v160, v200, v160
    v_or3_b32 v248, v248, v175, v160
    v_xor_b32 v161, v201, v161
    v_xor_b32 v162, v202, v162
    v_or3_b32 v248, v248, v161, v162
    v_xor_b32 v163, v203, v163
    v_bitop3_b32 v248, v248, v163, s3 bitop3:0xa8
    v_cmp_ne_u32 vcc, 0, v248
    s_cbranch_vccz L_slow_m_2_1_r
    s_add_u32 s75, s75, 1
    s_cmp_lt_u32 s75, 4000
    s_cbranch_scc1 L_slow_m_2_1_a
L_slow_m_2_1_r:
    buffer_load_dwordx4 v[180:183], v242, s[12:15], s71 offen offset:1024 sc1
    buffer_load_dwordx4 v[184:187], v242, s[12:15], s72 offen offset:1024 sc1
    buffer_load_dwordx4 v[188:191], v242, s[12:15], s73 offen offset:1024 sc1
    buffer_load_dwordx4 v[176:179], v242, s[12:15], s70 offen offset:1024 sc1
    buffer_load_dwordx4 v[68:71], v241, s[12:15], s71 offen offset:2048 sc1
    buffer_load_dwordx4 v[72:75], v241, s[12:15], s72 offen offset:2048 sc1
    buffer_load_dwordx4 v[76:79], v241, s[12:15], s73 offen offset:2048 sc1
    buffer_load_dwordx4 v[64:67], v241, s[12:15], s70 offen offset:2048 sc1
    buffer_load_dwordx4 v[84:87], v241, s[12:15], s71 offen offset:3072 sc1
    buffer_load_dwordx4 v[88:91], v241, s[12:15], s72 offen offset:3072 sc1
    buffer_load_dwordx4 v[92:95], v241, s[12:15], s73 offen offset:3072 sc1
    s_branch L_back_m_2_1
    s_nop 0
L_slow_m_3_1:
    s_mov_b32 s75, 0
L_slow_m_3_1_a:
    buffer_load_dwordx4 v[180:183], v242, s[12:15], s71 offen offset:1024 sc1
    buffer_load_dwordx4 v[184:187], v242, s[12:15], s72 offen offset:1024 sc1
    buffer_load_dwordx4 v[188:191], v242, s[12:15], s73 offen offset:1024 sc1
    buffer_load_dwordx4 v[176:179], v242, s[12:15], s70 offen offset:1024 sc1
    s_waitcnt vmcnt(0)
    v_xor_b32 v180, v200, v180
    v_xor_b32 v181, v201, v181
    v_xor_b32 v182, v202, v182
    v_or3_b32 v248, v180, v181, v182
    v_xor_b32 v183, v203, v183
    v_xor_b32 v184, v200, v184
    v_or3_b32 v248, v248, v183, v184
    v_xor_b32 v185, v201, v185
    v_xor_b32 v186, v202, v186
    v_or3_b32 v248, v248, v185, v186
    v_xor_b32 v187, v203, v187
    v_xor_b32 v188, v200, v188
    v_or3_b32 v248, v248, v187, v188
    v_xor_b32 v189, v201, v189
    v_xor_b32 v190, v202, v190
    v_or3_b32 v248, v248, v189, v190
    v_xor_b32 v191, v203, v191
    v_xor_b32 v176, v200, v176
    v_or3_b32 v248, v248, v191, v176
    v_xor_b32 v177, v201, v177
    v_xor_b32 v178, v202, v178
    v_or3_b32 v248, v248, v177, v178
    v_xor_b32 v179, v203, v179
    v_bitop3_b32 v248, v248, v179, s3 bitop3:0xa8
    v_cmp_ne_u32 vcc, 0, v248
    s_cbranch_vccz L_slow_m_3_1_r
    s_add_u32 s75, s75, 1
    s_cmp_lt_u32 s75, 4000
    s_cbranch_scc1 L_slow_m_3_1_a
L_slow_m_3_1_r:
    buffer_load_dwordx4 v[68:71], v241, s[12:15], s71 offen offset:2048 sc1
    buffer_load_dwordx4 v[72:75], v241, s[12:15], s72 offen offset:2048 sc1
    buffer_load_dwordx4 v[76:79], v241, s[12:15], s73 offen offset:2048 sc1
    buffer_load_dwordx4 v[64:67], v241, s[12:15], s70 offen offset:2048 sc1
    buffer_load_dwordx4 v[84:87], v241, s[12:15], s71 offen offset:3072 sc1
    buffer_load_dwordx4 v[88:91], v241, s[12:15], s72 offen offset:3072 sc1
    buffer_load_dwordx4 v[92:95], v241, s[12:15], s73 offen offset:3072 sc1
    buffer_load_dwordx4 v[80:83], v241, s[12:15], s70 offen offset:3072 sc1
    buffer_load_dwordx4 v[100:103], v242, s[12:15], s71 offen offset:2048 sc1
    buffer_load_dwordx4 v[104:107], v242, s[12:15], s72 offen offset:2048 sc1
    buffer_load_dwordx4 v[108:111], v242, s[12:15], s73 offen offset:2048 sc1
    buffer_load_dwordx4 v[96:99], v242, s[12:15], s70 offen offset:2048 sc1
    buffer_load_dwordx4 v[116:119], v242, s[12:15], s71 offen offset:3072 sc1
    buffer_load_dwordx4 v[120:123], v242, s[12:15], s72 offen offset:3072 sc1
    buffer_load_dwordx4 v[124:127], v242, s[12:15], s73 offen offset:3072 sc1
    s_branch L_back_m_3_1
    s_nop 0
L_slow_m_4_1:
    s_mov_b32 s75, 0
L_slow_m_4_1_a:
    buffer_load_dwordx4 v[68:71], v241, s[12:15], s71 offen offset:2048 sc1
    buffer_load_dwordx4 v[72:75], v241, s[12:15], s72 offen offset:2048 sc1
    buffer_load_dwordx4 v[76:79], v241, s[12:15], s73 offen offset:2048 sc1
    buffer_load_dwordx4 v[64:67], v241, s[12:15], s70 offen offset:2048 sc1
    s_waitcnt vmcnt(0)
    v_xor_b32 v68, v200, v68
    v_xor_b32 v69, v201, v69
    v_xor_b32 v70, v202, v70
    v_or3_b32 v248, v68, v69, v70
    v_xor_b32 v71, v203, v71
    v_xor_b32 v72, v200, v72
    v_or3_b32 v248, v248, v71, v72
    v_xor_b32 v73, v201, v73
    v_xor_b32 v74, v202, v74
    v_or3_b32 v248, v248, v73, v74
    v_xor_b32 v75, v203, v75
    v_xor_b32 v76, v200, v76
    v_or3_b32 v248, v248, v75, v76
    v_xor_b32 v77, v201, v77
    v_xor_b32 v78, v202, v78
    v_or3_b32 v248, v248, v77, v78
    v_xor_b32 v79, v203, v79
    v_xor_b32 v64, v200, v64
    v_or3_b32 v248, v248, v79, v64
    v_xor_b32 v65, v201, v65
    v_xor_b32 v66, v202, v66
    v_or3_b32 v248, v248, v65, v66
    v_xor_b32 v67, v203, v67
    v_bitop3_b32 v248, v248, v67, s3 bitop3:0xa8
    v_cmp_ne_u32 vcc, 0, v248
    s_cbranch_vccz L_slow_m_4_1_r
    s_add_u32 s75, s75, 1
    s_cmp_lt_u32 s75, 4000
    s_cbranch_scc1 L_slow_m_4_1_a
L_slow_m_4_1_r:
    buffer_load_dwordx4 v[84:87], v241, s[12:15], s71 offen offset:3072 sc1
    buffer_load_dwordx4 v[88:91], v241, s[12:15], s72 offen offset:3072 sc1
    buffer_load_dwordx4 v[92:95], v241, s[12:15], s73 offen offset:3072 sc1
    buffer_load_dwordx4 v[80:83], v241, s[12:15], s70 offen offset:3072 sc1
    buffer_load_dwordx4 v[100:103], v242, s[12:15], s71 offen offset:2048 sc1
    buffer_load_dwordx4 v[104:107], v242, s[12:15], s72 offen offset:2048 sc1
    buffer_load_dwordx4 v[108:111], v242, s[12:15], s73 offen offset:2048 sc1
    buffer_load_dwordx4 v[96:99], v242, s[12:15], s70 offen offset:2048 sc1
    buffer_load_dwordx4 v[116:119], v242, s[12:15], s71 offen offset:3072 sc1
    buffer_load_dwordx4 v[120:123], v242, s[12:15], s72 offen offset:3072 sc1
    buffer_load_dwordx4 v[124:127], v242, s[12:15], s73 offen offset:3072 sc1
    buffer_load_dwordx4 v[112:115], v242, s[12:15], s70 offen offset:3072 sc1
    buffer_load_dwordx4 v[132:135], v244, s[12:15], s71 offen offset:0 sc1
    buffer_load_dwordx4 v[136:139], v244, s[12:15], s72 offen offset:0 sc1
    buffer_load_dwordx4 v[140:143], v244, s[12:15], s73 offen offset:0 sc1
    buffer_load_dwordx4 v[128:131], v244, s[12:15], s70 offen offset:0 sc1
    s_branch L_back_m_4_1
    s_nop 0
L_slow_m_5_1:
    s_mov_b32 s75, 0
L_slow_m_5_1_a:
    buffer_load_dwordx4 v[84:87], v241, s[12:15], s71 offen offset:3072 sc1
    buffer_load_dwordx4 v[88:91], v241, s[12:15], s72 offen offset:3072 sc1
    buffer_load_dwordx4 v[92:95], v241, s[12:15], s73 offen offset:3072 sc1
    buffer_load_dwordx4 v[80:83], v241, s[12:15], s70 offen offset:3072 sc1
    s_waitcnt vmcnt(0)
    v_xor_b32 v84, v200, v84
    v_xor_b32 v85, v201, v85
    v_xor_b32 v86, v202, v86
    v_or3_b32 v248, v84, v85, v86
    v_xor_b32 v87, v203, v87
    v_xor_b32 v88, v200, v88
    v_or3_b32 v248, v248, v87, v88
    v_xor_b32 v89, v201, v89
    v_xor_b32 v90, v202, v90
    v_or3_b32 v248, v248, v89, v90
    v_xor_b32 v91, v203, v91
    v_xor_b32 v92, v200, v92
    v_or3_b32 v248, v248, v91, v92
    v_xor_b32 v93, v201, v93
    v_xor_b32 v94, v202, v94
    v_or3_b32 v248, v248, v93, v94
    v_xor_b32 v95, v203, v95
    v_xor_b32 v80, v200, v80
    v_or3_b32 v248, v248, v95, v80
    v_xor_b32 v81, v201, v81
    v_xor_b32 v82, v202, v82
    v_or3_b32 v248, v248, v81, v82
    v_xor_b32 v83, v203, v83
    v_bitop3_b32 v248, v248, v83, s3 bitop3:0xa8
    v_cmp_ne_u32 vcc, 0, v248
    s_cbranch_vccz L_slow_m_5_1_r
    s_add_u32 s75, s75, 1
    s_cmp_lt_u32 s75, 4000
    s_cbranch_scc1 L_slow_m_5_1_a
L_slow_m_5_1_r:
    buffer_load_dwordx4 v[100:103], v242, s[12:15], s71 offen offset:2048 sc1
    buffer_load_dwordx4 v[104:107], v242, s[12:15], s72 offen offset:2048 sc1
    buffer_load_dwordx4 v[108:111], v242, s[12:15], s73 offen offset:2048 sc1
    buffer_load_dwordx4 v[96:99], v242, s[12:15], s70 offen offset:2048 sc1
    buffer_load_dwordx4 v[116:119], v242, s[12:15], s71 offen offset:3072 sc1
    buffer_load_dwordx4 v[120:123], v242, s[12:15], s72 offen offset:3072 sc1
    buffer_load_dwordx4 v[124:127], v242, s[12:15], s73 offen offset:3072 sc1
    buffer_load_dwordx4 v[112:115], v242, s[12:15], s70 offen offset:3072 sc1
    buffer_load_dwordx4 v[132:135], v244, s[12:15], s71 offen offset:0 sc1
    buffer_load_dwordx4 v[136:139], v244, s[12:15], s72 offen offset:0 sc1
    buffer_load_dwordx4 v[140:143], v244, s[12:15], s73 offen offset:0 sc1
    buffer_load_dwordx4 v[128:131], v244, s[12:15], s70 offen offset:0 sc1
    buffer_load_dwordx4 v[148:151], v245, s[12:15], s71 offen offset:0 sc1
    buffer_load_dwordx4 v[152:155], v245, s[12:15], s72 offen offset:0 sc1
    buffer_load_dwordx4 v[156:159], v245, s[12:15], s73 offen offset:0 sc1
    buffer_load_dwordx4 v[144:147], v245, s[12:15], s70 offen offset:0 sc1
    s_branch L_back_m_5_1
    s_nop 0
L_slow_m_6_1:
    s_mov_b32 s75, 0
L_slow_m_6_1_a:
    buffer_load_dwordx4 v[100:103], v242, s[12:15], s71 offen offset:2048 sc1
    buffer_load_dwordx4 v[104:107], v242, s[12:15], s72 offen offset:2048 sc1
    buffer_load_dwordx4 v[108:111], v242, s[12:15], s73 offen offset:2048 sc1
    buffer_load_dwordx4 v[96:99], v242, s[12:15], s70 offen offset:2048 sc1
    s_waitcnt vmcnt(0)
    v_xor_b32 v100, v200, v100
    v_xor_b32 v101, v201, v101
    v_xor_b32 v102, v202, v102
    v_or3_b32 v248, v100, v101, v102
    v_xor_b32 v103, v203, v103
    v_xor_b32 v104, v200, v104
    v_or3_b32 v248, v248, v103, v104
    v_xor_b32 v105, v201, v105
    v_xor_b32 v106, v202, v106
    v_or3_b32 v248, v248, v105, v106
    v_xor_b32 v107, v203, v107
    v_xor_b32 v108, v200, v108
    v_or3_b32 v248, v248, v107, v108
    v_xor_b32 v109, v201, v109
    v_xor_b32 v110, v202, v110
    v_or3_b32 v248, v248, v109, v110
    v_xor_b32 v111, v203, v111
    v_xor_b32 v96, v200, v96
    v_or3_b32 v248, v248, v111, v96
    v_xor_b32 v97, v201, v97
    v_xor_b32 v98, v202, v98
    v_or3_b32 v248, v248, v97, v98
    v_xor_b32 v99, v203, v99
    v_bitop3_b32 v248, v248, v99, s3 bitop3:0xa8
    v_cmp_ne_u32 vcc, 0, v248
    s_cbranch_vccz L_slow_m_6_1_r
    s_add_u32 s75, s75, 1
    s_cmp_lt_u32 s75, 4000
    s_cbranch_scc1 L_slow_m_6_1_a
L_slow_m_6_1_r:
    buffer_load_dwordx4 v[116:119], v242, s[12:15], s71 offen offset:3072 sc1
    buffer_load_dwordx4 v[120:123], v242, s[12:15], s72 offen offset:3072 sc1
    buffer_load_dwordx4 v[124:127], v242, s[12:15], s73 offen offset:3072 sc1
    buffer_load_dwordx4 v[112:115], v242, s[12:15], s70 offen offset:3072 sc1
    buffer_load_dwordx4 v[132:135], v244, s[12:15], s71 offen offset:0 sc1
    buffer_load_dwordx4 v[136:139], v244, s[12:15], s72 offen offset:0 sc1
    buffer_load_dwordx4 v[140:143], v244, s[12:15], s73 offen offset:0 sc1
    buffer_load_dwordx4 v[128:131], v244, s[12:15], s70 offen offset:0 sc1
    buffer_load_dwordx4 v[148:151], v245, s[12:15], s71 offen offset:0 sc1
    buffer_load_dwordx4 v[152:155], v245, s[12:15], s72 offen offset:0 sc1
    buffer_load_dwordx4 v[156:159], v245, s[12:15], s73 offen offset:0 sc1
    buffer_load_dwordx4 v[144:147], v245, s[12:15], s70 offen offset:0 sc1
    buffer_load_dwordx4 v[164:167], v246, s[12:15], s71 offen offset:0 sc1
    buffer_load_dwordx4 v[168:171], v246, s[12:15], s72 offen offset:0 sc1
    buffer_load_dwordx4 v[172:175], v246, s[12:15], s73 offen offset:0 sc1
    buffer_load_dwordx4 v[160:163], v246, s[12:15], s70 offen offset:0 sc1
    s_branch L_back_m_6_1
    s_nop 0
L_slow_m_7_1:
    s_mov_b32 s75, 0
L_slow_m_7_1_a:
    buffer_load_dwordx4 v[116:119], v242, s[12:15], s71 offen offset:3072 sc1
    buffer_load_dwordx4 v[120:123], v242, s[12:15], s72 offen offset:3072 sc1
    buffer_load_dwordx4 v[124:127], v242, s[12:15], s73 offen offset:3072 sc1
    buffer_load_dwordx4 v[112:115], v242, s[12:15], s70 offen offset:3072 sc1
    s_waitcnt vmcnt(0)
    v_xor_b32 v116, v200, v116
    v_xor_b32 v117, v201, v117
    v_xor_b32 v118, v202, v118
    v_or3_b32 v248, v116, v117, v118
    v_xor_b32 v119, v203, v119
    v_xor_b32 v120, v200, v120
    v_or3_b32 v248, v248, v119, v120
    v_xor_b32 v121, v201, v121
    v_xor_b32 v122, v202, v122
    v_or3_b32 v248, v248, v121, v122
    v_xor_b32 v123, v203, v123
    v_xor_b32 v124, v200, v124
    v_or3_b32 v248, v248, v123, v124
    v_xor_b32 v125, v201, v125
    v_xor_b32 v126, v202, v126
    v_or3_b32 v248, v248, v125, v126
    v_xor_b32 v127, v203, v127
    v_xor_b32 v112, v200, v112
    v_or3_b32 v248, v248, v127, v112
    v_xor_b32 v113, v201, v113
    v_xor_b32 v114, v202, v114
    v_or3_b32 v248, v248, v113, v114
    v_xor_b32 v115, v203, v115
    v_bitop3_b32 v248, v248, v115, s3 bitop3:0xa8
    v_cmp_ne_u32 vcc, 0, v248
    s_cbranch_vccz L_slow_m_7_1_r
    s_add_u32 s75, s75, 1
    s_cmp_lt_u32 s75, 4000
    s_cbranch_scc1 L_slow_m_7_1_a
L_slow_m_7_1_r:
    buffer_load_dwordx4 v[132:135], v244, s[12:15], s71 offen offset:0 sc1
    buffer_load_dwordx4 v[136:139], v244, s[12:15], s72 offen offset:0 sc1
    buffer_load_dwordx4 v[140:143], v244, s[12:15], s73 offen offset:0 sc1
    buffer_load_dwordx4 v[128:131], v244, s[12:15], s70 offen offset:0 sc1
    buffer_load_dwordx4 v[148:151], v245, s[12:15], s71 offen offset:0 sc1
    buffer_load_dwordx4 v[152:155], v245, s[12:15], s72 offen offset:0 sc1
    buffer_load_dwordx4 v[156:159], v245, s[12:15], s73 offen offset:0 sc1
    buffer_load_dwordx4 v[144:147], v245, s[12:15], s70 offen offset:0 sc1
    buffer_load_dwordx4 v[164:167], v246, s[12:15], s71 offen offset:0 sc1
    buffer_load_dwordx4 v[168:171], v246, s[12:15], s72 offen offset:0 sc1
    buffer_load_dwordx4 v[172:175], v246, s[12:15], s73 offen offset:0 sc1
    buffer_load_dwordx4 v[160:163], v246, s[12:15], s70 offen offset:0 sc1
    buffer_load_dwordx4 v[180:183], v243, s[12:15], s71 offen offset:0 sc1
    buffer_load_dwordx4 v[184:187], v243, s[12:15], s72 offen offset:0 sc1
    buffer_load_dwordx4 v[188:191], v243, s[12:15], s73 offen offset:0 sc1
    buffer_load_dwordx4 v[176:179], v243, s[12:15], s70 offen offset:0 sc1
    s_branch L_back_m_7_1
    s_nop 0
L_slow_m_8_1:
    s_mov_b32 s75, 0
L_slow_m_8_1_a:
    buffer_load_dwordx4 v[132:135], v244, s[12:15], s71 offen offset:0 sc1
    buffer_load_dwordx4 v[136:139], v244, s[12:15], s72 offen offset:0 sc1
    buffer_load_dwordx4 v[140:143], v244, s[12:15], s73 offen offset:0 sc1
    buffer_load_dwordx4 v[128:131], v244, s[12:15], s70 offen offset:0 sc1
    s_waitcnt vmcnt(0)
    v_xor_b32 v132, v200, v132
    v_xor_b32 v133, v201, v133
    v_xor_b32 v134, v202, v134
    v_or3_b32 v248, v132, v133, v134
    v_xor_b32 v135, v203, v135
    v_xor_b32 v136, v200, v136
    v_or3_b32 v248, v248, v135, v136
    v_xor_b32 v137, v201, v137
    v_xor_b32 v138, v202, v138
    v_or3_b32 v248, v248, v137, v138
    v_xor_b32 v139, v203, v139
    v_xor_b32 v140, v200, v140
    v_or3_b32 v248, v248, v139, v140
    v_xor_b32 v141, v201, v141
    v_xor_b32 v142, v202, v142
    v_or3_b32 v248, v248, v141, v142
    v_xor_b32 v143, v203, v143
    v_xor_b32 v128, v200, v128
    v_or3_b32 v248, v248, v143, v128
    v_xor_b32 v129, v201, v129
    v_xor_b32 v130, v202, v130
    v_or3_b32 v248, v248, v129, v130
    v_xor_b32 v131, v203, v131
    v_bitop3_b32 v248, v248, v131, s3 bitop3:0xa8
    v_cmp_ne_u32 vcc, 0, v248
    s_cbranch_vccz L_slow_m_8_1_r
    s_add_u32 s75, s75, 1
    s_cmp_lt_u32 s75, 4000
    s_cbranch_scc1 L_slow_m_8_1_a
L_slow_m_8_1_r:
    buffer_load_dwordx4 v[148:151], v245, s[12:15], s71 offen offset:0 sc1
    buffer_load_dwordx4 v[152:155], v245, s[12:15], s72 offen offset:0 sc1
    buffer_load_dwordx4 v[156:159], v245, s[12:15], s73 offen offset:0 sc1
    buffer_load_dwordx4 v[144:147], v245, s[12:15], s70 offen offset:0 sc1
    buffer_load_dwordx4 v[164:167], v246, s[12:15], s71 offen offset:0 sc1
    buffer_load_dwordx4 v[168:171], v246, s[12:15], s72 offen offset:0 sc1
    buffer_load_dwordx4 v[172:175], v246, s[12:15], s73 offen offset:0 sc1
    buffer_load_dwordx4 v[160:163], v246, s[12:15], s70 offen offset:0 sc1
    buffer_load_dwordx4 v[180:183], v243, s[12:15], s71 offen offset:0 sc1
    buffer_load_dwordx4 v[184:187], v243, s[12:15], s72 offen offset:0 sc1
    buffer_load_dwordx4 v[188:191], v243, s[12:15], s73 offen offset:0 sc1
    buffer_load_dwordx4 v[176:179], v243, s[12:15], s70 offen offset:0 sc1
    buffer_load_dwordx4 v[68:71], v243, s[12:15], s71 offen offset:1024 sc1
    buffer_load_dwordx4 v[84:87], v243, s[12:15], s71 offen offset:2048 sc1
    buffer_load_dwordx4 v[100:103], v243, s[12:15], s71 offen offset:3072 sc1
    buffer_load_dwordx4 v[72:75], v243, s[12:15], s72 offen offset:1024 sc1
    s_branch L_back_m_8_1
    s_nop 0
L_slow_m_9_1:
    s_mov_b32 s75, 0
L_slow_m_9_1_a:
    buffer_load_dwordx4 v[148:151], v245, s[12:15], s71 offen offset:0 sc1
    buffer_load_dwordx4 v[152:155], v245, s[12:15], s72 offen offset:0 sc1
    buffer_load_dwordx4 v[156:159], v245, s[12:15], s73 offen offset:0 sc1
    buffer_load_dwordx4 v[144:147], v245, s[12:15], s70 offen offset:0 sc1
    s_waitcnt vmcnt(0)
    v_xor_b32 v148, v200, v148
    v_xor_b32 v149, v201, v149
    v_xor_b32 v150, v202, v150
    v_or3_b32 v248, v148, v149, v150
    v_xor_b32 v151, v203, v151
    v_xor_b32 v152, v200, v152
    v_or3_b32 v248, v248, v151, v152
    v_xor_b32 v153, v201, v153
    v_xor_b32 v154, v202, v154
    v_or3_b32 v248, v248, v153, v154
    v_xor_b32 v155, v203, v155
    v_xor_b32 v156, v200, v156
    v_or3_b32 v248, v248, v155, v156
    v_xor_b32 v157, v201, v157
    v_xor_b32 v158, v202, v158
    v_or3_b32 v248, v248, v157, v158
    v_xor_b32 v159, v203, v159
    v_xor_b32 v144, v200, v144
    v_or3_b32 v248, v248, v159, v144
    v_xor_b32 v145, v201, v145
    v_xor_b32 v146, v202, v146
    v_or3_b32 v248, v248, v145, v146
    v_xor_b32 v147, v203, v147
    v_bitop3_b32 v248, v248, v147, s3 bitop3:0xa8
    v_cmp_ne_u32 vcc, 0, v248
    s_cbranch_vccz L_slow_m_9_1_r
    s_add_u32 s75, s75, 1
    s_cmp_lt_u32 s75, 4000
    s_cbranch_scc1 L_slow_m_9_1_a
L_slow_m_9_1_r:
    buffer_load_dwordx4 v[164:167], v246, s[12:15], s71 offen offset:0 sc1
    buffer_load_dwordx4 v[168:171], v246, s[12:15], s72 offen offset:0 sc1
    buffer_load_dwordx4 v[172:175], v246, s[12:15], s73 offen offset:0 sc1
    buffer_load_dwordx4 v[160:163], v246, s[12:15], s70 offen offset:0 sc1
    buffer_load_dwordx4 v[180:183], v243, s[12:15], s71 offen offset:0 sc1
    buffer_load_dwordx4 v[184:187], v243, s[12:15], s72 offen offset:0 sc1
    buffer_load_dwordx4 v[188:191], v243, s[12:15], s73 offen offset:0 sc1
    buffer_load_dwordx4 v[176:179], v243, s[12:15], s70 offen offset:0 sc1
    buffer_load_dwordx4 v[68:71], v243, s[12:15], s71 offen offset:1024 sc1
    buffer_load_dwordx4 v[84:87], v243, s[12:15], s71 offen offset:2048 sc1
    buffer_load_dwordx4 v[100:103], v243, s[12:15], s71 offen offset:3072 sc1
    buffer_load_dwordx4 v[72:75], v243, s[12:15], s72 offen offset:1024 sc1
    buffer_load_dwordx4 v[88:91], v243, s[12:15], s72 offen offset:2048 sc1
    buffer_load_dwordx4 v[104:107], v243, s[12:15], s72 offen offset:3072 sc1
    buffer_load_dwordx4 v[76:79], v243, s[12:15], s73 offen offset:1024 sc1
    buffer_load_dwordx4 v[92:95], v243, s[12:15], s73 offen offset:2048 sc1
    s_branch L_back_m_9_1
    s_nop 0
L_slow_m_10_1:
    s_mov_b32 s75, 0
L_slow_m_10_1_a:
    buffer_load_dwordx4 v[164:167], v246, s[12:15], s71 offen offset:0 sc1
    buffer_load_dwordx4 v[168:171], v246, s[12:15], s72 offen offset:0 sc1
    buffer_load_dwordx4 v[172:175], v246, s[12:15], s73 offen offset:0 sc1
    buffer_load_dwordx4 v[160:163], v246, s[12:15], s70 offen offset:0 sc1
    s_waitcnt vmcnt(0)
    v_xor_b32 v164, v200, v164
    v_xor_b32 v165, v201, v165
    v_xor_b32 v166, v202, v166
    v_or3_b32 v248, v164, v165, v166
    v_xor_b32 v167, v203, v167
    v_xor_b32 v168, v200, v168
    v_or3_b32 v248, v248, v167, v168
    v_xor_b32 v169, v201, v169
    v_xor_b32 v170, v202, v170
    v_or3_b32 v248, v248, v169, v170
    v_xor_b32 v171, v203, v171
    v_xor_b32 v172, v200, v172
    v_or3_b32 v248, v248, v171, v172
    v_xor_b32 v173, v201, v173
    v_xor_b32 v174, v202, v174
    v_or3_b32 v248, v248, v173, v174
    v_xor_b32 v175, v203, v175
    v_xor_b32 v160, v200, v160
    v_or3_b32 v248, v248, v175, v160
    v_xor_b32 v161, v201, v161
    v_xor_b32 v162, v202, v162
    v_or3_b32 v248, v248, v161, v162
    v_xor_b32 v163, v203, v163
    v_bitop3_b32 v248, v248, v163, s3 bitop3:0xa8
    v_cmp_ne_u32 vcc, 0, v248
    s_cbranch_vccz L_slow_m_10_1_r
    s_add_u32 s75, s75, 1
    s_cmp_lt_u32 s75, 4000
    s_cbranch_scc1 L_slow_m_10_1_a
L_slow_m_10_1_r:
    buffer_load_dwordx4 v[180:183], v243, s[12:15], s71 offen offset:0 sc1
    buffer_load_dwordx4 v[184:187], v243, s[12:15], s72 offen offset:0 sc1
    buffer_load_dwordx4 v[188:191], v243, s[12:15], s73 offen offset:0 sc1
    buffer_load_dwordx4 v[176:179], v243, s[12:15], s70 offen offset:0 sc1
    buffer_load_dwordx4 v[68:71], v243, s[12:15], s71 offen offset:1024 sc1
    buffer_load_dwordx4 v[84:87], v243, s[12:15], s71 offen offset:2048 sc1
    buffer_load_dwordx4 v[100:103], v243, s[12:15], s71 offen offset:3072 sc1
    buffer_load_dwordx4 v[72:75], v243, s[12:15], s72 offen offset:1024 sc1
    buffer_load_dwordx4 v[88:91], v243, s[12:15], s72 offen offset:2048 sc1
    buffer_load_dwordx4 v[104:107], v243, s[12:15], s72 offen offset:3072 sc1
    buffer_load_dwordx4 v[76:79], v243, s[12:15], s73 offen offset:1024 sc1
    buffer_load_dwordx4 v[92:95], v243, s[12:15], s73 offen offset:2048 sc1
    buffer_load_dwordx4 v[108:111], v243, s[12:15], s73 offen offset:3072 sc1
    buffer_load_dwordx4 v[64:67], v243, s[12:15], s70 offen offset:1024 sc1
    buffer_load_dwordx4 v[80:83], v243, s[12:15], s70 offen offset:2048 sc1
    buffer_load_dwordx4 v[96:99], v243, s[12:15], s70 offen offset:3072 sc1
    s_branch L_back_m_10_1
    s_nop 0
L_slow_m_11_1:
    s_mov_b32 s75, 0
L_slow_m_11_1_a:
    buffer_load_dwordx4 v[180:183], v243, s[12:15], s71 offen offset:0 sc1
    buffer_load_dwordx4 v[184:187], v243, s[12:15], s72 offen offset:0 sc1
    buffer_load_dwordx4 v[188:191], v243, s[12:15], s73 offen offset:0 sc1
    buffer_load_dwordx4 v[176:179], v243, s[12:15], s70 offen offset:0 sc1
    s_waitcnt vmcnt(0)
    v_max3_u32 v248, v180, v184, v188
    v_max_u32 v248, v248, v176
    v_cmp_eq_u32 vcc, -1, v248
    s_cbranch_vccz L_slow_m_11_1_r
    s_add_u32 s75, s75, 1
    s_cmp_lt_u32 s75, 4000
    s_cbranch_scc1 L_slow_m_11_1_a
L_slow_m_11_1_r:
    buffer_load_dwordx4 v[68:71], v243, s[12:15], s71 offen offset:1024 sc1
    buffer_load_dwordx4 v[84:87], v243, s[12:15], s71 offen offset:2048 sc1
    buffer_load_dwordx4 v[100:103], v243, s[12:15], s71 offen offset:3072 sc1
    buffer_load_dwordx4 v[72:75], v243, s[12:15], s72 offen offset:1024 sc1
    buffer_load_dwordx4 v[88:91], v243, s[12:15], s72 offen offset:2048 sc1
    buffer_load_dwordx4 v[104:107], v243, s[12:15], s72 offen offset:3072 sc1
    buffer_load_dwordx4 v[76:79], v243, s[12:15], s73 offen offset:1024 sc1
    buffer_load_dwordx4 v[92:95], v243, s[12:15], s73 offen offset:2048 sc1
    buffer_load_dwordx4 v[108:111], v243, s[12:15], s73 offen offset:3072 sc1
    buffer_load_dwordx4 v[64:67], v243, s[12:15], s70 offen offset:1024 sc1
    buffer_load_dwordx4 v[80:83], v243, s[12:15], s70 offen offset:2048 sc1
    buffer_load_dwordx4 v[96:99], v243, s[12:15], s70 offen offset:3072 sc1
    buffer_load_dword v252, off, s[12:15], 0
    s_waitcnt vmcnt(0)
    buffer_load_dword v252, off, s[12:15], 0
    s_waitcnt vmcnt(0)
    buffer_load_dword v252, off, s[12:15], 0
    s_waitcnt vmcnt(0)
    buffer_load_dword v252, off, s[12:15], 0
    s_branch L_back_m_11_1
    s_nop 0
L_slow_m_12_1:
    s_mov_b32 s75, 0
L_slow_m_12_1_a:
    buffer_load_dwordx4 v[68:71], v243, s[12:15], s71 offen offset:1024 sc1
    buffer_load_dwordx4 v[84:87], v243, s[12:15], s71 offen offset:2048 sc1
    buffer_load_dwordx4 v[100:103], v243, s[12:15], s71 offen offset:3072 sc1
    s_waitcnt vmcnt(0)
    v_max3_u32 v248, v68, v84, v100
    v_cmp_eq_u32 vcc, -1, v248
    s_cbranch_vccz L_slow_m_12_1_r
    s_add_u32 s75, s75, 1
    s_cmp_lt_u32 s75, 4000
    s_cbranch_scc1 L_slow_m_12_1_a
L_slow_m_12_1_r:
    buffer_load_dwordx4 v[72:75], v243, s[12:15], s72 offen offset:1024 sc1
    buffer_load_dwordx4 v[88:91], v243, s[12:15], s72 offen offset:2048 sc1
    buffer_load_dwordx4 v[104:107], v243, s[12:15], s72 offen offset:3072 sc1
    buffer_load_dwordx4 v[76:79], v243, s[12:15], s73 offen offset:1024 sc1
    buffer_load_dwordx4 v[92:95], v243, s[12:15], s73 offen offset:2048 sc1
    buffer_load_dwordx4 v[108:111], v243, s[12:15], s73 offen offset:3072 sc1
    buffer_load_dwordx4 v[64:67], v243, s[12:15], s70 offen offset:1024 sc1
    buffer_load_dwordx4 v[80:83], v243, s[12:15], s70 offen offset:2048 sc1
    buffer_load_dwordx4 v[96:99], v243, s[12:15], s70 offen offset:3072 sc1
    buffer_load_dword v252, off, s[12:15], 0
    s_waitcnt vmcnt(0)
    buffer_load_dword v252, off, s[12:15], 0
    s_waitcnt vmcnt(0)
    buffer_load_dword v252, off, s[12:15], 0
    s_waitcnt vmcnt(0)
    buffer_load_dword v252, off, s[12:15], 0
    s_branch L_back_m_12_1
    s_nop 0
L_slow_m_12_2:
    s_mov_b32 s75, 0
L_slow_m_12_2_a:
    buffer_load_dwordx4 v[72:75], v243, s[12:15], s72 offen offset:1024 sc1
    buffer_load_dwordx4 v[88:91], v243, s[12:15], s72 offen offset:2048 sc1
    buffer_load_dwordx4 v[104:107], v243, s[12:15], s72 offen offset:3072 sc1
    s_waitcnt vmcnt(0)
    v_max3_u32 v248, v72, v88, v104
    v_cmp_eq_u32 vcc, -1, v248
    s_cbranch_vccz L_slow_m_12_2_r
    s_add_u32 s75, s75, 1
    s_cmp_lt_u32 s75, 4000
    s_cbranch_scc1 L_slow_m_12_2_a
L_slow_m_12_2_r:
    buffer_load_dwordx4 v[76:79], v243, s[12:15], s73 offen offset:1024 sc1
    buffer_load_dwordx4 v[92:95], v243, s[12:15], s73 offen offset:2048 sc1
    buffer_load_dwordx4 v[108:111], v243, s[12:15], s73 offen offset:3072 sc1
    buffer_load_dwordx4 v[64:67], v243, s[12:15], s70 offen offset:1024 sc1
    buffer_load_dwordx4 v[80:83], v243, s[12:15], s70 offen offset:2048 sc1
    buffer_load_dwordx4 v[96:99], v243, s[12:15], s70 offen offset:3072 sc1
    buffer_load_dword v252, off, s[12:15], 0
    s_waitcnt vmcnt(0)
    buffer_load_dword v252, off, s[12:15], 0
    s_waitcnt vmcnt(0)
    buffer_load_dword v252, off, s[12:15], 0
    s_waitcnt vmcnt(0)
    buffer_load_dword v252, off, s[12:15], 0
    s_branch L_back_m_12_2
    s_nop 0
L_slow_m_12_3:
    s_mov_b32 s75, 0
L_slow_m_12_3_a:
    buffer_load_dwordx4 v[76:79], v243, s[12:15], s73 offen offset:1024 sc1
    buffer_load_dwordx4 v[92:95], v243, s[12:15], s73 offen offset:2048 sc1
    buffer_load_dwordx4 v[108:111], v243, s[12:15], s73 offen offset:3072 sc1
    s_waitcnt vmcnt(0)
    v_max3_u32 v248, v76, v92, v108
    v_cmp_eq_u32 vcc, -1, v248
    s_cbranch_vccz L_slow_m_12_3_r
    s_add_u32 s75, s75, 1
    s_cmp_lt_u32 s75, 4000
    s_cbranch_scc1 L_slow_m_12_3_a
L_slow_m_12_3_r:
    buffer_load_dwordx4 v[64:67], v243, s[12:15], s70 offen offset:1024 sc1
    buffer_load_dwordx4 v[80:83], v243, s[12:15], s70 offen offset:2048 sc1
    buffer_load_dwordx4 v[96:99], v243, s[12:15], s70 offen offset:3072 sc1
    buffer_load_dword v252, off, s[12:15], 0
    s_waitcnt vmcnt(0)
    buffer_load_dword v252, off, s[12:15], 0
    s_waitcnt vmcnt(0)
    buffer_load_dword v252, off, s[12:15], 0
    s_waitcnt vmcnt(0)
    buffer_load_dword v252, off, s[12:15], 0
    s_branch L_back_m_12_3
    s_nop 0
L_slow_m_12_0:
    s_mov_b32 s75, 0
L_slow_m_12_0_a:
    buffer_load_dwordx4 v[64:67], v243, s[12:15], s70 offen offset:1024 sc1
    buffer_load_dwordx4 v[80:83], v243, s[12:15], s70 offen offset:2048 sc1
    buffer_load_dwordx4 v[96:99], v243, s[12:15], s70 offen offset:3072 sc1
    s_waitcnt vmcnt(0)
    v_max3_u32 v248, v64, v80, v96
    v_cmp_eq_u32 vcc, -1, v248
    s_cbranch_vccz L_slow_m_12_0_r
    s_add_u32 s75, s75, 1
    s_cmp_lt_u32 s75, 4000
    s_cbranch_scc1 L_slow_m_12_0_a
L_slow_m_12_0_r:
    buffer_load_dword v252, off, s[12:15], 0
    s_waitcnt vmcnt(0)
    buffer_load_dword v252, off, s[12:15], 0
    s_waitcnt vmcnt(0)
    buffer_load_dword v252, off, s[12:15], 0
    s_waitcnt vmcnt(0)
    buffer_load_dword v252, off, s[12:15], 0
    s_branch L_back_m_12_0
.p2align 12
.fill 832, 4, 0xbf810000
L_mlp:
    s_nop 7
    s_lshl_b32 s54, s32, 9
    s_add_u32 s45, s54, 0
    s_lshl_b32 s54, s33, 7
    s_lshl_b32 s55, s32, 2
    s_add_u32 s55, s55, s54
    s_sub_u32 s55, s55, 16
    v_add_u32 v5, s55, v1
    v_max_i32 v5, 0, v5
    s_lshl_b32 s56, s32, 1
    v_add_u32 v6, s56, v3
    v_xor_b32 v6, v2, v6
    v_and_b32 v6, 7, v6
    v_lshlrev_b32 v6, 4, v6
    v_lshl_add_u32 v224, v5, 10, v6
    s_cmp_eq_u32 s32, 0
    s_cselect_b32 s48, 0xffffff00, -1
    s_mov_b32 s49, 0
    s_waitcnt lgkmcnt(0)
    s_add_u32 m0, s43, 0
    s_nop 0
    buffer_load_dwordx4 v220, s[4:7], s42 offen lds
    buffer_load_dwordx4 v221, s[4:7], s42 offen offset:1024 lds
    buffer_load_dwordx4 v222, s[4:7], s42 offen offset:2048 lds
    buffer_load_dwordx4 v223, s[4:7], s42 offen offset:3072 lds
    s_add_u32 m0, s45, 0
    s_mov_b64 exec, s[48:49]
    buffer_load_dwordx4 v224, s[4:7], s42 offen lds
    s_mov_b64 exec, -1
    s_add_u32 m0, s44, 0
    s_nop 0
    buffer_load_dwordx4 v225, s[8:11], s36 offen lds
    buffer_load_dwordx4 v225, s[8:11], s37 offen offset:1024 lds
    buffer_load_dwordx4 v225, s[8:11], s38 offen offset:2048 lds
    s_add_u32 m0, s44, 3072
    s_nop 0
    buffer_load_dwordx4 v225, s[8:11], s39 offen lds
    buffer_load_dwordx4 v225, s[8:11], s40 offen offset:1024 lds
    buffer_load_dwordx4 v225, s[8:11], s41 offen offset:2048 lds
    v_add_u32 v225, s46, v225
    s_add_u32 s42, s42, 128
    s_mov_b32 s14, 7864320
    s_mov_b32 s15, 0x20000
    s_mov_b32 s18, 256
    s_mov_b32 s19, 0x20000
    s_mov_b32 s22, 1409024
    s_mov_b32 s23, 0x20000
    s_mov_b32 s26, 524288
    s_mov_b32 s27, 0x20000
    s_mov_b32 s30, 0x200000
    s_mov_b32 s31, 0x20000
    s_and_b32 s54, s2, 15
    s_lshr_b32 s55, s2, 5
    s_lshl_b32 s55, s55, 4
    s_or_b32 s54, s54, s55
    s_lshl_b32 s54, s54, 2
    s_add_u32 s54, s54, s32
    v_lshlrev_b32 v108, 7, v239
    s_cmp_ge_u32 s54, 192
    s_cbranch_scc1 L_pfn_28
    s_sub_u32 s55, s54, 0
    s_lshl_b32 s55, s55, 13
    buffer_load_dword a240, v108, s[8:11], s55 offen
    s_branch L_pfd_27
L_pfn_28:
    s_cmp_ge_u32 s54, 448
    s_cbranch_scc1 L_pfn_29
    s_sub_u32 s55, s54, 192
    s_lshl_b32 s55, s55, 13
    buffer_load_dword a241, v108, s[4:7], s55 offen
    s_branch L_pfd_27
L_pfn_29:
    s_sub_u32 s55, s54, 448
    s_lshl_b32 s55, s55, 13
    buffer_load_dword a242, v108, s[24:27], s55 offen
L_pfd_27:
    s_lshl_b32 s54, s2, 2
    s_or_b32 s54, s54, s32
    s_cmp_lg_u32 s54, 0
    s_cbranch_scc1 L_nopub_31
    s_or_b32 s58, s58, 1
    v_mov_b32 v228, s58
    v_mov_b32 v229, s59
    s_mov_b64 exec, 1
    buffer_store_dwordx2 v[228:229], off, s[16:19], 0 sc1
    s_mov_b64 exec, -1
L_nopub_31:
    s_mov_b32 s99, 1
    s_cmp_eq_u32 s32, 0
    s_cbranch_scc1 L_pad_a1
    s_cmp_eq_u32 s32, 1
    s_cbranch_scc1 L_pad_a2
    s_cmp_eq_u32 s32, 2
    s_cbranch_scc1 L_pad_a3
    s_cmp_eq_u32 s32, 3
    s_cbranch_scc1 L_pad_a4
L_padback_a:
    s_mov_b32 s99, 0
    s_add_u32 m0, s43, 43008
    v_lshlrev_b32 v240, 4, v239
    buffer_load_dwordx4 v220, s[4:7], s42 offen lds
    v_mov_b32 v212, 0x3f803f80
    v_mov_b32 v213, 0x3f803f80
    v_mov_b32 v214, 0x3f803f80
    v_mov_b32 v215, 0x3f803f80
    v_add_u32 v5, 86016, v240
    s_mov_b64 exec, 0xff
    ds_write_b128 v240, v[212:215] offset:0
    ds_write_b128 v240, v[212:215] offset:43008
    ds_write_b128 v5, v[212:215] offset:0
    s_mov_b64 exec, -1
    buffer_load_dwordx4 v221, s[4:7], s42 offen offset:1024 lds
    v_lshrrev_b32 v5, 1, v4
    v_xor_b32 v5, v5, v3
    v_lshlrev_b32 v5, 4, v5
    v_lshl_add_u32 v5, v4, 7, v5
    v_add_u32 v216, 0, v5
    v_xor_b32 v217, 64, v216
    buffer_load_dwordx4 v222, s[4:7], s42 offen offset:2048 lds
    v_bfe_u32 v7, v239, 2, 2
    v_and_b32 v8, 3, v239
    v_and_b32 v5, 1, v3
    v_lshl_add_u32 v5, v5, 2, v7
    v_lshrrev_b32 v6, 1, v5
    v_lshlrev_b32 v6, 1, v6
    buffer_load_dwordx4 v223, s[4:7], s42 offen offset:3072 lds
    s_lshl_b32 s54, s32, 1
    v_xor_b32 v6, s54, v6
    v_lshrrev_b32 v9, 1, v8
    v_add_u32 v6, v6, v9
    v_lshlrev_b32 v6, 4, v6
    s_add_u32 m0, s45, 43008
    v_lshl_add_u32 v6, v5, 7, v6
    s_mov_b64 exec, s[48:49]
    buffer_load_dwordx4 v224, s[4:7], s42 offen lds
    s_mov_b64 exec, -1
    v_and_b32 v5, 1, v8
    v_lshl_add_u32 v6, v5, 3, v6
    v_lshrrev_b32 v5, 1, v3
    s_mov_b32 s54, 6144
    v_mad_u32_u24 v6, v5, s54, v6
L_pad_a1:
    s_cmp_eq_u32 s99, 1
    s_cbranch_scc1 L_pad_a5
    s_add_u32 m0, s44, 43008
    v_add_u32 v218, 18432, v6
    buffer_load_dwordx4 v225, s[8:11], s36 offen lds
    v_min_u32 v5, 35, v239
    s_mul_i32 s54, s32, 36
    v_add_u32 v5, s54, v5
    v_lshlrev_b32 v6, 2, v5
    v_add_u32 v238, 161792, v6
    s_lshl_b32 s54, s33, 7
    buffer_load_dwordx4 v225, s[8:11], s37 offen offset:1024 lds
    s_sub_u32 s54, s54, 16
    v_add_u32 v5, s54, v5
    v_max_i32 v5, 0, v5
    v_lshlrev_b32 v227, 4, v5
    s_lshl_b32 s54, s33, 3
    s_and_b32 s55, s32, 1
    buffer_load_dwordx4 v225, s[8:11], s38 offen offset:2048 lds
    s_lshl_b32 s55, s55, 2
    s_add_u32 s54, s54, s55
    s_mul_i32 s54, s54, 59
    s_lshl_b32 s55, s34, 1
    s_add_u32 s55, s55, 43
    s_add_u32 m0, s44, 46080
    s_lshl_b32 s60, s33, 7
    buffer_load_dwordx4 v225, s[8:11], s39 offen lds
    s_lshl_b32 s61, s35, 3
    s_add_u32 s61, s61, s34
    s_lshl_b32 s61, s61, 3
    s_add_u32 s61, s61, s60
    s_lshl_b32 s62, s32, 1
    s_add_u32 s61, s61, s62
    buffer_load_dwordx4 v225, s[8:11], s40 offen offset:1024 lds
    v_lshrrev_b32 v12, 5, v239
    v_add_u32 v12, s61, v12
    v_lshlrev_b32 v226, 4, v12
    v_and_b32 v13, 31, v239
    v_lshlrev_b32 v13, 4, v13
    v_lshl_add_u32 v11, v12, 10, v13
    buffer_load_dwordx4 v225, s[8:11], s41 offen offset:2048 lds
    v_add_u32 v225, s46, v225
    s_add_u32 s42, s42, 128
    s_add_u32 s54, s54, s55
    s_lshr_b32 s55, s32, 1
    s_add_u32 s54, s54, s55
    s_lshl_b32 s54, s54, 10
    s_add_u32 s50, s54, 131072
    buffer_load_dwordx4 v[244:247], v11, s[4:7], 0 offen
    buffer_load_dwordx4 v[248:251], v11, s[4:7], 0 offen offset:512
    s_add_u32 m0, s43, 86016
    s_lshl_b32 s54, s33, 1
    buffer_load_dwordx4 v220, s[4:7], s42 offen lds
    s_and_b32 s55, s32, 1
    s_add_u32 s54, s54, s55
    s_lshl_b32 s54, s54, 2
    s_lshr_b32 s55, s34, 1
    s_add_u32 s54, s54, s55
    s_lshl_b32 s54, s54, 4
    buffer_load_dwordx4 v221, s[4:7], s42 offen offset:1024 lds
    s_and_b32 s55, s34, 1
    s_lshl_b32 s55, s55, 1
    s_add_u32 s54, s54, s55
    s_lshr_b32 s55, s32, 1
    s_add_u32 s54, s54, s55
    s_lshl_b32 s54, s54, 3
    buffer_load_dwordx4 v222, s[4:7], s42 offen offset:2048 lds
    s_add_u32 s51, s54, 32768
    v_accvgpr_write_b32 a252, -1
    v_accvgpr_write_b32 a253, -1
    v_accvgpr_write_b32 a254, -1
    v_accvgpr_write_b32 a255, -1
    buffer_load_dwordx4 v223, s[4:7], s42 offen offset:3072 lds
    s_add_u32 m0, s45, 86016
    s_mov_b64 exec, s[48:49]
    buffer_load_dwordx4 v224, s[4:7], s42 offen lds
    s_mov_b64 exec, -1
    s_add_u32 m0, s44, 86016
    s_nop 0
    buffer_load_dwordx4 v225, s[8:11], s36 offen lds
    s_waitcnt vmcnt(20)
    s_waitcnt lgkmcnt(0)
    s_barrier
    ds_read_b64_tr_b16 v[156:157], v218 offset:1024
    ds_read_b64_tr_b16 v[158:159], v218 offset:13312
    ds_read_b128 v[116:119], v216 offset:0
    ds_read_b128 v[120:123], v216 offset:2048
    ds_read_b64_tr_b16 v[152:153], v218 offset:0
    ds_read_b64_tr_b16 v[154:155], v218 offset:12288
    ds_read_b128 v[124:127], v216 offset:4096
    ds_read_b128 v[128:131], v216 offset:6144
    ds_read_b128 v[132:135], v216 offset:8192
    ds_read_b128 v[136:139], v216 offset:10240
    ds_read_b128 v[140:143], v216 offset:12288
    ds_read_b128 v[144:147], v216 offset:14336
    ds_read_b128 v[148:151], v216 offset:16384
    ds_read_b64_tr_b16 v[160:161], v218 offset:2048
    ds_read_b64_tr_b16 v[162:163], v218 offset:14336
    s_waitcnt lgkmcnt(12)
    v_mfma_f32_16x16x32_bf16 v[32:35], v[156:159], v[116:119], 0
    ds_read_b64_tr_b16 v[204:205], v218 offset:4096
    s_waitcnt lgkmcnt(12)
    v_mfma_f32_16x16x32_bf16 v[36:39], v[156:159], v[120:123], 0
    buffer_load_dwordx4 v225, s[8:11], s37 offen offset:1024 lds
    s_waitcnt lgkmcnt(10)
    v_mfma_f32_16x16x32_bf16 v[0:3], v[152:155], v[120:123], 0
    ds_read_b64_tr_b16 v[206:207], v218 offset:16384
    v_mfma_f32_16x16x32_bf16 v[104:107], v[152:155], v[212:215], 0
    ds_read_b128 v[164:167], v217 offset:0
    s_waitcnt lgkmcnt(11)
    v_mfma_f32_16x16x32_bf16 v[4:7], v[152:155], v[124:127], 0
    buffer_load_dwordx4 v225, s[8:11], s38 offen offset:2048 lds
    v_mfma_f32_16x16x32_bf16 v[40:43], v[156:159], v[124:127], 0
    ds_read_b128 v[168:171], v217 offset:2048
    s_waitcnt lgkmcnt(4)
    v_mfma_f32_16x16x32_bf16 v[44:47], v[156:159], v[128:131], 0
    ds_read_b64_tr_b16 v[200:201], v218 offset:3072
    v_mfma_f32_16x16x32_bf16 v[8:11], v[152:155], v[128:131], 0
    ds_read_b64_tr_b16 v[202:203], v218 offset:15360
    s_add_u32 m0, s44, 89088
    v_mfma_f32_16x16x32_bf16 v[12:15], v[152:155], v[132:135], 0
    v_mfma_f32_16x16x32_bf16 v[48:51], v[156:159], v[132:135], 0
    ds_read_b128 v[172:175], v217 offset:4096
    ds_read_b128 v[176:179], v217 offset:6144
    v_mfma_f32_16x16x32_bf16 v[52:55], v[156:159], v[136:139], 0
    buffer_load_dwordx4 v225, s[8:11], s39 offen lds
    v_mfma_f32_16x16x32_bf16 v[16:19], v[152:155], v[136:139], 0
    ds_read_b128 v[180:183], v217 offset:8192
    v_mfma_f32_16x16x32_bf16 v[20:23], v[152:155], v[140:143], 0
    ds_read_b128 v[184:187], v217 offset:10240
    v_mfma_f32_16x16x32_bf16 v[56:59], v[156:159], v[140:143], 0
    buffer_load_dwordx2 v[236:237], off, s[16:19], 0 sc1
    v_mfma_f32_16x16x32_bf16 v[60:63], v[156:159], v[144:147], 0
    ds_read_b128 v[188:191], v217 offset:12288
    v_mfma_f32_16x16x32_bf16 v[24:27], v[152:155], v[144:147], 0
    ds_read_b128 v[192:195], v217 offset:14336
    v_mfma_f32_16x16x32_bf16 v[28:31], v[152:155], v[148:151], 0
    buffer_load_dwordx4 v225, s[8:11], s40 offen offset:1024 lds
    v_mfma_f32_16x16x32_bf16 v[64:67], v[156:159], v[148:151], 0
    ds_read_b128 v[196:199], v217 offset:16384
    v_mfma_f32_16x16x32_bf16 v[100:103], v[148:151], v[160:163], 0
    ds_read_b64_tr_b16 v[208:209], v218 offset:5120
    v_mfma_f32_16x16x32_bf16 v[96:99], v[144:147], v[160:163], 0
    buffer_load_dwordx4 v225, s[8:11], s41 offen offset:2048 lds
    v_mfma_f32_16x16x32_bf16 v[92:95], v[140:143], v[160:163], 0
    ds_read_b64_tr_b16 v[210:211], v218 offset:17408
    v_mfma_f32_16x16x32_bf16 v[88:91], v[136:139], v[160:163], 0
    v_mfma_f32_16x16x32_bf16 v[84:87], v[132:135], v[160:163], 0
    v_add_u32 v225, s46, v225
    v_mfma_f32_16x16x32_bf16 v[80:83], v[128:131], v[160:163], 0
    v_mfma_f32_16x16x32_bf16 v[76:79], v[124:127], v[160:163], 0
    v_mfma_f32_16x16x32_bf16 v[72:75], v[120:123], v[160:163], 0
    s_add_u32 s42, s42, 128
    v_mfma_f32_16x16x32_bf16 v[68:71], v[116:119], v[160:163], 0
    s_waitcnt lgkmcnt(0)
    s_waitcnt vmcnt(14)
    s_barrier
    v_mfma_f32_16x16x32_bf16 v[32:35], v[204:207], v[164:167], v[32:35]
    v_add_u32 v218, 0xa800, v218
    s_waitcnt vmcnt(13)
    v_dot2_f32_bf16 v252, v244, v212, 0
    v_mfma_f32_16x16x32_bf16 v[36:39], v[204:207], v[168:171], v[36:39]
    v_add_u32 v216, 0xa800, v216
    s_add_u32 m0, s43, 0
    v_mfma_f32_16x16x32_bf16 v[0:3], v[200:203], v[168:171], v[0:3]
    ds_read_b64_tr_b16 v[156:157], v218 offset:1024
    v_dot2_f32_bf16 v254, v244, v244, 0
    v_mfma_f32_16x16x32_bf16 v[104:107], v[200:203], v[212:215], v[104:107]
    buffer_load_dwordx4 v220, s[4:7], s42 offen lds
    v_mfma_f32_16x16x32_bf16 v[4:7], v[200:203], v[172:175], v[4:7]
    ds_read_b64_tr_b16 v[158:159], v218 offset:13312
    ds_read_b128 v[116:119], v216 offset:0
    v_mfma_f32_16x16x32_bf16 v[40:43], v[204:207], v[172:175], v[40:43]
    buffer_load_dwordx4 v221, s[4:7], s42 offen offset:1024 lds
    v_mfma_f32_16x16x32_bf16 v[44:47], v[204:207], v[176:179], v[44:47]
    v_add_u32 v217, 0xa800, v217
    v_dot2_f32_bf16 v253, v245, v212, 0
    v_mfma_f32_16x16x32_bf16 v[8:11], v[200:203], v[176:179], v[8:11]
    buffer_load_dwordx4 v222, s[4:7], s42 offen offset:2048 lds
    v_mfma_f32_16x16x32_bf16 v[12:15], v[200:203], v[180:183], v[12:15]
    ds_read_b128 v[120:123], v216 offset:2048
    ds_read_b64_tr_b16 v[152:153], v218 offset:0
    v_mfma_f32_16x16x32_bf16 v[48:51], v[204:207], v[180:183], v[48:51]
    buffer_load_dwordx4 v223, s[4:7], s42 offen offset:3072 lds
    v_mfma_f32_16x16x32_bf16 v[52:55], v[204:207], v[184:187], v[52:55]
    ds_read_b64_tr_b16 v[154:155], v218 offset:12288
    v_dot2_f32_bf16 v255, v245, v245, 0
    v_dot2_f32_bf16 v252, v246, v212, v252
    v_mfma_f32_16x16x32_bf16 v[16:19], v[200:203], v[184:187], v[16:19]
    ds_read_b128 v[124:127], v216 offset:4096
    s_add_u32 m0, s45, 0
    v_mfma_f32_16x16x32_bf16 v[20:23], v[200:203], v[188:191], v[20:23]
    ds_read_b128 v[128:131], v216 offset:6144
    ds_read_b128 v[132:135], v216 offset:8192
    v_mfma_f32_16x16x32_bf16 v[56:59], v[204:207], v[188:191], v[56:59]
    s_mov_b64 exec, s[48:49]
    buffer_load_dwordx4 v224, s[4:7], s42 offen lds
    s_mov_b64 exec, -1
    v_mfma_f32_16x16x32_bf16 v[60:63], v[204:207], v[192:195], v[60:63]
    ds_read_b128 v[136:139], v216 offset:10240
    v_dot2_f32_bf16 v254, v246, v246, v254
    v_mfma_f32_16x16x32_bf16 v[24:27], v[200:203], v[192:195], v[24:27]
    ds_read_b128 v[140:143], v216 offset:12288
    s_add_u32 m0, s44, 0
    v_mfma_f32_16x16x32_bf16 v[28:31], v[200:203], v[196:199], v[28:31]
    ds_read_b128 v[144:147], v216 offset:14336
    v_dot2_f32_bf16 v253, v247, v212, v253
    v_mfma_f32_16x16x32_bf16 v[64:67], v[204:207], v[196:199], v[64:67]
    buffer_load_dwordx4 v225, s[8:11], s36 offen lds
    v_mfma_f32_16x16x32_bf16 v[100:103], v[196:199], v[208:211], v[100:103]
    ds_read_b128 v[148:151], v216 offset:16384
    v_mfma_f32_16x16x32_bf16 v[96:99], v[192:195], v[208:211], v[96:99]
    ds_read_b64_tr_b16 v[160:161], v218 offset:2048
    v_mfma_f32_16x16x32_bf16 v[92:95], v[188:191], v[208:211], v[92:95]
    ds_read_b64_tr_b16 v[162:163], v218 offset:14336
    v_mfma_f32_16x16x32_bf16 v[88:91], v[184:187], v[208:211], v[88:91]
    v_dot2_f32_bf16 v255, v247, v247, v255
    v_mfma_f32_16x16x32_bf16 v[84:87], v[180:183], v[208:211], v[84:87]
    s_waitcnt vmcnt(18)
    v_dot2_f32_bf16 v252, v248, v212, v252
    v_mfma_f32_16x16x32_bf16 v[80:83], v[176:179], v[208:211], v[80:83]
    s_add_u32 s56, s50, 0
    buffer_store_dwordx4 a[252:255], v240, s[12:15], s56 offen sc1
    v_mfma_f32_16x16x32_bf16 v[76:79], v[172:175], v[208:211], v[76:79]
    v_dot2_f32_bf16 v254, v248, v248, v254
    v_mfma_f32_16x16x32_bf16 v[72:75], v[168:171], v[208:211], v[72:75]
    v_dot2_f32_bf16 v253, v249, v212, v253
    v_mfma_f32_16x16x32_bf16 v[68:71], v[164:167], v[208:211], v[68:71]
    v_dot2_f32_bf16 v255, v249, v249, v255
    v_dot2_f32_bf16 v252, v250, v212, v252
    s_waitcnt lgkmcnt(0)
    v_mfma_f32_16x16x32_bf16 v[32:35], v[156:159], v[116:119], v[32:35]
    ds_read_b64_tr_b16 v[204:205], v218 offset:4096
    v_dot2_f32_bf16 v254, v250, v250, v254
    v_mfma_f32_16x16x32_bf16 v[36:39], v[156:159], v[120:123], v[36:39]
    buffer_load_dwordx4 v225, s[8:11], s37 offen offset:1024 lds
    v_mfma_f32_16x16x32_bf16 v[0:3], v[152:155], v[120:123], v[0:3]
    ds_read_b64_tr_b16 v[206:207], v218 offset:16384
    ds_read_b128 v[164:167], v217 offset:0
    v_mfma_f32_16x16x32_bf16 v[104:107], v[152:155], v[212:215], v[104:107]
    buffer_load_dwordx4 v225, s[8:11], s38 offen offset:2048 lds
    v_mfma_f32_16x16x32_bf16 v[4:7], v[152:155], v[124:127], v[4:7]
    ds_read_b128 v[168:171], v217 offset:2048
    v_dot2_f32_bf16 v253, v251, v212, v253
    v_mfma_f32_16x16x32_bf16 v[40:43], v[156:159], v[124:127], v[40:43]
    v_dot2_f32_bf16 v255, v251, v251, v255
    s_add_u32 m0, s44, 3072
    v_mfma_f32_16x16x32_bf16 v[44:47], v[156:159], v[128:131], v[44:47]
    ds_read_b64_tr_b16 v[200:201], v218 offset:3072
    v_mfma_f32_16x16x32_bf16 v[8:11], v[152:155], v[128:131], v[8:11]
    ds_read_b64_tr_b16 v[202:203], v218 offset:15360
    v_add_f32 v252, v252, v253
    v_mfma_f32_16x16x32_bf16 v[12:15], v[152:155], v[132:135], v[12:15]
    buffer_load_dwordx4 v225, s[8:11], s39 offen lds
    v_mfma_f32_16x16x32_bf16 v[48:51], v[156:159], v[132:135], v[48:51]
    ds_read_b128 v[172:175], v217 offset:4096
    ds_read_b128 v[176:179], v217 offset:6144
    v_mfma_f32_16x16x32_bf16 v[52:55], v[156:159], v[136:139], v[52:55]
    buffer_load_dwordx4 v225, s[8:11], s40 offen offset:1024 lds
    v_mfma_f32_16x16x32_bf16 v[16:19], v[152:155], v[136:139], v[16:19]
    ds_read_b128 v[180:183], v217 offset:8192
    v_add_f32 v254, v254, v255
    v_mfma_f32_16x16x32_bf16 v[20:23], v[152:155], v[140:143], v[20:23]
    ds_read_b128 v[184:187], v217 offset:10240
    v_add_f32_dpp v252, v252, v252 row_ror:8 row_mask:0xf bank_mask:0xf
    v_mfma_f32_16x16x32_bf16 v[56:59], v[156:159], v[140:143], v[56:59]
    buffer_load_dwordx4 v225, s[8:11], s41 offen offset:2048 lds
    v_mfma_f32_16x16x32_bf16 v[60:63], v[156:159], v[144:147], v[60:63]
    ds_read_b128 v[188:191], v217 offset:12288
    v_add_f32_dpp v254, v254, v254 row_ror:8 row_mask:0xf bank_mask:0xf
    v_mfma_f32_16x16x32_bf16 v[24:27], v[152:155], v[144:147], v[24:27]
    v_add_f32_dpp v252, v252, v252 row_ror:4 row_mask:0xf bank_mask:0xf
    v_add_u32 v225, s46, v225
    v_mfma_f32_16x16x32_bf16 v[28:31], v[152:155], v[148:151], v[28:31]
    ds_read_b128 v[192:195], v217 offset:14336
    v_mfma_f32_16x16x32_bf16 v[64:67], v[156:159], v[148:151], v[64:67]
    ds_read_b128 v[196:199], v217 offset:16384
    s_add_u32 s42, s42, 128
    v_mfma_f32_16x16x32_bf16 v[100:103], v[148:151], v[160:163], v[100:103]
    ds_read_b64_tr_b16 v[208:209], v218 offset:5120
    v_add_f32_dpp v254, v254, v254 row_ror:4 row_mask:0xf bank_mask:0xf
    v_mfma_f32_16x16x32_bf16 v[96:99], v[144:147], v[160:163], v[96:99]
    v_add_f32_dpp v252, v252, v252 row_ror:2 row_mask:0xf bank_mask:0xf
    v_mfma_f32_16x16x32_bf16 v[92:95], v[140:143], v[160:163], v[92:95]
    ds_read_b64_tr_b16 v[210:211], v218 offset:17408
    v_mfma_f32_16x16x32_bf16 v[88:91], v[136:139], v[160:163], v[88:91]
    v_add_f32_dpp v254, v254, v254 row_ror:2 row_mask:0xf bank_mask:0xf
    v_mfma_f32_16x16x32_bf16 v[84:87], v[132:135], v[160:163], v[84:87]
    v_mfma_f32_16x16x32_bf16 v[80:83], v[128:131], v[160:163], v[80:83]
    s_add_u32 s56, s50, 60416
    buffer_store_dwordx4 a[252:255], v240, s[12:15], s56 offen sc1
    v_mfma_f32_16x16x32_bf16 v[76:79], v[124:127], v[160:163], v[76:79]
    v_add_f32_dpp v252, v252, v252 row_ror:1 row_mask:0xf bank_mask:0xf
    v_mfma_f32_16x16x32_bf16 v[72:75], v[120:123], v[160:163], v[72:75]
    v_add_f32_dpp v254, v254, v254 row_ror:1 row_mask:0xf bank_mask:0xf
    v_mfma_f32_16x16x32_bf16 v[68:71], v[116:119], v[160:163], v[68:71]
    s_waitcnt lgkmcnt(0)
    s_waitcnt vmcnt(13)
    s_barrier
    v_mfma_f32_16x16x32_bf16 v[32:35], v[204:207], v[164:167], v[32:35]
    v_add_u32 v218, 0xa800, v218
    v_mov_b32 v253, v252
    v_mfma_f32_16x16x32_bf16 v[36:39], v[204:207], v[168:171], v[36:39]
    v_add_u32 v216, 0xa800, v216
    s_add_u32 m0, s43, 43008
    v_mfma_f32_16x16x32_bf16 v[0:3], v[200:203], v[168:171], v[0:3]
    ds_read_b64_tr_b16 v[156:157], v218 offset:1024
    v_mov_b32 v255, v254
    v_mfma_f32_16x16x32_bf16 v[104:107], v[200:203], v[212:215], v[104:107]
    buffer_load_dwordx4 v220, s[4:7], s42 offen lds
    v_mfma_f32_16x16x32_bf16 v[4:7], v[200:203], v[172:175], v[4:7]
    ds_read_b64_tr_b16 v[158:159], v218 offset:13312
    ds_read_b128 v[116:119], v216 offset:0
    v_mfma_f32_16x16x32_bf16 v[40:43], v[204:207], v[172:175], v[40:43]
    buffer_load_dwordx4 v221, s[4:7], s42 offen offset:1024 lds
    v_mfma_f32_16x16x32_bf16 v[44:47], v[204:207], v[176:179], v[44:47]
    v_add_u32 v217, 0xa800, v217
    v_permlane16_swap_b32 v252, v253
    v_mfma_f32_16x16x32_bf16 v[8:11], v[200:203], v[176:179], v[8:11]
    buffer_load_dwordx4 v222, s[4:7], s42 offen offset:2048 lds
    v_mfma_f32_16x16x32_bf16 v[12:15], v[200:203], v[180:183], v[12:15]
    ds_read_b128 v[120:123], v216 offset:2048
    ds_read_b64_tr_b16 v[152:153], v218 offset:0
    v_mfma_f32_16x16x32_bf16 v[48:51], v[204:207], v[180:183], v[48:51]
    buffer_load_dwordx4 v223, s[4:7], s42 offen offset:3072 lds
    v_mfma_f32_16x16x32_bf16 v[52:55], v[204:207], v[184:187], v[52:55]
    ds_read_b64_tr_b16 v[154:155], v218 offset:12288
    v_permlane16_swap_b32 v254, v255
    v_add_f32 v252, v252, v253
    v_mfma_f32_16x16x32_bf16 v[16:19], v[200:203], v[184:187], v[16:19]
    ds_read_b128 v[124:127], v216 offset:4096
    s_add_u32 m0, s45, 43008
    v_mfma_f32_16x16x32_bf16 v[20:23], v[200:203], v[188:191], v[20:23]
    ds_read_b128 v[128:131], v216 offset:6144
    ds_read_b128 v[132:135], v216 offset:8192
    v_mfma_f32_16x16x32_bf16 v[56:59], v[204:207], v[188:191], v[56:59]
    s_mov_b64 exec, s[48:49]
    buffer_load_dwordx4 v224, s[4:7], s42 offen lds
    s_mov_b64 exec, -1
    v_mfma_f32_16x16x32_bf16 v[60:63], v[204:207], v[192:195], v[60:63]
    ds_read_b128 v[136:139], v216 offset:10240
    v_add_f32 v254, v254, v255
    v_mfma_f32_16x16x32_bf16 v[24:27], v[200:203], v[192:195], v[24:27]
    ds_read_b128 v[140:143], v216 offset:12288
    s_add_u32 m0, s44, 43008
    v_mfma_f32_16x16x32_bf16 v[28:31], v[200:203], v[196:199], v[28:31]
    ds_read_b128 v[144:147], v216 offset:14336
    v_mul_f32 v228, 0xbb000000, v252
    v_mfma_f32_16x16x32_bf16 v[64:67], v[204:207], v[196:199], v[64:67]
    buffer_load_dwordx4 v225, s[8:11], s36 offen lds
    v_mfma_f32_16x16x32_bf16 v[100:103], v[196:199], v[208:211], v[100:103]
    ds_read_b128 v[148:151], v216 offset:16384
    v_mul_f32 v254, 0x3b000000, v254
    v_mfma_f32_16x16x32_bf16 v[96:99], v[192:195], v[208:211], v[96:99]
    ds_read_b64_tr_b16 v[160:161], v218 offset:2048
    v_fma_f32 v254, -v228, v228, v254
    v_mfma_f32_16x16x32_bf16 v[92:95], v[188:191], v[208:211], v[92:95]
    ds_read_b64_tr_b16 v[162:163], v218 offset:14336
    v_mfma_f32_16x16x32_bf16 v[88:91], v[184:187], v[208:211], v[88:91]
    v_max_f32 v254, 0, v254
    v_mfma_f32_16x16x32_bf16 v[84:87], v[180:183], v[208:211], v[84:87]
    v_mfma_f32_16x16x32_bf16 v[80:83], v[176:179], v[208:211], v[80:83]
    s_add_u32 s56, s50, 120832
    buffer_store_dwordx4 a[252:255], v240, s[12:15], s56 offen sc1
    v_mfma_f32_16x16x32_bf16 v[76:79], v[172:175], v[208:211], v[76:79]
    v_add_f32 v254, 0x3727c5ac, v254
    v_mfma_f32_16x16x32_bf16 v[72:75], v[168:171], v[208:211], v[72:75]
    v_rsq_f32 v229, v254
    v_mfma_f32_16x16x32_bf16 v[68:71], v[164:167], v[208:211], v[68:71]
    s_waitcnt lgkmcnt(0)
    v_mfma_f32_16x16x32_bf16 v[32:35], v[156:159], v[116:119], v[32:35]
    ds_read_b64_tr_b16 v[204:205], v218 offset:4096
    v_mfma_f32_16x16x32_bf16 v[36:39], v[156:159], v[120:123], v[36:39]
    buffer_load_dwordx4 v225, s[8:11], s37 offen offset:1024 lds
    v_mfma_f32_16x16x32_bf16 v[0:3], v[152:155], v[120:123], v[0:3]
    ds_read_b64_tr_b16 v[206:207], v218 offset:16384
    ds_read_b128 v[164:167], v217 offset:0
    v_readfirstlane_b32 s58, v236
    v_readfirstlane_b32 s59, v237
    s_cmp_lg_u32 s58, 0
    s_cbranch_scc1 L_non_ok_32
    s_mov_b32 s75, 0
L_non_again_33:
    s_sleep 1
    buffer_load_dwordx2 v[236:237], off, s[16:19], 0 sc1
    s_waitcnt vmcnt(0)
    v_readfirstlane_b32 s58, v236
    v_readfirstlane_b32 s59, v237
    s_cmp_lg_u32 s58, 0
    s_cbranch_scc1 L_non_ok_32
    s_add_u32 s75, s75, 1
    s_cmp_lt_u32 s75, 4000
    s_cbranch_scc1 L_non_again_33
L_non_ok_32:
    s_nop 1
    v_mov_b32 v230, s58
    v_mov_b32 v231, s59
    s_mul_i32 s52, s58, 0x9e3779b1
    s_mov_b32 exec_lo, 1
    s_mov_b32 exec_hi, 1
    buffer_store_dwordx4 v[228:231], v226, s[12:15], 0 offen sc1
    s_mov_b64 exec, -1
    s_lshr_b32 s3, s52, 16
    s_xor_b32 s52, s52, s3
    s_mov_b32 s3, 0x80008000
    v_mfma_f32_16x16x32_bf16 v[104:107], v[152:155], v[212:215], v[104:107]
    buffer_load_dwordx4 v225, s[8:11], s38 offen offset:2048 lds
    v_mfma_f32_16x16x32_bf16 v[4:7], v[152:155], v[124:127], v[4:7]
    ds_read_b128 v[168:171], v217 offset:2048
    v_mfma_f32_16x16x32_bf16 v[40:43], v[156:159], v[124:127], v[40:43]
    s_add_u32 m0, s44, 46080
    v_mfma_f32_16x16x32_bf16 v[44:47], v[156:159], v[128:131], v[44:47]
    ds_read_b64_tr_b16 v[200:201], v218 offset:3072
    v_mfma_f32_16x16x32_bf16 v[8:11], v[152:155], v[128:131], v[8:11]
    ds_read_b64_tr_b16 v[202:203], v218 offset:15360
    v_mfma_f32_16x16x32_bf16 v[12:15], v[152:155], v[132:135], v[12:15]
    buffer_load_dwordx4 v225, s[8:11], s39 offen lds
    v_mfma_f32_16x16x32_bf16 v[48:51], v[156:159], v[132:135], v[48:51]
    ds_read_b128 v[172:175], v217 offset:4096
    ds_read_b128 v[176:179], v217 offset:6144
    v_mfma_f32_16x16x32_bf16 v[52:55], v[156:159], v[136:139], v[52:55]
    buffer_load_dwordx4 v225, s[8:11], s40 offen offset:1024 lds
    v_mfma_f32_16x16x32_bf16 v[16:19], v[152:155], v[136:139], v[16:19]
    ds_read_b128 v[180:183], v217 offset:8192
    v_mfma_f32_16x16x32_bf16 v[20:23], v[152:155], v[140:143], v[20:23]
    ds_read_b128 v[184:187], v217 offset:10240
    v_mfma_f32_16x16x32_bf16 v[56:59], v[156:159], v[140:143], v[56:59]
    buffer_load_dwordx4 v225, s[8:11], s41 offen offset:2048 lds
    v_mfma_f32_16x16x32_bf16 v[60:63], v[156:159], v[144:147], v[60:63]
    ds_read_b128 v[188:191], v217 offset:12288
    v_mfma_f32_16x16x32_bf16 v[24:27], v[152:155], v[144:147], v[24:27]
    v_add_u32 v225, s46, v225
    v_mfma_f32_16x16x32_bf16 v[28:31], v[152:155], v[148:151], v[28:31]
    ds_read_b128 v[192:195], v217 offset:14336
    v_mfma_f32_16x16x32_bf16 v[64:67], v[156:159], v[148:151], v[64:67]
    ds_read_b128 v[196:199], v217 offset:16384
    s_add_u32 s42, s42, 128
    v_mfma_f32_16x16x32_bf16 v[100:103], v[148:151], v[160:163], v[100:103]
    ds_read_b64_tr_b16 v[208:209], v218 offset:5120
    v_mfma_f32_16x16x32_bf16 v[96:99], v[144:147], v[160:163], v[96:99]
    v_mfma_f32_16x16x32_bf16 v[92:95], v[140:143], v[160:163], v[92:95]
    ds_read_b64_tr_b16 v[210:211], v218 offset:17408
    v_mfma_f32_16x16x32_bf16 v[88:91], v[136:139], v[160:163], v[88:91]
    v_mfma_f32_16x16x32_bf16 v[84:87], v[132:135], v[160:163], v[84:87]
    v_mfma_f32_16x16x32_bf16 v[80:83], v[128:131], v[160:163], v[80:83]
    s_add_u32 s56, s50, 181248
    buffer_store_dwordx4 a[252:255], v240, s[12:15], s56 offen sc1
    v_mfma_f32_16x16x32_bf16 v[76:79], v[124:127], v[160:163], v[76:79]
    v_mfma_f32_16x16x32_bf16 v[72:75], v[120:123], v[160:163], v[72:75]
    v_mfma_f32_16x16x32_bf16 v[68:71], v[116:119], v[160:163], v[68:71]
    s_waitcnt lgkmcnt(0)
    s_waitcnt vmcnt(15)
    s_barrier
    v_mfma_f32_16x16x32_bf16 v[32:35], v[204:207], v[164:167], v[32:35]
    v_add_u32 v218, 0xfffeb000, v218
    s_lshl_b32 s55, s68, 2
    v_mfma_f32_16x16x32_bf16 v[36:39], v[204:207], v[168:171], v[36:39]
    v_add_u32 v216, 0xfffeb000, v216
    s_add_u32 m0, s43, 86016
    v_mfma_f32_16x16x32_bf16 v[0:3], v[200:203], v[168:171], v[0:3]
    ds_read_b64_tr_b16 v[156:157], v218 offset:1024
    v_mfma_f32_16x16x32_bf16 v[104:107], v[200:203], v[212:215], v[104:107]
    ds_read_b64_tr_b16 v[158:159], v218 offset:13312
    s_add_u32 s70, s32, 0
    v_mfma_f32_16x16x32_bf16 v[4:7], v[200:203], v[172:175], v[4:7]
    buffer_load_dwordx4 v220, s[4:7], s42 offen lds
    v_mfma_f32_16x16x32_bf16 v[40:43], v[204:207], v[172:175], v[40:43]
    ds_read_b128 v[116:119], v216 offset:0
    v_and_b32 v250, 3, v239
    v_mfma_f32_16x16x32_bf16 v[44:47], v[204:207], v[176:179], v[44:47]
    v_add_u32 v217, 0xfffeb000, v217
    s_and_b32 s70, s70, 3
    v_mfma_f32_16x16x32_bf16 v[8:11], v[200:203], v[176:179], v[8:11]
    buffer_load_dwordx4 v221, s[4:7], s42 offen offset:1024 lds
    v_mfma_f32_16x16x32_bf16 v[12:15], v[200:203], v[180:183], v[12:15]
    ds_read_b128 v[120:123], v216 offset:2048
    ds_read_b64_tr_b16 v[152:153], v218 offset:0
    v_mfma_f32_16x16x32_bf16 v[48:51], v[204:207], v[180:183], v[48:51]
    ds_read_b64_tr_b16 v[154:155], v218 offset:12288
    s_add_u32 s70, s70, s55
    v_mfma_f32_16x16x32_bf16 v[52:55], v[204:207], v[184:187], v[52:55]
    buffer_load_dwordx4 v222, s[4:7], s42 offen offset:2048 lds
    v_mfma_f32_16x16x32_bf16 v[16:19], v[200:203], v[184:187], v[16:19]
    ds_read_b128 v[124:127], v216 offset:4096
    v_lshlrev_b32 v250, 2, v250
    v_mfma_f32_16x16x32_bf16 v[20:23], v[200:203], v[188:191], v[20:23]
    ds_read_b128 v[128:131], v216 offset:6144
    ds_read_b128 v[132:135], v216 offset:8192
    v_mfma_f32_16x16x32_bf16 v[56:59], v[204:207], v[188:191], v[56:59]
    buffer_load_dwordx4 v223, s[4:7], s42 offen offset:3072 lds
    v_mfma_f32_16x16x32_bf16 v[60:63], v[204:207], v[192:195], v[60:63]
    ds_read_b128 v[136:139], v216 offset:10240
    s_mul_i32 s70, s70, 60416
    v_mfma_f32_16x16x32_bf16 v[24:27], v[200:203], v[192:195], v[24:27]
    ds_read_b128 v[140:143], v216 offset:12288
    s_add_u32 s70, s70, 131072
    v_mfma_f32_16x16x32_bf16 v[28:31], v[200:203], v[196:199], v[28:31]
    ds_read_b128 v[144:147], v216 offset:14336
    s_add_u32 m0, s45, 86016
    v_mfma_f32_16x16x32_bf16 v[64:67], v[204:207], v[196:199], v[64:67]
    v_mfma_f32_16x16x32_bf16 v[100:103], v[196:199], v[208:211], v[100:103]
    ds_read_b128 v[148:151], v216 offset:16384
    ds_read_b64_tr_b16 v[160:161], v218 offset:2048
    v_mfma_f32_16x16x32_bf16 v[96:99], v[192:195], v[208:211], v[96:99]
    s_mov_b64 exec, s[48:49]
    buffer_load_dwordx4 v224, s[4:7], s42 offen lds
    s_mov_b64 exec, -1
    v_mfma_f32_16x16x32_bf16 v[92:95], v[188:191], v[208:211], v[92:95]
    ds_read_b64_tr_b16 v[162:163], v218 offset:14336
    s_add_u32 s71, s32, 1
    v_mfma_f32_16x16x32_bf16 v[88:91], v[184:187], v[208:211], v[88:91]
    v_lshlrev_b32 v250, v250, s52
    v_mfma_f32_16x16x32_bf16 v[84:87], v[180:183], v[208:211], v[84:87]
    s_and_b32 s71, s71, 3
    s_add_u32 m0, s44, 86016
    v_mfma_f32_16x16x32_bf16 v[80:83], v[176:179], v[208:211], v[80:83]
    v_mfma_f32_16x16x32_bf16 v[76:79], v[172:175], v[208:211], v[76:79]
    s_add_u32 s71, s71, s55
    v_mfma_f32_16x16x32_bf16 v[72:75], v[168:171], v[208:211], v[72:75]
    buffer_load_dwordx4 v225, s[8:11], s36 offen lds
    v_mfma_f32_16x16x32_bf16 v[68:71], v[164:167], v[208:211], v[68:71]
    s_waitcnt lgkmcnt(0)
    v_mfma_f32_16x16x32_bf16 v[32:35], v[156:159], v[116:119], v[32:35]
    ds_read_b64_tr_b16 v[204:205], v218 offset:4096
    s_mul_i32 s71, s71, 60416
    v_mfma_f32_16x16x32_bf16 v[36:39], v[156:159], v[120:123], v[36:39]
    buffer_load_dwordx4 v225, s[8:11], s37 offen offset:1024 lds
    v_mfma_f32_16x16x32_bf16 v[0:3], v[152:155], v[120:123], v[0:3]
    ds_read_b64_tr_b16 v[206:207], v218 offset:16384
    v_mfma_f32_16x16x32_bf16 v[104:107], v[152:155], v[212:215], v[104:107]
    ds_read_b128 v[164:167], v217 offset:0
    v_and_b32 v251, s3, v250
    v_mfma_f32_16x16x32_bf16 v[4:7], v[152:155], v[124:127], v[4:7]
    ds_read_b128 v[168:171], v217 offset:2048
    s_add_u32 s71, s71, 131072
    v_mfma_f32_16x16x32_bf16 v[40:43], v[156:159], v[124:127], v[40:43]
    buffer_load_dwordx4 v225, s[8:11], s38 offen offset:2048 lds
    v_mfma_f32_16x16x32_bf16 v[44:47], v[156:159], v[128:131], v[44:47]
    ds_read_b64_tr_b16 v[200:201], v218 offset:3072
    v_mfma_f32_16x16x32_bf16 v[8:11], v[152:155], v[128:131], v[8:11]
    ds_read_b64_tr_b16 v[202:203], v218 offset:15360
    s_add_u32 s72, s32, 2
    v_mfma_f32_16x16x32_bf16 v[12:15], v[152:155], v[132:135], v[12:15]
    s_add_u32 m0, s44, 89088
    v_mfma_f32_16x16x32_bf16 v[48:51], v[156:159], v[132:135], v[48:51]
    ds_read_b128 v[172:175], v217 offset:4096
    v_mfma_f32_16x16x32_bf16 v[52:55], v[156:159], v[136:139], v[52:55]
    ds_read_b128 v[176:179], v217 offset:6144
    s_and_b32 s72, s72, 3
    v_mfma_f32_16x16x32_bf16 v[16:19], v[152:155], v[136:139], v[16:19]
    buffer_load_dwordx4 v225, s[8:11], s39 offen lds
    v_mfma_f32_16x16x32_bf16 v[20:23], v[152:155], v[140:143], v[20:23]
    ds_read_b128 v[180:183], v217 offset:8192
    v_accvgpr_write_b32 a244, v251
    v_mfma_f32_16x16x32_bf16 v[56:59], v[156:159], v[140:143], v[56:59]
    ds_read_b128 v[184:187], v217 offset:10240
    s_add_u32 s72, s72, s55
    v_mfma_f32_16x16x32_bf16 v[60:63], v[156:159], v[144:147], v[60:63]
    ds_read_b128 v[188:191], v217 offset:12288
    v_mfma_f32_16x16x32_bf16 v[24:27], v[152:155], v[144:147], v[24:27]
    buffer_load_dwordx4 v225, s[8:11], s40 offen offset:1024 lds
    v_mfma_f32_16x16x32_bf16 v[28:31], v[152:155], v[148:151], v[28:31]
    ds_read_b128 v[192:195], v217 offset:14336
    s_mul_i32 s72, s72, 60416
    v_mfma_f32_16x16x32_bf16 v[64:67], v[156:159], v[148:151], v[64:67]
    ds_read_b128 v[196:199], v217 offset:16384
    v_mfma_f32_16x16x32_bf16 v[100:103], v[148:151], v[160:163], v[100:103]
    buffer_load_dwordx4 v225, s[8:11], s41 offen offset:2048 lds
    v_mfma_f32_16x16x32_bf16 v[96:99], v[144:147], v[160:163], v[96:99]
    ds_read_b64_tr_b16 v[208:209], v218 offset:5120
    s_add_u32 s72, s72, 131072
    v_mfma_f32_16x16x32_bf16 v[92:95], v[140:143], v[160:163], v[92:95]
    ds_read_b64_tr_b16 v[210:211], v218 offset:17408
    v_mfma_f32_16x16x32_bf16 v[88:91], v[136:139], v[160:163], v[88:91]
    v_add_u32 v225, s46, v225
    v_mfma_f32_16x16x32_bf16 v[84:87], v[132:135], v[160:163], v[84:87]
    s_add_u32 s73, s32, 3
    v_lshlrev_b32 v250, 1, v250
    v_mfma_f32_16x16x32_bf16 v[80:83], v[128:131], v[160:163], v[80:83]
    v_mfma_f32_16x16x32_bf16 v[76:79], v[124:127], v[160:163], v[76:79]
    v_mfma_f32_16x16x32_bf16 v[72:75], v[120:123], v[160:163], v[72:75]
L_pad_a2:
    s_cmp_eq_u32 s99, 1
    s_cbranch_scc1 L_padback_a
    s_and_b32 s73, s73, 3
    s_add_u32 s42, s42, 128
    v_mfma_f32_16x16x32_bf16 v[68:71], v[116:119], v[160:163], v[68:71]
    s_waitcnt lgkmcnt(0)
    s_waitcnt vmcnt(12)
    s_barrier
    v_mfma_f32_16x16x32_bf16 v[32:35], v[204:207], v[164:167], v[32:35]
    v_add_u32 v218, 0xa800, v218
    v_mfma_f32_16x16x32_bf16 v[36:39], v[204:207], v[168:171], v[36:39]
    v_add_u32 v216, 0xa800, v216
    s_add_u32 m0, s43, 0
    v_mfma_f32_16x16x32_bf16 v[0:3], v[200:203], v[168:171], v[0:3]
    ds_read_b64_tr_b16 v[156:157], v218 offset:1024
    s_add_u32 s73, s73, s55
    v_mfma_f32_16x16x32_bf16 v[104:107], v[200:203], v[212:215], v[104:107]
    ds_read_b64_tr_b16 v[158:159], v218 offset:13312
    v_and_b32 v251, s3, v250
    v_mfma_f32_16x16x32_bf16 v[4:7], v[200:203], v[172:175], v[4:7]
    buffer_load_dwordx4 v220, s[4:7], s42 offen lds
    v_mfma_f32_16x16x32_bf16 v[40:43], v[204:207], v[172:175], v[40:43]
    ds_read_b128 v[116:119], v216 offset:0
    s_mul_i32 s73, s73, 60416
    v_mfma_f32_16x16x32_bf16 v[44:47], v[204:207], v[176:179], v[44:47]
    v_add_u32 v217, 0xa800, v217
    v_mfma_f32_16x16x32_bf16 v[8:11], v[200:203], v[176:179], v[8:11]
    buffer_load_dwordx4 v221, s[4:7], s42 offen offset:1024 lds
    v_mfma_f32_16x16x32_bf16 v[12:15], v[200:203], v[180:183], v[12:15]
    ds_read_b128 v[120:123], v216 offset:2048
    ds_read_b64_tr_b16 v[152:153], v218 offset:0
    v_mfma_f32_16x16x32_bf16 v[48:51], v[204:207], v[180:183], v[48:51]
    ds_read_b64_tr_b16 v[154:155], v218 offset:12288
    s_add_u32 s73, s73, 131072
    v_mfma_f32_16x16x32_bf16 v[52:55], v[204:207], v[184:187], v[52:55]
    buffer_load_dwordx4 v222, s[4:7], s42 offen offset:2048 lds
    v_mfma_f32_16x16x32_bf16 v[16:19], v[200:203], v[184:187], v[16:19]
    ds_read_b128 v[124:127], v216 offset:4096
    s_mul_i32 s54, s32, 11264
    v_mfma_f32_16x16x32_bf16 v[20:23], v[200:203], v[188:191], v[20:23]
    ds_read_b128 v[128:131], v216 offset:6144
    ds_read_b128 v[132:135], v216 offset:8192
    v_mfma_f32_16x16x32_bf16 v[56:59], v[204:207], v[188:191], v[56:59]
    buffer_load_dwordx4 v223, s[4:7], s42 offen offset:3072 lds
    v_mfma_f32_16x16x32_bf16 v[60:63], v[204:207], v[192:195], v[60:63]
    ds_read_b128 v[136:139], v216 offset:10240
    v_accvgpr_write_b32 a245, v251
    v_mfma_f32_16x16x32_bf16 v[24:27], v[200:203], v[192:195], v[24:27]
    ds_read_b128 v[140:143], v216 offset:12288
    v_add_u32 v241, s54, v240
    v_mfma_f32_16x16x32_bf16 v[28:31], v[200:203], v[196:199], v[28:31]
    ds_read_b128 v[144:147], v216 offset:14336
    s_add_u32 m0, s45, 0
    v_mfma_f32_16x16x32_bf16 v[64:67], v[204:207], v[196:199], v[64:67]
    s_cmp_eq_u32 s32, 3
    s_cselect_b32 s54, 5, 6
    v_mfma_f32_16x16x32_bf16 v[100:103], v[196:199], v[208:211], v[100:103]
    ds_read_b128 v[148:151], v216 offset:16384
    ds_read_b64_tr_b16 v[160:161], v218 offset:2048
    v_mfma_f32_16x16x32_bf16 v[96:99], v[192:195], v[208:211], v[96:99]
    s_mov_b64 exec, s[48:49]
    buffer_load_dwordx4 v224, s[4:7], s42 offen lds
    s_mov_b64 exec, -1
    v_mfma_f32_16x16x32_bf16 v[92:95], v[188:191], v[208:211], v[92:95]
    ds_read_b64_tr_b16 v[162:163], v218 offset:14336
    v_mfma_f32_16x16x32_bf16 v[88:91], v[184:187], v[208:211], v[88:91]
    v_lshl_add_u32 v242, s54, 10, v241
    v_mfma_f32_16x16x32_bf16 v[84:87], v[180:183], v[208:211], v[84:87]
    v_lshlrev_b32 v250, 1, v250
    s_add_u32 m0, s44, 0
    v_mfma_f32_16x16x32_bf16 v[80:83], v[176:179], v[208:211], v[80:83]
    v_mfma_f32_16x16x32_bf16 v[76:79], v[172:175], v[208:211], v[76:79]
    v_and_b32 v252, 15, v239
    v_mfma_f32_16x16x32_bf16 v[72:75], v[168:171], v[208:211], v[72:75]
    buffer_load_dwordx4 v225, s[8:11], s36 offen lds
    v_mfma_f32_16x16x32_bf16 v[68:71], v[164:167], v[208:211], v[68:71]
    s_waitcnt lgkmcnt(0)
    v_mfma_f32_16x16x32_bf16 v[32:35], v[156:159], v[116:119], v[32:35]
    ds_read_b64_tr_b16 v[204:205], v218 offset:4096
    v_mfma_f32_16x16x32_bf16 v[36:39], v[156:159], v[120:123], v[36:39]
    buffer_load_dwordx4 v225, s[8:11], s37 offen offset:1024 lds
    v_mfma_f32_16x16x32_bf16 v[0:3], v[152:155], v[120:123], v[0:3]
    ds_read_b64_tr_b16 v[206:207], v218 offset:16384
    s_lshl_b32 s54, s68, 6
    v_mfma_f32_16x16x32_bf16 v[104:107], v[152:155], v[212:215], v[104:107]
    ds_read_b128 v[164:167], v217 offset:0
    v_and_b32 v251, s3, v250
    v_mfma_f32_16x16x32_bf16 v[4:7], v[152:155], v[124:127], v[4:7]
    ds_read_b128 v[168:171], v217 offset:2048
    s_lshl_b32 s55, s32, 4
    v_mfma_f32_16x16x32_bf16 v[40:43], v[156:159], v[124:127], v[40:43]
    buffer_load_dwordx4 v225, s[8:11], s38 offen offset:2048 lds
    v_mfma_f32_16x16x32_bf16 v[44:47], v[156:159], v[128:131], v[44:47]
    ds_read_b64_tr_b16 v[200:201], v218 offset:3072
    v_mfma_f32_16x16x32_bf16 v[8:11], v[152:155], v[128:131], v[8:11]
    ds_read_b64_tr_b16 v[202:203], v218 offset:15360
    v_mfma_f32_16x16x32_bf16 v[12:15], v[152:155], v[132:135], v[12:15]
    s_add_u32 s54, s54, s55
    s_add_u32 m0, s44, 3072
    v_mfma_f32_16x16x32_bf16 v[48:51], v[156:159], v[132:135], v[48:51]
    ds_read_b128 v[172:175], v217 offset:4096
    v_mfma_f32_16x16x32_bf16 v[52:55], v[156:159], v[136:139], v[52:55]
    ds_read_b128 v[176:179], v217 offset:6144
    v_mfma_f32_16x16x32_bf16 v[16:19], v[152:155], v[136:139], v[16:19]
    buffer_load_dwordx4 v225, s[8:11], s39 offen lds
    v_mfma_f32_16x16x32_bf16 v[20:23], v[152:155], v[140:143], v[20:23]
    ds_read_b128 v[180:183], v217 offset:8192
    v_add_u32 v252, s54, v252
    v_mfma_f32_16x16x32_bf16 v[56:59], v[156:159], v[140:143], v[56:59]
    ds_read_b128 v[184:187], v217 offset:10240
    v_accvgpr_write_b32 a246, v251
    v_mfma_f32_16x16x32_bf16 v[60:63], v[156:159], v[144:147], v[60:63]
    ds_read_b128 v[188:191], v217 offset:12288
    v_lshlrev_b32 v252, 10, v252
    v_mfma_f32_16x16x32_bf16 v[24:27], v[152:155], v[144:147], v[24:27]
    buffer_load_dwordx4 v225, s[8:11], s40 offen offset:1024 lds
    v_mfma_f32_16x16x32_bf16 v[28:31], v[152:155], v[148:151], v[28:31]
    ds_read_b128 v[192:195], v217 offset:14336
    v_mfma_f32_16x16x32_bf16 v[64:67], v[156:159], v[148:151], v[64:67]
    ds_read_b128 v[196:199], v217 offset:16384
    v_mfma_f32_16x16x32_bf16 v[100:103], v[148:151], v[160:163], v[100:103]
    buffer_load_dwordx4 v225, s[8:11], s41 offen offset:2048 lds
    v_mfma_f32_16x16x32_bf16 v[96:99], v[144:147], v[160:163], v[96:99]
    ds_read_b64_tr_b16 v[208:209], v218 offset:5120
    v_lshrrev_b32 v253, 4, v239
    v_mfma_f32_16x16x32_bf16 v[92:95], v[140:143], v[160:163], v[92:95]
    ds_read_b64_tr_b16 v[210:211], v218 offset:17408
    v_mfma_f32_16x16x32_bf16 v[88:91], v[136:139], v[160:163], v[88:91]
    s_lshl_b32 s55, s69, 7
    v_add_u32 v225, s46, v225
    v_mfma_f32_16x16x32_bf16 v[84:87], v[132:135], v[160:163], v[84:87]
    v_lshlrev_b32 v250, 1, v250
    v_mfma_f32_16x16x32_bf16 v[80:83], v[128:131], v[160:163], v[80:83]
    v_mfma_f32_16x16x32_bf16 v[76:79], v[124:127], v[160:163], v[76:79]
    v_mfma_f32_16x16x32_bf16 v[72:75], v[120:123], v[160:163], v[72:75]
    v_lshl_add_u32 v226, v253, 3, v252
    s_add_u32 s42, s42, 128
    v_mfma_f32_16x16x32_bf16 v[68:71], v[116:119], v[160:163], v[68:71]
    s_waitcnt lgkmcnt(0)
    s_waitcnt vmcnt(11)
    s_barrier
    v_mfma_f32_16x16x32_bf16 v[32:35], v[204:207], v[164:167], v[32:35]
    v_add_u32 v218, 0xa800, v218
    v_mfma_f32_16x16x32_bf16 v[36:39], v[204:207], v[168:171], v[36:39]
    v_add_u32 v216, 0xa800, v216
    s_add_u32 m0, s43, 43008
    v_mfma_f32_16x16x32_bf16 v[0:3], v[200:203], v[168:171], v[0:3]
    ds_read_b64_tr_b16 v[156:157], v218 offset:1024
    v_add_u32 v226, s55, v226
    v_mfma_f32_16x16x32_bf16 v[104:107], v[200:203], v[212:215], v[104:107]
    ds_read_b64_tr_b16 v[158:159], v218 offset:13312
    v_mfma_f32_16x16x32_bf16 v[4:7], v[200:203], v[172:175], v[4:7]
    buffer_load_dwordx4 v220, s[4:7], s42 offen lds
    v_mfma_f32_16x16x32_bf16 v[40:43], v[204:207], v[172:175], v[40:43]
    ds_read_b128 v[116:119], v216 offset:0
    v_and_b32 v237, 1, v253
    v_mfma_f32_16x16x32_bf16 v[44:47], v[204:207], v[176:179], v[44:47]
    v_add_u32 v217, 0xa800, v217
    v_and_b32 v251, s3, v250
    v_mfma_f32_16x16x32_bf16 v[8:11], v[200:203], v[176:179], v[8:11]
    buffer_load_dwordx4 v221, s[4:7], s42 offen offset:1024 lds
    v_mfma_f32_16x16x32_bf16 v[12:15], v[200:203], v[180:183], v[12:15]
    ds_read_b128 v[120:123], v216 offset:2048
    ds_read_b64_tr_b16 v[152:153], v218 offset:0
    v_mfma_f32_16x16x32_bf16 v[48:51], v[204:207], v[180:183], v[48:51]
    ds_read_b64_tr_b16 v[154:155], v218 offset:12288
    v_lshlrev_b32 v237, 5, v237
    v_mfma_f32_16x16x32_bf16 v[52:55], v[204:207], v[184:187], v[52:55]
    buffer_load_dwordx4 v222, s[4:7], s42 offen offset:2048 lds
    v_mfma_f32_16x16x32_bf16 v[16:19], v[200:203], v[184:187], v[16:19]
    ds_read_b128 v[124:127], v216 offset:4096
    v_lshrrev_b32 v253, 1, v253
    v_mfma_f32_16x16x32_bf16 v[20:23], v[200:203], v[188:191], v[20:23]
    ds_read_b128 v[128:131], v216 offset:6144
    ds_read_b128 v[132:135], v216 offset:8192
    v_mfma_f32_16x16x32_bf16 v[56:59], v[204:207], v[188:191], v[56:59]
    buffer_load_dwordx4 v223, s[4:7], s42 offen offset:3072 lds
    v_mfma_f32_16x16x32_bf16 v[60:63], v[204:207], v[192:195], v[60:63]
    ds_read_b128 v[136:139], v216 offset:10240
    v_mfma_f32_16x16x32_bf16 v[24:27], v[200:203], v[192:195], v[24:27]
    ds_read_b128 v[140:143], v216 offset:12288
    v_lshl_add_u32 v237, v253, 4, v237
    v_mfma_f32_16x16x32_bf16 v[28:31], v[200:203], v[196:199], v[28:31]
    ds_read_b128 v[144:147], v216 offset:14336
    s_add_u32 m0, s45, 43008
    v_mfma_f32_16x16x32_bf16 v[64:67], v[204:207], v[196:199], v[64:67]
    v_add3_u32 v237, v237, v252, s55
    v_mfma_f32_16x16x32_bf16 v[100:103], v[196:199], v[208:211], v[100:103]
    ds_read_b128 v[148:151], v216 offset:16384
    ds_read_b64_tr_b16 v[160:161], v218 offset:2048
    v_mfma_f32_16x16x32_bf16 v[96:99], v[192:195], v[208:211], v[96:99]
    s_mov_b64 exec, s[48:49]
    buffer_load_dwordx4 v224, s[4:7], s42 offen lds
    s_mov_b64 exec, -1
    v_mfma_f32_16x16x32_bf16 v[92:95], v[188:191], v[208:211], v[92:95]
    ds_read_b64_tr_b16 v[162:163], v218 offset:14336
    v_accvgpr_write_b32 a247, v251
    v_mfma_f32_16x16x32_bf16 v[88:91], v[184:187], v[208:211], v[88:91]
    v_and_b32 v236, 3, v239
    v_mfma_f32_16x16x32_bf16 v[84:87], v[180:183], v[208:211], v[84:87]
    s_add_u32 m0, s44, 43008
    v_mfma_f32_16x16x32_bf16 v[80:83], v[176:179], v[208:211], v[80:83]
    v_mfma_f32_16x16x32_bf16 v[76:79], v[172:175], v[208:211], v[76:79]
    v_lshlrev_b32 v236, 3, v236
    v_mfma_f32_16x16x32_bf16 v[72:75], v[168:171], v[208:211], v[72:75]
    buffer_load_dwordx4 v225, s[8:11], s36 offen lds
    v_mfma_f32_16x16x32_bf16 v[68:71], v[164:167], v[208:211], v[68:71]
    s_waitcnt lgkmcnt(0)
    v_mfma_f32_16x16x32_bf16 v[32:35], v[156:159], v[116:119], v[32:35]
    ds_read_b64_tr_b16 v[204:205], v218 offset:4096
    v_lshrrev_b32 v252, 4, v239
    v_mfma_f32_16x16x32_bf16 v[36:39], v[156:159], v[120:123], v[36:39]
    buffer_load_dwordx4 v225, s[8:11], s37 offen offset:1024 lds
    v_mfma_f32_16x16x32_bf16 v[0:3], v[152:155], v[120:123], v[0:3]
    ds_read_b64_tr_b16 v[206:207], v218 offset:16384
    v_mfma_f32_16x16x32_bf16 v[104:107], v[152:155], v[212:215], v[104:107]
    ds_read_b128 v[164:167], v217 offset:0
    v_mfma_f32_16x16x32_bf16 v[4:7], v[152:155], v[124:127], v[4:7]
    ds_read_b128 v[168:171], v217 offset:2048
    v_lshlrev_b32 v252, 1, v252
    v_mfma_f32_16x16x32_bf16 v[40:43], v[156:159], v[124:127], v[40:43]
    buffer_load_dwordx4 v225, s[8:11], s38 offen offset:2048 lds
    v_mfma_f32_16x16x32_bf16 v[44:47], v[156:159], v[128:131], v[44:47]
    ds_read_b64_tr_b16 v[200:201], v218 offset:3072
    v_and_b32 v253, 7, v239
    v_mfma_f32_16x16x32_bf16 v[8:11], v[152:155], v[128:131], v[8:11]
    ds_read_b64_tr_b16 v[202:203], v218 offset:15360
    v_mfma_f32_16x16x32_bf16 v[12:15], v[152:155], v[132:135], v[12:15]
    s_add_u32 m0, s44, 46080
    v_mfma_f32_16x16x32_bf16 v[48:51], v[156:159], v[132:135], v[48:51]
    ds_read_b128 v[172:175], v217 offset:4096
    v_xor_b32 v252, v252, v253
    v_mfma_f32_16x16x32_bf16 v[52:55], v[156:159], v[136:139], v[52:55]
    ds_read_b128 v[176:179], v217 offset:6144
    v_mfma_f32_16x16x32_bf16 v[16:19], v[152:155], v[136:139], v[16:19]
    buffer_load_dwordx4 v225, s[8:11], s39 offen lds
    v_mfma_f32_16x16x32_bf16 v[20:23], v[152:155], v[140:143], v[20:23]
    ds_read_b128 v[180:183], v217 offset:8192
    v_lshlrev_b32 v252, 4, v252
    v_mfma_f32_16x16x32_bf16 v[56:59], v[156:159], v[140:143], v[56:59]
    ds_read_b128 v[184:187], v217 offset:10240
    v_mfma_f32_16x16x32_bf16 v[60:63], v[156:159], v[144:147], v[60:63]
    ds_read_b128 v[188:191], v217 offset:12288
    v_lshrrev_b32 v253, 3, v239
    v_mfma_f32_16x16x32_bf16 v[24:27], v[152:155], v[144:147], v[24:27]
    buffer_load_dwordx4 v225, s[8:11], s40 offen offset:1024 lds
    v_mfma_f32_16x16x32_bf16 v[28:31], v[152:155], v[148:151], v[28:31]
    ds_read_b128 v[192:195], v217 offset:14336
    v_mfma_f32_16x16x32_bf16 v[64:67], v[156:159], v[148:151], v[64:67]
    ds_read_b128 v[196:199], v217 offset:16384
    v_lshl_add_u32 v252, v253, 10, v252
    v_mfma_f32_16x16x32_bf16 v[100:103], v[148:151], v[160:163], v[100:103]
    buffer_load_dwordx4 v225, s[8:11], s41 offen offset:2048 lds
    v_mfma_f32_16x16x32_bf16 v[96:99], v[144:147], v[160:163], v[96:99]
    ds_read_b64_tr_b16 v[208:209], v218 offset:5120
    v_mfma_f32_16x16x32_bf16 v[92:95], v[140:143], v[160:163], v[92:95]
    ds_read_b64_tr_b16 v[210:211], v218 offset:17408
    s_lshl_b32 s54, s69, 7
    v_mfma_f32_16x16x32_bf16 v[88:91], v[136:139], v[160:163], v[88:91]
    v_add_u32 v225, s46, v225
    v_mfma_f32_16x16x32_bf16 v[84:87], v[132:135], v[160:163], v[84:87]
    v_add_u32 v220, s54, v252
    v_mfma_f32_16x16x32_bf16 v[80:83], v[128:131], v[160:163], v[80:83]
    v_mfma_f32_16x16x32_bf16 v[76:79], v[124:127], v[160:163], v[76:79]
    v_mfma_f32_16x16x32_bf16 v[72:75], v[120:123], v[160:163], v[72:75]
    v_add_u32 v221, 7168, v220
    s_add_u32 s42, s42, 128
    v_mfma_f32_16x16x32_bf16 v[68:71], v[116:119], v[160:163], v[68:71]
    s_waitcnt lgkmcnt(0)
    s_waitcnt vmcnt(11)
    s_barrier
    v_mfma_f32_16x16x32_bf16 v[32:35], v[204:207], v[164:167], v[32:35]
    v_add_u32 v218, 0xfffeb000, v218
    s_mul_i32 s36, s32, 360448
    v_mfma_f32_16x16x32_bf16 v[36:39], v[204:207], v[168:171], v[36:39]
    v_add_u32 v216, 0xfffeb000, v216
    s_mul_i32 s55, s32, 10752
    v_mfma_f32_16x16x32_bf16 v[0:3], v[200:203], v[168:171], v[0:3]
    ds_read_b64_tr_b16 v[156:157], v218 offset:1024
    v_mfma_f32_16x16x32_bf16 v[104:107], v[200:203], v[212:215], v[104:107]
    ds_read_b64_tr_b16 v[158:159], v218 offset:13312
    s_add_u32 s44, s55, 0
    v_mfma_f32_16x16x32_bf16 v[4:7], v[200:203], v[172:175], v[4:7]
    s_cmp_eq_u32 s32, 3
    s_cselect_b32 s37, 5, 6
    s_cselect_b32 s38, 1073741824, s36
    v_mfma_f32_16x16x32_bf16 v[40:43], v[204:207], v[172:175], v[40:43]
    ds_read_b128 v[116:119], v216 offset:0
    s_lshl_b32 s37, s37, 15
    v_mfma_f32_16x16x32_bf16 v[44:47], v[204:207], v[176:179], v[44:47]
    v_add_u32 v217, 0xfffeb000, v217
    v_mfma_f32_16x16x32_bf16 v[8:11], v[200:203], v[176:179], v[8:11]
    ds_read_b128 v[120:123], v216 offset:2048
    s_add_u32 s37, s37, s36
    v_mfma_f32_16x16x32_bf16 v[12:15], v[200:203], v[180:183], v[12:15]
    ds_read_b64_tr_b16 v[152:153], v218 offset:0
    s_lshl_b32 s39, s32, 17
    v_mfma_f32_16x16x32_bf16 v[48:51], v[204:207], v[180:183], v[48:51]
    ds_read_b64_tr_b16 v[154:155], v218 offset:12288
    s_lshl_b32 s55, s68, 2
    v_mfma_f32_16x16x32_bf16 v[52:55], v[204:207], v[184:187], v[52:55]
    s_add_u32 s55, s55, s32
    v_mfma_f32_16x16x32_bf16 v[16:19], v[200:203], v[184:187], v[16:19]
    ds_read_b128 v[124:127], v216 offset:4096
    v_mfma_f32_16x16x32_bf16 v[20:23], v[200:203], v[188:191], v[20:23]
    ds_read_b128 v[128:131], v216 offset:6144
    s_lshl_b32 s55, s55, 7
    v_mfma_f32_16x16x32_bf16 v[56:59], v[204:207], v[188:191], v[56:59]
    ds_read_b128 v[132:135], v216 offset:8192
    s_add_u32 s41, s55, 32768
    v_mfma_f32_16x16x32_bf16 v[60:63], v[204:207], v[192:195], v[60:63]
    s_add_u32 s53, s36, 0
    s_add_u32 m0, s44, 86016
    v_mfma_f32_16x16x32_bf16 v[24:27], v[200:203], v[192:195], v[24:27]
    ds_read_b128 v[136:139], v216 offset:10240
    ds_read_b128 v[140:143], v216 offset:12288
    v_mfma_f32_16x16x32_bf16 v[28:31], v[200:203], v[196:199], v[28:31]
    buffer_load_dwordx4 v220, s[20:23], s53 offen lds
    v_mfma_f32_16x16x32_bf16 v[64:67], v[204:207], v[196:199], v[64:67]
    buffer_load_dwordx4 v221, s[20:23], s53 offen offset:1024 lds
    v_mfma_f32_16x16x32_bf16 v[100:103], v[196:199], v[208:211], v[100:103]
    s_add_u32 s53, s36, 16384
    s_add_u32 m0, s44, 88064
    v_mfma_f32_16x16x32_bf16 v[96:99], v[192:195], v[208:211], v[96:99]
    buffer_load_dwordx4 v220, s[20:23], s53 offen lds
    v_mfma_f32_16x16x32_bf16 v[92:95], v[188:191], v[208:211], v[92:95]
    ds_read_b128 v[144:147], v216 offset:14336
    ds_read_b128 v[148:151], v216 offset:16384
    ds_read_b64_tr_b16 v[160:161], v218 offset:2048
    ds_read_b64_tr_b16 v[162:163], v218 offset:14336
    v_mfma_f32_16x16x32_bf16 v[88:91], v[184:187], v[208:211], v[88:91]
    buffer_load_dwordx4 v[232:235], v227, s[12:15], 0 offen sc1
    v_mfma_f32_16x16x32_bf16 v[84:87], v[180:183], v[208:211], v[84:87]
    buffer_load_dwordx4 v221, s[20:23], s53 offen offset:1024 lds
    v_mfma_f32_16x16x32_bf16 v[80:83], v[176:179], v[208:211], v[80:83]
    s_add_u32 s53, s36, 32768
    s_add_u32 m0, s44, 90112
    v_mfma_f32_16x16x32_bf16 v[76:79], v[172:175], v[208:211], v[76:79]
    v_mfma_f32_16x16x32_bf16 v[72:75], v[168:171], v[208:211], v[72:75]
    buffer_load_dwordx4 v220, s[20:23], s53 offen lds
    v_mfma_f32_16x16x32_bf16 v[68:71], v[164:167], v[208:211], v[68:71]
    buffer_load_dwordx4 v221, s[20:23], s53 offen offset:1024 lds
    s_waitcnt lgkmcnt(0)
    v_mfma_f32_16x16x32_bf16 v[32:35], v[156:159], v[116:119], v[32:35]
    ds_read_b64_tr_b16 v[204:205], v218 offset:4096
    v_bfe_u32 v252, v239, 2, 2
    v_mfma_f32_16x16x32_bf16 v[36:39], v[156:159], v[120:123], v[36:39]
    ds_read_b64_tr_b16 v[206:207], v218 offset:16384
    v_lshrrev_b32 v253, 4, v239
    v_mfma_f32_16x16x32_bf16 v[0:3], v[152:155], v[120:123], v[0:3]
    s_add_u32 s53, s36, 49152
    s_add_u32 m0, s44, 92160
    v_mfma_f32_16x16x32_bf16 v[104:107], v[152:155], v[212:215], v[104:107]
    ds_read_b128 v[164:167], v217 offset:0
    v_mov_b32 v250, s58
    v_mov_b32 v251, s59
    s_mov_b64 exec, 1
    buffer_store_dwordx2 v[250:251], off, s[12:15], s51 sc1
    s_mov_b64 exec, -1
    v_mfma_f32_16x16x32_bf16 v[4:7], v[152:155], v[124:127], v[4:7]
    ds_read_b128 v[168:171], v217 offset:2048
    v_lshl_add_u32 v254, v253, 2, v252
    v_mfma_f32_16x16x32_bf16 v[40:43], v[156:159], v[124:127], v[40:43]
    ds_read_b64_tr_b16 v[200:201], v218 offset:3072
    v_mfma_f32_16x16x32_bf16 v[44:47], v[156:159], v[128:131], v[44:47]
    buffer_load_dwordx4 v220, s[20:23], s53 offen lds
    v_mfma_f32_16x16x32_bf16 v[8:11], v[152:155], v[128:131], v[8:11]
    ds_read_b64_tr_b16 v[202:203], v218 offset:15360
    v_bfe_u32 v255, v254, 1, 2
    v_mfma_f32_16x16x32_bf16 v[12:15], v[152:155], v[132:135], v[12:15]
    v_lshlrev_b32 v255, 5, v255
    v_mfma_f32_16x16x32_bf16 v[48:51], v[156:159], v[132:135], v[48:51]
    ds_read_b128 v[172:175], v217 offset:4096
    v_mfma_f32_16x16x32_bf16 v[52:55], v[156:159], v[136:139], v[52:55]
    ds_read_b128 v[176:179], v217 offset:6144
    v_lshl_add_u32 v255, v254, 7, v255
    v_mfma_f32_16x16x32_bf16 v[16:19], v[152:155], v[136:139], v[16:19]
    buffer_load_dwordx4 v221, s[20:23], s53 offen offset:1024 lds
    v_mfma_f32_16x16x32_bf16 v[20:23], v[152:155], v[140:143], v[20:23]
    ds_read_b128 v[180:183], v217 offset:8192
    v_and_b32 v252, 3, v239
    v_mfma_f32_16x16x32_bf16 v[56:59], v[156:159], v[140:143], v[56:59]
    ds_read_b128 v[184:187], v217 offset:10240
    v_mfma_f32_16x16x32_bf16 v[60:63], v[156:159], v[144:147], v[60:63]
    ds_read_b128 v[188:191], v217 offset:12288
    v_lshl_add_u32 v255, v252, 3, v255
    v_mfma_f32_16x16x32_bf16 v[24:27], v[152:155], v[144:147], v[24:27]
    s_add_u32 s53, s37, 0
    s_add_u32 m0, s44, 94208
    v_mfma_f32_16x16x32_bf16 v[28:31], v[152:155], v[148:151], v[28:31]
    ds_read_b128 v[192:195], v217 offset:14336
    s_mul_i32 s54, s32, 10752
    v_mfma_f32_16x16x32_bf16 v[64:67], v[156:159], v[148:151], v[64:67]
    ds_read_b128 v[196:199], v217 offset:16384
    v_mfma_f32_16x16x32_bf16 v[100:103], v[148:151], v[160:163], v[100:103]
    ds_read_b64_tr_b16 v[208:209], v218 offset:5120
    s_add_u32 s54, s54, 86016
    v_mfma_f32_16x16x32_bf16 v[96:99], v[144:147], v[160:163], v[96:99]
    ds_read_b64_tr_b16 v[210:211], v218 offset:17408
    v_add_u32 v228, s54, v255
    v_mfma_f32_16x16x32_bf16 v[92:95], v[140:143], v[160:163], v[92:95]
    buffer_load_dwordx4 v220, s[20:23], s53 offen lds
    v_mfma_f32_16x16x32_bf16 v[88:91], v[136:139], v[160:163], v[88:91]
    v_mfma_f32_16x16x32_bf16 v[84:87], v[132:135], v[160:163], v[84:87]
    v_xor_b32 v229, 32, v228
    v_mfma_f32_16x16x32_bf16 v[80:83], v[128:131], v[160:163], v[80:83]
    v_xor_b32 v230, 64, v228
    v_mfma_f32_16x16x32_bf16 v[76:79], v[124:127], v[160:163], v[76:79]
    buffer_load_dwordx4 v221, s[20:23], s53 offen offset:1024 lds
    v_mfma_f32_16x16x32_bf16 v[72:75], v[120:123], v[160:163], v[72:75]
    v_mfma_f32_16x16x32_bf16 v[68:71], v[116:119], v[160:163], v[68:71]
    v_xor_b32 v231, 96, v228
    s_waitcnt lgkmcnt(0)
    s_waitcnt vmcnt(12)
    s_barrier
    v_mfma_f32_16x16x32_bf16 v[32:35], v[204:207], v[164:167], v[32:35]
    v_add_u32 v218, 0xa800, v218
    v_mfma_f32_16x16x32_bf16 v[36:39], v[204:207], v[168:171], v[36:39]
    s_add_u32 s53, s37, 16384
    s_add_u32 m0, s44, 0
    v_mfma_f32_16x16x32_bf16 v[0:3], v[200:203], v[168:171], v[0:3]
    v_add_u32 v216, 0xa800, v216
    ds_read_b64_tr_b16 v[156:157], v218 offset:1024
    v_mfma_f32_16x16x32_bf16 v[104:107], v[200:203], v[212:215], v[104:107]
    ds_read_b64_tr_b16 v[158:159], v218 offset:13312
    v_mfma_f32_16x16x32_bf16 v[4:7], v[200:203], v[172:175], v[4:7]
    buffer_load_dwordx4 v220, s[20:23], s53 offen lds
    v_mfma_f32_16x16x32_bf16 v[40:43], v[204:207], v[172:175], v[40:43]
    ds_read_b128 v[116:119], v216 offset:0
    v_mfma_f32_16x16x32_bf16 v[44:47], v[204:207], v[176:179], v[44:47]
    v_add_u32 v217, 0xa800, v217
    v_mfma_f32_16x16x32_bf16 v[8:11], v[200:203], v[176:179], v[8:11]
    buffer_load_dwordx4 v221, s[20:23], s53 offen offset:1024 lds
    v_mfma_f32_16x16x32_bf16 v[12:15], v[200:203], v[180:183], v[12:15]
    ds_read_b128 v[120:123], v216 offset:2048
    ds_read_b64_tr_b16 v[152:153], v218 offset:0
    v_mfma_f32_16x16x32_bf16 v[48:51], v[204:207], v[180:183], v[48:51]
    ds_read_b64_tr_b16 v[154:155], v218 offset:12288
    v_mfma_f32_16x16x32_bf16 v[52:55], v[204:207], v[184:187], v[52:55]
    s_add_u32 s53, s37, 32768
    s_add_u32 m0, s44, 2048
    v_mfma_f32_16x16x32_bf16 v[16:19], v[200:203], v[184:187], v[16:19]
    ds_read_b128 v[124:127], v216 offset:4096
    v_mfma_f32_16x16x32_bf16 v[20:23], v[200:203], v[188:191], v[20:23]
    ds_read_b128 v[128:131], v216 offset:6144
    ds_read_b128 v[132:135], v216 offset:8192
    v_mfma_f32_16x16x32_bf16 v[56:59], v[204:207], v[188:191], v[56:59]
    buffer_load_dwordx4 v220, s[20:23], s53 offen lds
    v_mfma_f32_16x16x32_bf16 v[60:63], v[204:207], v[192:195], v[60:63]
    ds_read_b128 v[136:139], v216 offset:10240
    v_mfma_f32_16x16x32_bf16 v[24:27], v[200:203], v[192:195], v[24:27]
    ds_read_b128 v[140:143], v216 offset:12288
    v_mfma_f32_16x16x32_bf16 v[28:31], v[200:203], v[196:199], v[28:31]
    buffer_load_dwordx4 v221, s[20:23], s53 offen offset:1024 lds
    v_mfma_f32_16x16x32_bf16 v[64:67], v[204:207], v[196:199], v[64:67]
    ds_read_b128 v[144:147], v216 offset:14336
    v_mfma_f32_16x16x32_bf16 v[100:103], v[196:199], v[208:211], v[100:103]
    ds_read_b128 v[148:151], v216 offset:16384
    ds_read_b64_tr_b16 v[160:161], v218 offset:2048
    v_mfma_f32_16x16x32_bf16 v[96:99], v[192:195], v[208:211], v[96:99]
    s_add_u32 s53, s37, 49152
    s_add_u32 m0, s44, 4096
    v_mfma_f32_16x16x32_bf16 v[92:95], v[188:191], v[208:211], v[92:95]
    ds_read_b64_tr_b16 v[162:163], v218 offset:14336
    v_mfma_f32_16x16x32_bf16 v[88:91], v[184:187], v[208:211], v[88:91]
    v_mfma_f32_16x16x32_bf16 v[84:87], v[180:183], v[208:211], v[84:87]
    buffer_load_dwordx4 v220, s[20:23], s53 offen lds
    v_mfma_f32_16x16x32_bf16 v[80:83], v[176:179], v[208:211], v[80:83]
    v_mfma_f32_16x16x32_bf16 v[76:79], v[172:175], v[208:211], v[76:79]
    v_mfma_f32_16x16x32_bf16 v[72:75], v[168:171], v[208:211], v[72:75]
    buffer_load_dwordx4 v221, s[20:23], s53 offen offset:1024 lds
    v_mfma_f32_16x16x32_bf16 v[68:71], v[164:167], v[208:211], v[68:71]
    s_waitcnt lgkmcnt(0)
    v_mfma_f32_16x16x32_bf16 v[32:35], v[156:159], v[116:119], v[32:35]
    ds_read_b64_tr_b16 v[204:205], v218 offset:4096
    v_mfma_f32_16x16x32_bf16 v[36:39], v[156:159], v[120:123], v[36:39]
    ds_read_b64_tr_b16 v[206:207], v218 offset:16384
    s_waitcnt vmcnt(14)
    v_cmp_ne_u32 vcc, s58, v234
    v_cmp_ne_u32 s[66:67], s59, v235
    s_or_b64 vcc, vcc, s[66:67]
    s_cmp_eq_u64 vcc, 0
    s_cbranch_scc1 L_gat_ok_34
    s_mov_b32 s75, 0
L_gat_again_35:
    s_sleep 1
    buffer_load_dwordx4 v[232:235], v227, s[12:15], 0 offen sc1
    s_waitcnt vmcnt(0)
    v_cmp_ne_u32 vcc, s58, v234
    v_cmp_ne_u32 s[66:67], s59, v235
    s_or_b64 vcc, vcc, s[66:67]
    s_cmp_eq_u64 vcc, 0
    s_cbranch_scc1 L_gat_ok_34
    s_add_u32 s75, s75, 1
    s_cmp_lt_u32 s75, 4000
    s_cbranch_scc1 L_gat_again_35
L_gat_ok_34:
    ds_write_b32 v238, v232
    ds_write_b32 v238, v233 offset:576
    v_mfma_f32_16x16x32_bf16 v[0:3], v[152:155], v[120:123], v[0:3]
    s_add_u32 s53, s36, 65536
    s_add_u32 m0, s44, 6144
    v_mfma_f32_16x16x32_bf16 v[104:107], v[152:155], v[212:215], v[104:107]
    ds_read_b128 v[164:167], v217 offset:0
    v_mfma_f32_16x16x32_bf16 v[4:7], v[152:155], v[124:127], v[4:7]
    ds_read_b128 v[168:171], v217 offset:2048
    v_mfma_f32_16x16x32_bf16 v[40:43], v[156:159], v[124:127], v[40:43]
    ds_read_b64_tr_b16 v[200:201], v218 offset:3072
    v_mfma_f32_16x16x32_bf16 v[44:47], v[156:159], v[128:131], v[44:47]
    buffer_load_dwordx4 v220, s[20:23], s53 offen lds
    v_mfma_f32_16x16x32_bf16 v[8:11], v[152:155], v[128:131], v[8:11]
    ds_read_b64_tr_b16 v[202:203], v218 offset:15360
    v_mfma_f32_16x16x32_bf16 v[12:15], v[152:155], v[132:135], v[12:15]
    v_mfma_f32_16x16x32_bf16 v[48:51], v[156:159], v[132:135], v[48:51]
    ds_read_b128 v[172:175], v217 offset:4096
    v_mfma_f32_16x16x32_bf16 v[52:55], v[156:159], v[136:139], v[52:55]
    ds_read_b128 v[176:179], v217 offset:6144
    v_mfma_f32_16x16x32_bf16 v[16:19], v[152:155], v[136:139], v[16:19]
    buffer_load_dwordx4 v221, s[20:23], s53 offen offset:1024 lds
    v_mfma_f32_16x16x32_bf16 v[20:23], v[152:155], v[140:143], v[20:23]
    ds_read_b128 v[180:183], v217 offset:8192
    v_mfma_f32_16x16x32_bf16 v[56:59], v[156:159], v[140:143], v[56:59]
    ds_read_b128 v[184:187], v217 offset:10240
    v_mfma_f32_16x16x32_bf16 v[60:63], v[156:159], v[144:147], v[60:63]
    ds_read_b128 v[188:191], v217 offset:12288
    v_mfma_f32_16x16x32_bf16 v[24:27], v[152:155], v[144:147], v[24:27]
    s_add_u32 s53, s36, 81920
    s_add_u32 m0, s44, 8192
    v_mfma_f32_16x16x32_bf16 v[28:31], v[152:155], v[148:151], v[28:31]
    ds_read_b128 v[192:195], v217 offset:14336
    v_mfma_f32_16x16x32_bf16 v[64:67], v[156:159], v[148:151], v[64:67]
    ds_read_b128 v[196:199], v217 offset:16384
    v_mfma_f32_16x16x32_bf16 v[100:103], v[148:151], v[160:163], v[100:103]
    ds_read_b64_tr_b16 v[208:209], v218 offset:5120
    v_mfma_f32_16x16x32_bf16 v[96:99], v[144:147], v[160:163], v[96:99]
    ds_read_b64_tr_b16 v[210:211], v218 offset:17408
    v_mfma_f32_16x16x32_bf16 v[92:95], v[140:143], v[160:163], v[92:95]
    buffer_load_dwordx4 v220, s[20:23], s53 offen lds
    v_mfma_f32_16x16x32_bf16 v[88:91], v[136:139], v[160:163], v[88:91]
    v_mfma_f32_16x16x32_bf16 v[84:87], v[132:135], v[160:163], v[84:87]
    v_mfma_f32_16x16x32_bf16 v[80:83], v[128:131], v[160:163], v[80:83]
    v_mfma_f32_16x16x32_bf16 v[76:79], v[124:127], v[160:163], v[76:79]
    buffer_load_dwordx4 v221, s[20:23], s53 offen offset:1024 lds
    v_mfma_f32_16x16x32_bf16 v[72:75], v[120:123], v[160:163], v[72:75]
    v_mfma_f32_16x16x32_bf16 v[68:71], v[116:119], v[160:163], v[68:71]
    s_waitcnt lgkmcnt(0)
    s_barrier
    v_mfma_f32_16x16x32_bf16 v[32:35], v[204:207], v[164:167], v[32:35]
    v_mfma_f32_16x16x32_bf16 v[36:39], v[204:207], v[168:171], v[36:39]
    s_add_u32 s53, s36, 98304
    s_add_u32 m0, s44, 43008
    v_mfma_f32_16x16x32_bf16 v[0:3], v[200:203], v[168:171], v[0:3]
    v_mfma_f32_16x16x32_bf16 v[104:107], v[200:203], v[212:215], v[104:107]
    v_add_u32 v232, 0xfffeb000, v228
    v_mfma_f32_16x16x32_bf16 v[4:7], v[200:203], v[172:175], v[4:7]
    buffer_load_dwordx4 v220, s[20:23], s53 offen lds
    v_mfma_f32_16x16x32_bf16 v[40:43], v[204:207], v[172:175], v[40:43]
    v_mfma_f32_16x16x32_bf16 v[44:47], v[204:207], v[176:179], v[44:47]
    v_mfma_f32_16x16x32_bf16 v[8:11], v[200:203], v[176:179], v[8:11]
    buffer_load_dwordx4 v221, s[20:23], s53 offen offset:1024 lds
    v_mfma_f32_16x16x32_bf16 v[12:15], v[200:203], v[180:183], v[12:15]
    v_mfma_f32_16x16x32_bf16 v[48:51], v[204:207], v[180:183], v[48:51]
    v_add_u32 v233, 0xfffeb000, v229
L_pad_a3:
    s_cmp_eq_u32 s99, 1
    s_cbranch_scc1 L_padback_a
    s_waitcnt vmcnt(12)
    ds_read_b64_tr_b16 a[0:1], v228 offset:0
    v_mfma_f32_16x16x32_bf16 v[52:55], v[204:207], v[184:187], v[52:55]
    s_add_u32 s53, s36, 114688
    s_add_u32 m0, s44, 45056
    v_mfma_f32_16x16x32_bf16 v[16:19], v[200:203], v[184:187], v[16:19]
    ds_read_b64_tr_b16 a[4:5], v229 offset:0
    ds_read_b64_tr_b16 a[8:9], v230 offset:0
    v_mfma_f32_16x16x32_bf16 v[20:23], v[200:203], v[188:191], v[20:23]
    ds_read_b64_tr_b16 a[12:13], v231 offset:0
    v_mfma_f32_16x16x32_bf16 v[56:59], v[204:207], v[188:191], v[56:59]
    buffer_load_dwordx4 v220, s[20:23], s53 offen lds
    v_mfma_f32_16x16x32_bf16 v[60:63], v[204:207], v[192:195], v[60:63]
    ds_read_b64_tr_b16 a[2:3], v228 offset:2048
    ds_read_b64_tr_b16 a[6:7], v229 offset:2048
    v_mfma_f32_16x16x32_bf16 v[24:27], v[200:203], v[192:195], v[24:27]
    ds_read_b64_tr_b16 a[10:11], v230 offset:2048
    ds_read_b64_tr_b16 a[14:15], v231 offset:2048
    v_mfma_f32_16x16x32_bf16 v[28:31], v[200:203], v[196:199], v[28:31]
    buffer_load_dwordx4 v221, s[20:23], s53 offen offset:1024 lds
    v_mfma_f32_16x16x32_bf16 v[64:67], v[204:207], v[196:199], v[64:67]
    v_add_u32 v234, 0xfffeb000, v230
    ds_read_b64_tr_b16 a[16:17], v228 offset:4096
    v_mfma_f32_16x16x32_bf16 v[100:103], v[196:199], v[208:211], v[100:103]
    ds_read_b64_tr_b16 a[20:21], v229 offset:4096
    ds_read_b64_tr_b16 a[24:25], v230 offset:4096
    v_mfma_f32_16x16x32_bf16 v[96:99], v[192:195], v[208:211], v[96:99]
    s_add_u32 s53, s37, 65536
    s_add_u32 m0, s44, 47104
    v_mfma_f32_16x16x32_bf16 v[92:95], v[188:191], v[208:211], v[92:95]
    ds_read_b64_tr_b16 a[28:29], v231 offset:4096
    ds_read_b64_tr_b16 a[18:19], v228 offset:6144
    v_mfma_f32_16x16x32_bf16 v[88:91], v[184:187], v[208:211], v[88:91]
    ds_read_b64_tr_b16 a[22:23], v229 offset:6144
    ds_read_b64_tr_b16 a[26:27], v230 offset:6144
    v_mfma_f32_16x16x32_bf16 v[84:87], v[180:183], v[208:211], v[84:87]
    buffer_load_dwordx4 v220, s[20:23], s53 offen lds
    v_mfma_f32_16x16x32_bf16 v[80:83], v[176:179], v[208:211], v[80:83]
    v_add_u32 v235, 0xfffeb000, v231
    ds_read_b64_tr_b16 a[30:31], v231 offset:6144
    v_mfma_f32_16x16x32_bf16 v[76:79], v[172:175], v[208:211], v[76:79]
    ds_read_b64_tr_b16 a[32:33], v228 offset:8192
    ds_read_b64_tr_b16 a[36:37], v229 offset:8192
    v_mfma_f32_16x16x32_bf16 v[72:75], v[168:171], v[208:211], v[72:75]
    buffer_load_dwordx4 v221, s[20:23], s53 offen offset:1024 lds
    v_mfma_f32_16x16x32_bf16 v[68:71], v[164:167], v[208:211], v[68:71]
    ds_read_b64_tr_b16 a[40:41], v230 offset:8192
    ds_read_b64_tr_b16 a[44:45], v231 offset:8192
    v_and_b32 v244, 15, v239
    v_lshrrev_b32 v245, 4, v239
    v_lshlrev_b32 v252, 2, v244
    s_add_u32 s53, s37, 81920
    s_add_u32 m0, s44, 49152
    v_add_u32 v252, 161792, v252
    v_add_u32 v253, 256, v252
    v_lshlrev_b32 v254, 4, v245
    v_add_u32 v254, 161792, v254
    buffer_load_dwordx4 v220, s[20:23], s53 offen lds
    ds_read2_b32 v[116:117], v252 offset0:0 offset1:144
    ds_read2_b32 v[118:119], v252 offset0:16 offset1:160
    ds_read2_b32 v[120:121], v252 offset0:32 offset1:176
    ds_read2_b32 v[122:123], v252 offset0:48 offset1:192
    ds_read2_b32 v[124:125], v252 offset0:64 offset1:208
    ds_read2_b32 v[126:127], v252 offset0:80 offset1:224
    ds_read2_b32 v[128:129], v252 offset0:96 offset1:240
    ds_read2_b32 v[130:131], v253 offset0:48 offset1:192
    ds_read2_b32 v[132:133], v253 offset0:64 offset1:208
    ds_read_b128 v[134:137], v254 offset:0
    ds_read_b128 v[138:141], v254 offset:576
    ds_read_b128 v[142:145], v254 offset:64
    ds_read_b128 v[146:149], v254 offset:640
    ds_read_b128 v[150:153], v254 offset:128
    ds_read_b128 v[154:157], v254 offset:704
    v_mov_b32_dpp v108, v32 row_newbcast:0 row_mask:0xf bank_mask:0xf
    v_mov_b32_dpp v109, v33 row_newbcast:0 row_mask:0xf bank_mask:0xf
    v_mov_b32_dpp v110, v34 row_newbcast:0 row_mask:0xf bank_mask:0xf
    v_mov_b32_dpp v111, v35 row_newbcast:0 row_mask:0xf bank_mask:0xf
    buffer_load_dwordx4 v221, s[20:23], s53 offen offset:1024 lds
    v_mov_b32 v216, v68
    v_mov_b32 v217, v68
    v_and_b32 v246, 1, v244
    s_nop 0
    v_permlane16_swap_b32 v216, v217
    v_cmp_eq_u32 s[60:61], 1, v246
    s_add_u32 s53, s37, 98304
    s_add_u32 m0, s44, 51200
    v_lshl_add_u32 v245, v245, 2, v246
    v_mov_b32 v217, v216
    v_cmp_le_u32 s[62:63], v245, v244
    v_add_u32 v245, 2, v245
    buffer_load_dwordx4 v220, s[20:23], s53 offen lds
    v_permlane32_swap_b32 v216, v217
    v_cmp_le_u32 s[64:65], v245, v244
    v_mov_b32 v244, 0x0c0c0100
    v_mov_b32 v245, 0x01000c0c
    v_cndmask_b32 v244, v244, v245, s[60:61]
    buffer_load_dwordx4 v221, s[20:23], s53 offen offset:1024 lds
    v_mov_b32 v245, 0x0c0c0302
    v_mov_b32 v246, 0x03020c0c
    v_cndmask_b32 v245, v245, v246, s[60:61]
    v_mov_b32 v246, 0x0c0c0c0c
    s_waitcnt lgkmcnt(15)
    v_cndmask_b32 v248, v244, v246, s[62:63]
    v_cndmask_b32 v249, v245, v246, s[64:65]
    v_cndmask_b32 v250, v246, v244, s[62:63]
    v_cndmask_b32 v251, v246, v245, s[64:65]
    s_add_u32 s53, s37, 114688
    s_add_u32 m0, s44, 86016
    v_mov_b32 v247, 0xcf6e6b28
    s_cmp_eq_u32 s33, 0
    s_cselect_b64 s[66:67], -1, 0
    s_mov_b32 s47, 0x3eb8aa3b
    s_lshl_b32 s56, s32, 13
    s_add_u32 s56, s56, 129024
    v_lshl_add_u32 v255, v239, 3, s56
    s_waitcnt lgkmcnt(14)
    v_pk_fma_f32 v[32:33], v[108:109], v[116:117], v[32:33] op_sel:[0,0,0] op_sel_hi:[1,0,1]
    v_pk_fma_f32 v[34:35], v[110:111], v[116:117], v[34:35] op_sel:[0,0,0] op_sel_hi:[1,0,1]
    buffer_load_dwordx4 v220, s[20:23], s53 offen lds
    v_pk_mul_f32 v[32:33], v[32:33], v[116:117] op_sel:[0,1] op_sel_hi:[1,1]
    v_pk_mul_f32 v[34:35], v[34:35], v[116:117] op_sel:[0,1] op_sel_hi:[1,1]
    v_cvt_pk_bf16_f32 v176, v32, v33
    v_cvt_pk_bf16_f32 v177, v34, v35
    buffer_load_dwordx4 v221, s[20:23], s53 offen offset:1024 lds
    s_waitcnt lgkmcnt(13)
    v_pk_fma_f32 v[36:37], v[108:109], v[118:119], v[36:37] op_sel:[0,0,0] op_sel_hi:[1,0,1]
    v_pk_fma_f32 v[38:39], v[110:111], v[118:119], v[38:39] op_sel:[0,0,0] op_sel_hi:[1,0,1]
    v_pk_mul_f32 v[36:37], v[36:37], v[118:119] op_sel:[0,1] op_sel_hi:[1,1]
    v_pk_mul_f32 v[38:39], v[38:39], v[118:119] op_sel:[0,1] op_sel_hi:[1,1]
    s_add_u32 s53, s36, 131072
    s_add_u32 m0, s44, 88064
    v_cvt_pk_bf16_f32 v178, v36, v37
    v_cvt_pk_bf16_f32 v179, v38, v39
    s_waitcnt lgkmcnt(12)
    v_pk_fma_f32 v[40:41], v[108:109], v[120:121], v[40:41] op_sel:[0,0,0] op_sel_hi:[1,0,1]
    v_pk_fma_f32 v[42:43], v[110:111], v[120:121], v[42:43] op_sel:[0,0,0] op_sel_hi:[1,0,1]
    buffer_load_dwordx4 v220, s[20:23], s53 offen lds
    v_pk_mul_f32 v[40:41], v[40:41], v[120:121] op_sel:[0,1] op_sel_hi:[1,1]
    v_pk_mul_f32 v[42:43], v[42:43], v[120:121] op_sel:[0,1] op_sel_hi:[1,1]
    v_cvt_pk_bf16_f32 v180, v40, v41
    v_cvt_pk_bf16_f32 v181, v42, v43
    buffer_load_dwordx4 v221, s[20:23], s53 offen offset:1024 lds
    s_waitcnt lgkmcnt(11)
    v_pk_fma_f32 v[44:45], v[108:109], v[122:123], v[44:45] op_sel:[0,0,0] op_sel_hi:[1,0,1]
    v_pk_fma_f32 v[46:47], v[110:111], v[122:123], v[46:47] op_sel:[0,0,0] op_sel_hi:[1,0,1]
    v_pk_mul_f32 v[44:45], v[44:45], v[122:123] op_sel:[0,1] op_sel_hi:[1,1]
    v_pk_mul_f32 v[46:47], v[46:47], v[122:123] op_sel:[0,1] op_sel_hi:[1,1]
    s_add_u32 s53, s36, 147456
    s_add_u32 m0, s44, 90112
    v_cvt_pk_bf16_f32 v182, v44, v45
    v_cvt_pk_bf16_f32 v183, v46, v47
    s_waitcnt lgkmcnt(10)
    v_pk_fma_f32 v[48:49], v[108:109], v[124:125], v[48:49] op_sel:[0,0,0] op_sel_hi:[1,0,1]
    v_pk_fma_f32 v[50:51], v[110:111], v[124:125], v[50:51] op_sel:[0,0,0] op_sel_hi:[1,0,1]
    buffer_load_dwordx4 v220, s[20:23], s53 offen lds
    v_pk_mul_f32 v[48:49], v[48:49], v[124:125] op_sel:[0,1] op_sel_hi:[1,1]
    v_pk_mul_f32 v[50:51], v[50:51], v[124:125] op_sel:[0,1] op_sel_hi:[1,1]
    v_cvt_pk_bf16_f32 v184, v48, v49
    v_cvt_pk_bf16_f32 v185, v50, v51
    buffer_load_dwordx4 v221, s[20:23], s53 offen offset:1024 lds
    s_waitcnt lgkmcnt(9)
    v_pk_fma_f32 v[52:53], v[108:109], v[126:127], v[52:53] op_sel:[0,0,0] op_sel_hi:[1,0,1]
    v_pk_fma_f32 v[54:55], v[110:111], v[126:127], v[54:55] op_sel:[0,0,0] op_sel_hi:[1,0,1]
    v_pk_mul_f32 v[52:53], v[52:53], v[126:127] op_sel:[0,1] op_sel_hi:[1,1]
    v_pk_mul_f32 v[54:55], v[54:55], v[126:127] op_sel:[0,1] op_sel_hi:[1,1]
    s_add_u32 s53, s38, 163840
    s_add_u32 m0, s44, 92160
    v_cvt_pk_bf16_f32 v186, v52, v53
    v_cvt_pk_bf16_f32 v187, v54, v55
    s_waitcnt lgkmcnt(8)
    v_pk_fma_f32 v[56:57], v[108:109], v[128:129], v[56:57] op_sel:[0,0,0] op_sel_hi:[1,0,1]
    v_pk_fma_f32 v[58:59], v[110:111], v[128:129], v[58:59] op_sel:[0,0,0] op_sel_hi:[1,0,1]
    buffer_load_dwordx4 v220, s[20:23], s53 offen lds
    v_pk_mul_f32 v[56:57], v[56:57], v[128:129] op_sel:[0,1] op_sel_hi:[1,1]
    v_pk_mul_f32 v[58:59], v[58:59], v[128:129] op_sel:[0,1] op_sel_hi:[1,1]
    v_cvt_pk_bf16_f32 v188, v56, v57
    v_cvt_pk_bf16_f32 v189, v58, v59
    buffer_load_dwordx4 v221, s[20:23], s53 offen offset:1024 lds
    s_waitcnt lgkmcnt(7)
    v_pk_fma_f32 v[60:61], v[108:109], v[130:131], v[60:61] op_sel:[0,0,0] op_sel_hi:[1,0,1]
    v_pk_fma_f32 v[62:63], v[110:111], v[130:131], v[62:63] op_sel:[0,0,0] op_sel_hi:[1,0,1]
    v_pk_mul_f32 v[60:61], v[60:61], v[130:131] op_sel:[0,1] op_sel_hi:[1,1]
    v_pk_mul_f32 v[62:63], v[62:63], v[130:131] op_sel:[0,1] op_sel_hi:[1,1]
    s_add_u32 s53, s38, 180224
    s_add_u32 m0, s44, 94208
    v_cvt_pk_bf16_f32 v190, v60, v61
    v_cvt_pk_bf16_f32 v191, v62, v63
    s_waitcnt lgkmcnt(6)
    v_pk_fma_f32 v[64:65], v[108:109], v[132:133], v[64:65] op_sel:[0,0,0] op_sel_hi:[1,0,1]
    v_pk_fma_f32 v[66:67], v[110:111], v[132:133], v[66:67] op_sel:[0,0,0] op_sel_hi:[1,0,1]
    buffer_load_dwordx4 v220, s[20:23], s53 offen lds
    v_pk_mul_f32 v[64:65], v[64:65], v[132:133] op_sel:[0,1] op_sel_hi:[1,1]
    v_pk_mul_f32 v[66:67], v[66:67], v[132:133] op_sel:[0,1] op_sel_hi:[1,1]
    v_cvt_pk_bf16_f32 v192, v64, v65
    v_cvt_pk_bf16_f32 v193, v66, v67
    buffer_load_dwordx4 v221, s[20:23], s53 offen offset:1024 lds
    v_pk_fma_f32 v[0:1], v[104:105], v[118:119], v[0:1] op_sel:[0,0,0] op_sel_hi:[1,0,1]
    v_pk_fma_f32 v[2:3], v[106:107], v[118:119], v[2:3] op_sel:[0,0,0] op_sel_hi:[1,0,1]
    v_pk_mul_f32 v[0:1], v[0:1], v[118:119] op_sel:[0,1] op_sel_hi:[1,1]
    v_pk_mul_f32 v[2:3], v[2:3], v[118:119] op_sel:[0,1] op_sel_hi:[1,1]
    s_waitcnt vmcnt(20)
    v_cvt_pk_bf16_f32 v194, v0, v1
    v_cvt_pk_bf16_f32 v195, v2, v3
    v_pk_fma_f32 v[4:5], v[104:105], v[120:121], v[4:5] op_sel:[0,0,0] op_sel_hi:[1,0,1]
    v_pk_fma_f32 v[6:7], v[106:107], v[120:121], v[6:7] op_sel:[0,0,0] op_sel_hi:[1,0,1]
    ds_read_b64_tr_b16 a[34:35], v232 offset:0
    ds_read_b64_tr_b16 a[38:39], v233 offset:0
    v_pk_mul_f32 v[4:5], v[4:5], v[120:121] op_sel:[0,1] op_sel_hi:[1,1]
    v_pk_mul_f32 v[6:7], v[6:7], v[120:121] op_sel:[0,1] op_sel_hi:[1,1]
    v_cvt_pk_bf16_f32 v196, v4, v5
    v_cvt_pk_bf16_f32 v197, v6, v7
    ds_read_b64_tr_b16 a[42:43], v234 offset:0
    ds_read_b64_tr_b16 a[46:47], v235 offset:0
    v_pk_fma_f32 v[8:9], v[104:105], v[122:123], v[8:9] op_sel:[0,0,0] op_sel_hi:[1,0,1]
    v_pk_fma_f32 v[10:11], v[106:107], v[122:123], v[10:11] op_sel:[0,0,0] op_sel_hi:[1,0,1]
    v_pk_mul_f32 v[8:9], v[8:9], v[122:123] op_sel:[0,1] op_sel_hi:[1,1]
    v_pk_mul_f32 v[10:11], v[10:11], v[122:123] op_sel:[0,1] op_sel_hi:[1,1]
    ds_read_b64_tr_b16 a[48:49], v232 offset:2048
    ds_read_b64_tr_b16 a[52:53], v233 offset:2048
    v_cvt_pk_bf16_f32 v198, v8, v9
    v_cvt_pk_bf16_f32 v199, v10, v11
    v_pk_fma_f32 v[12:13], v[104:105], v[124:125], v[12:13] op_sel:[0,0,0] op_sel_hi:[1,0,1]
    v_pk_fma_f32 v[14:15], v[106:107], v[124:125], v[14:15] op_sel:[0,0,0] op_sel_hi:[1,0,1]
    ds_read_b64_tr_b16 a[56:57], v234 offset:2048
    ds_read_b64_tr_b16 a[60:61], v235 offset:2048
    v_pk_mul_f32 v[12:13], v[12:13], v[124:125] op_sel:[0,1] op_sel_hi:[1,1]
    v_pk_mul_f32 v[14:15], v[14:15], v[124:125] op_sel:[0,1] op_sel_hi:[1,1]
    v_cvt_pk_bf16_f32 v200, v12, v13
    v_cvt_pk_bf16_f32 v201, v14, v15
    ds_read_b64_tr_b16 a[50:51], v232 offset:4096
    ds_read_b64_tr_b16 a[54:55], v233 offset:4096
    v_pk_fma_f32 v[16:17], v[104:105], v[126:127], v[16:17] op_sel:[0,0,0] op_sel_hi:[1,0,1]
    v_pk_fma_f32 v[18:19], v[106:107], v[126:127], v[18:19] op_sel:[0,0,0] op_sel_hi:[1,0,1]
    v_pk_mul_f32 v[16:17], v[16:17], v[126:127] op_sel:[0,1] op_sel_hi:[1,1]
    v_pk_mul_f32 v[18:19], v[18:19], v[126:127] op_sel:[0,1] op_sel_hi:[1,1]
    ds_read_b64_tr_b16 a[58:59], v234 offset:4096
    ds_read_b64_tr_b16 a[62:63], v235 offset:4096
    v_cvt_pk_bf16_f32 v202, v16, v17
    v_cvt_pk_bf16_f32 v203, v18, v19
    v_pk_fma_f32 v[20:21], v[104:105], v[128:129], v[20:21] op_sel:[0,0,0] op_sel_hi:[1,0,1]
    v_pk_fma_f32 v[22:23], v[106:107], v[128:129], v[22:23] op_sel:[0,0,0] op_sel_hi:[1,0,1]
    ds_read_b64_tr_b16 a[64:65], v232 offset:6144
    ds_read_b64_tr_b16 a[68:69], v233 offset:6144
    v_pk_mul_f32 v[20:21], v[20:21], v[128:129] op_sel:[0,1] op_sel_hi:[1,1]
    v_pk_mul_f32 v[22:23], v[22:23], v[128:129] op_sel:[0,1] op_sel_hi:[1,1]
    v_cvt_pk_bf16_f32 v204, v20, v21
    v_cvt_pk_bf16_f32 v205, v22, v23
    ds_read_b64_tr_b16 a[72:73], v234 offset:6144
    ds_read_b64_tr_b16 a[76:77], v235 offset:6144
    v_pk_fma_f32 v[24:25], v[104:105], v[130:131], v[24:25] op_sel:[0,0,0] op_sel_hi:[1,0,1]
    v_pk_fma_f32 v[26:27], v[106:107], v[130:131], v[26:27] op_sel:[0,0,0] op_sel_hi:[1,0,1]
    v_pk_mul_f32 v[24:25], v[24:25], v[130:131] op_sel:[0,1] op_sel_hi:[1,1]
    v_pk_mul_f32 v[26:27], v[26:27], v[130:131] op_sel:[0,1] op_sel_hi:[1,1]
    ds_read_b64_tr_b16 a[66:67], v232 offset:8192
    ds_read_b64_tr_b16 a[70:71], v233 offset:8192
    v_cvt_pk_bf16_f32 v206, v24, v25
    v_cvt_pk_bf16_f32 v207, v26, v27
    v_pk_fma_f32 v[28:29], v[104:105], v[132:133], v[28:29] op_sel:[0,0,0] op_sel_hi:[1,0,1]
    v_pk_fma_f32 v[30:31], v[106:107], v[132:133], v[30:31] op_sel:[0,0,0] op_sel_hi:[1,0,1]
    ds_read_b64_tr_b16 a[74:75], v234 offset:8192
    ds_read_b64_tr_b16 a[78:79], v235 offset:8192
    v_pk_mul_f32 v[28:29], v[28:29], v[132:133] op_sel:[0,1] op_sel_hi:[1,1]
    v_pk_mul_f32 v[30:31], v[30:31], v[132:133] op_sel:[0,1] op_sel_hi:[1,1]
    v_cvt_pk_bf16_f32 v208, v28, v29
    v_cvt_pk_bf16_f32 v209, v30, v31
    buffer_load_dwordx2 v[222:223], v236, s[12:15], s41 offen sc1
    v_mfma_f32_16x16x16_bf16 v[0:3], v[176:177], v[194:195], 0
    v_mfma_f32_16x16x16_bf16 v[4:7], v[178:179], v[194:195], 0
    v_mfma_f32_16x16x16_bf16 v[8:11], v[178:179], v[196:197], 0
    v_mfma_f32_16x16x16_bf16 v[12:15], v[180:181], v[196:197], 0
    v_mfma_f32_16x16x16_bf16 v[16:19], v[180:181], v[198:199], 0
    v_mfma_f32_16x16x16_bf16 v[20:23], v[182:183], v[198:199], 0
    v_mfma_f32_16x16x16_bf16 v[24:27], v[182:183], v[200:201], 0
    v_mfma_f32_16x16x16_bf16 v[28:31], v[184:185], v[200:201], 0
    v_mfma_f32_16x16x16_bf16 v[32:35], v[184:185], v[202:203], 0
    v_mfma_f32_16x16x16_bf16 v[36:39], v[186:187], v[202:203], 0
    v_mfma_f32_16x16x16_bf16 v[40:43], v[186:187], v[204:205], 0
    v_mfma_f32_16x16x16_bf16 v[44:47], v[188:189], v[204:205], 0
    v_mfma_f32_16x16x16_bf16 v[48:51], v[188:189], v[206:207], 0
    v_mfma_f32_16x16x16_bf16 v[52:55], v[190:191], v[206:207], 0
    v_mfma_f32_16x16x16_bf16 v[56:59], v[190:191], v[208:209], 0
    v_mfma_f32_16x16x16_bf16 v[60:63], v[192:193], v[208:209], 0
    s_waitcnt lgkmcnt(15)
    v_pk_fma_f32 v[68:69], v[134:135], v[216:217], v[68:69] op_sel_hi:[1,0,1]
    v_pk_fma_f32 v[70:71], v[136:137], v[216:217], v[70:71] op_sel_hi:[1,0,1]
    s_waitcnt lgkmcnt(15)
    v_pk_mul_f32 v[68:69], v[68:69], v[138:139]
    v_pk_mul_f32 v[70:71], v[70:71], v[140:141]
    s_waitcnt lgkmcnt(0)
    v_cvt_pk_bf16_f32 v192, v68, v69
    v_cvt_pk_bf16_f32 v193, v70, v71
    ds_read_b128 v[134:137], v254 offset:192
    ds_read_b128 v[138:141], v254 offset:768
    v_pk_fma_f32 v[72:73], v[142:143], v[216:217], v[72:73] op_sel_hi:[1,0,1]
    v_pk_fma_f32 v[74:75], v[144:145], v[216:217], v[74:75] op_sel_hi:[1,0,1]
    s_add_u32 s53, s37, 131072
    s_add_u32 m0, s44, 0
    v_pk_mul_f32 v[72:73], v[72:73], v[146:147]
    v_pk_mul_f32 v[74:75], v[74:75], v[148:149]
    v_cvt_pk_bf16_f32 v194, v72, v73
    v_cvt_pk_bf16_f32 v195, v74, v75
    buffer_load_dwordx4 v220, s[20:23], s53 offen lds
    ds_read_b128 v[142:145], v254 offset:256
    ds_read_b128 v[146:149], v254 offset:832
    v_pk_fma_f32 v[76:77], v[150:151], v[216:217], v[76:77] op_sel_hi:[1,0,1]
    v_pk_fma_f32 v[78:79], v[152:153], v[216:217], v[78:79] op_sel_hi:[1,0,1]
    v_pk_mul_f32 v[76:77], v[76:77], v[154:155]
    v_pk_mul_f32 v[78:79], v[78:79], v[156:157]
    buffer_load_dwordx4 v221, s[20:23], s53 offen offset:1024 lds
    v_cvt_pk_bf16_f32 v196, v76, v77
    v_cvt_pk_bf16_f32 v197, v78, v79
    ds_read_b128 v[150:153], v254 offset:320
    ds_read_b128 v[154:157], v254 offset:896
    s_waitcnt lgkmcnt(5)
    v_pk_fma_f32 v[80:81], v[134:135], v[216:217], v[80:81] op_sel_hi:[1,0,1]
    v_pk_fma_f32 v[82:83], v[136:137], v[216:217], v[82:83] op_sel_hi:[1,0,1]
    s_add_u32 s53, s37, 147456
    s_add_u32 m0, s44, 2048
    s_waitcnt lgkmcnt(4)
    v_pk_mul_f32 v[80:81], v[80:81], v[138:139]
    v_pk_mul_f32 v[82:83], v[82:83], v[140:141]
    v_cvt_pk_bf16_f32 v198, v80, v81
    v_cvt_pk_bf16_f32 v199, v82, v83
    buffer_load_dwordx4 v220, s[20:23], s53 offen lds
    ds_read_b128 v[134:137], v254 offset:384
    ds_read_b128 v[138:141], v254 offset:960
    s_waitcnt lgkmcnt(5)
    v_pk_fma_f32 v[84:85], v[142:143], v[216:217], v[84:85] op_sel_hi:[1,0,1]
    v_pk_fma_f32 v[86:87], v[144:145], v[216:217], v[86:87] op_sel_hi:[1,0,1]
    s_waitcnt lgkmcnt(4)
    v_pk_mul_f32 v[84:85], v[84:85], v[146:147]
    v_pk_mul_f32 v[86:87], v[86:87], v[148:149]
    buffer_load_dwordx4 v221, s[20:23], s53 offen offset:1024 lds
    v_cvt_pk_bf16_f32 v200, v84, v85
    v_cvt_pk_bf16_f32 v201, v86, v87
    ds_read_b128 v[142:145], v254 offset:448
    ds_read_b128 v[146:149], v254 offset:1024
    s_waitcnt lgkmcnt(5)
    v_pk_fma_f32 v[88:89], v[150:151], v[216:217], v[88:89] op_sel_hi:[1,0,1]
    v_pk_fma_f32 v[90:91], v[152:153], v[216:217], v[90:91] op_sel_hi:[1,0,1]
    s_add_u32 s53, s39, 0
    s_add_u32 m0, s44, 4096
    s_waitcnt lgkmcnt(4)
    v_pk_mul_f32 v[88:89], v[88:89], v[154:155]
    v_pk_mul_f32 v[90:91], v[90:91], v[156:157]
    v_cvt_pk_bf16_f32 v202, v88, v89
    v_cvt_pk_bf16_f32 v203, v90, v91
    buffer_load_dwordx4 v220, s[24:27], s53 offen lds
    ds_read_b128 v[150:153], v254 offset:512
    ds_read_b128 v[154:157], v254 offset:1088
    s_waitcnt lgkmcnt(5)
    v_pk_fma_f32 v[92:93], v[134:135], v[216:217], v[92:93] op_sel_hi:[1,0,1]
    v_pk_fma_f32 v[94:95], v[136:137], v[216:217], v[94:95] op_sel_hi:[1,0,1]
    s_waitcnt lgkmcnt(4)
    v_pk_mul_f32 v[92:93], v[92:93], v[138:139]
    v_pk_mul_f32 v[94:95], v[94:95], v[140:141]
    buffer_load_dwordx4 v221, s[24:27], s53 offen offset:1024 lds
    v_cvt_pk_bf16_f32 v204, v92, v93
    v_cvt_pk_bf16_f32 v205, v94, v95
    s_waitcnt lgkmcnt(3)
    v_pk_fma_f32 v[96:97], v[142:143], v[216:217], v[96:97] op_sel_hi:[1,0,1]
    v_pk_fma_f32 v[98:99], v[144:145], v[216:217], v[98:99] op_sel_hi:[1,0,1]
    s_add_u32 s53, s39, 16384
    s_add_u32 m0, s44, 6144
    s_waitcnt lgkmcnt(2)
    v_pk_mul_f32 v[96:97], v[96:97], v[146:147]
    v_pk_mul_f32 v[98:99], v[98:99], v[148:149]
    v_cvt_pk_bf16_f32 v206, v96, v97
    v_cvt_pk_bf16_f32 v207, v98, v99
    buffer_load_dwordx4 v220, s[24:27], s53 offen lds
    s_waitcnt lgkmcnt(1)
    v_pk_fma_f32 v[100:101], v[150:151], v[216:217], v[100:101] op_sel_hi:[1,0,1]
    v_pk_fma_f32 v[102:103], v[152:153], v[216:217], v[102:103] op_sel_hi:[1,0,1]
    s_waitcnt lgkmcnt(0)
    v_pk_mul_f32 v[100:101], v[100:101], v[154:155]
    v_pk_mul_f32 v[102:103], v[102:103], v[156:157]
    buffer_load_dwordx4 v221, s[24:27], s53 offen offset:1024 lds
    v_cvt_pk_bf16_f32 v208, v100, v101
    v_cvt_pk_bf16_f32 v209, v102, v103
    v_cndmask_b32 v0, v0, v1, s[60:61]
    v_cndmask_b32 v4, v4, v5, s[60:61]
    s_add_u32 s53, s39, 32768
    s_add_u32 m0, s44, 8192
    v_cndmask_b32 v2, v2, v3, s[60:61]
    v_cndmask_b32 v6, v6, v7, s[60:61]
    v_cndmask_b32 v0, v0, v247, s[66:67]
    v_cndmask_b32 v2, v2, v247, s[66:67]
    buffer_load_dwordx4 v220, s[24:27], s53 offen lds
    v_cndmask_b32 v64, v0, v4, s[62:63]
    v_cndmask_b32 v65, v2, v6, s[64:65]
    v_max_f32 v80, v64, v65
    v_cndmask_b32 v8, v8, v9, s[60:61]
    buffer_load_dwordx4 v221, s[24:27], s53 offen offset:1024 lds
    v_cndmask_b32 v12, v12, v13, s[60:61]
    v_cndmask_b32 v10, v10, v11, s[60:61]
    v_cndmask_b32 v14, v14, v15, s[60:61]
    v_cndmask_b32 v66, v8, v12, s[62:63]
    v_cndmask_b32 v67, v10, v14, s[64:65]
    v_max_f32 v81, v66, v67
    v_cndmask_b32 v16, v16, v17, s[60:61]
    v_cndmask_b32 v20, v20, v21, s[60:61]
    s_waitcnt vmcnt(21)
    v_cndmask_b32 v18, v18, v19, s[60:61]
    v_cndmask_b32 v22, v22, v23, s[60:61]
    v_cndmask_b32 v68, v16, v20, s[62:63]
    v_cndmask_b32 v69, v18, v22, s[64:65]
    ds_read_b64_tr_b16 a[80:81], v232 offset:43008
    ds_read_b64_tr_b16 a[84:85], v233 offset:43008
    v_max_f32 v82, v68, v69
    v_cndmask_b32 v24, v24, v25, s[60:61]
    v_cndmask_b32 v28, v28, v29, s[60:61]
    v_cndmask_b32 v26, v26, v27, s[60:61]
    ds_read_b64_tr_b16 a[88:89], v234 offset:43008
    ds_read_b64_tr_b16 a[92:93], v235 offset:43008
    v_cndmask_b32 v30, v30, v31, s[60:61]
    v_cndmask_b32 v70, v24, v28, s[62:63]
    v_cndmask_b32 v71, v26, v30, s[64:65]
    v_max_f32 v83, v70, v71
    ds_read_b64_tr_b16 a[82:83], v232 offset:45056
    ds_read_b64_tr_b16 a[86:87], v233 offset:45056
    v_cndmask_b32 v32, v32, v33, s[60:61]
    v_cndmask_b32 v36, v36, v37, s[60:61]
    v_cndmask_b32 v34, v34, v35, s[60:61]
    v_cndmask_b32 v38, v38, v39, s[60:61]
    ds_read_b64_tr_b16 a[90:91], v234 offset:45056
    ds_read_b64_tr_b16 a[94:95], v235 offset:45056
    v_cndmask_b32 v72, v32, v36, s[62:63]
    v_cndmask_b32 v73, v34, v38, s[64:65]
    v_max_f32 v84, v72, v73
    v_cndmask_b32 v40, v40, v41, s[60:61]
    ds_read_b64_tr_b16 a[96:97], v232 offset:47104
    ds_read_b64_tr_b16 a[100:101], v233 offset:47104
    v_cndmask_b32 v44, v44, v45, s[60:61]
    v_cndmask_b32 v42, v42, v43, s[60:61]
    v_cndmask_b32 v46, v46, v47, s[60:61]
    v_cndmask_b32 v74, v40, v44, s[62:63]
    ds_read_b64_tr_b16 a[104:105], v234 offset:47104
    ds_read_b64_tr_b16 a[108:109], v235 offset:47104
    v_cndmask_b32 v75, v42, v46, s[64:65]
    v_max_f32 v85, v74, v75
    v_cndmask_b32 v48, v48, v49, s[60:61]
    v_cndmask_b32 v52, v52, v53, s[60:61]
    ds_read_b64_tr_b16 a[98:99], v232 offset:49152
    ds_read_b64_tr_b16 a[102:103], v233 offset:49152
    v_cndmask_b32 v50, v50, v51, s[60:61]
    v_cndmask_b32 v54, v54, v55, s[60:61]
    v_cndmask_b32 v76, v48, v52, s[62:63]
    v_cndmask_b32 v77, v50, v54, s[64:65]
    ds_read_b64_tr_b16 a[106:107], v234 offset:49152
    ds_read_b64_tr_b16 a[110:111], v235 offset:49152
    v_max_f32 v86, v76, v77
    v_cndmask_b32 v56, v56, v57, s[60:61]
    v_cndmask_b32 v60, v60, v61, s[60:61]
    v_cndmask_b32 v58, v58, v59, s[60:61]
    ds_read_b64_tr_b16 a[112:113], v232 offset:51200
    ds_read_b64_tr_b16 a[116:117], v233 offset:51200
    v_cndmask_b32 v62, v62, v63, s[60:61]
    v_cndmask_b32 v78, v56, v60, s[62:63]
    v_cndmask_b32 v79, v58, v62, s[64:65]
    v_max_f32 v87, v78, v79
    ds_read_b64_tr_b16 a[120:121], v234 offset:51200
    ds_read_b64_tr_b16 a[124:125], v235 offset:51200
    v_permlane16_swap_b32 v80, v81
    v_permlane16_swap_b32 v82, v83
    v_permlane16_swap_b32 v84, v85
    v_permlane16_swap_b32 v86, v87
    v_max_f32 v80, v80, v81
    v_max_f32 v82, v82, v83
    v_max_f32 v84, v84, v85
    v_max_f32 v86, v86, v87
    s_waitcnt lgkmcnt(0)
    v_permlane32_swap_b32 v80, v82
    v_permlane32_swap_b32 v84, v86
    v_max_f32 v80, v80, v82
    v_max_f32 v84, v84, v86
    v_mul_f32 v80, s47, v80
    v_mul_f32 v84, s47, v84
    s_add_u32 s53, s39, 49152
    s_add_u32 m0, s44, 43008
    v_mov_b32 v82, v80
    v_mov_b32 v86, v84
    s_nop 0
    v_permlane32_swap_b32 v80, v82
    v_permlane32_swap_b32 v84, v86
    v_mov_b32 v81, v80
    v_mov_b32 v83, v82
    buffer_load_dwordx4 v220, s[24:27], s53 offen lds
    v_mov_b32 v85, v84
    v_mov_b32 v87, v86
    v_permlane16_swap_b32 v80, v81
    v_permlane16_swap_b32 v82, v83
    v_permlane16_swap_b32 v84, v85
    v_permlane16_swap_b32 v86, v87
    v_fma_f32 v64, v64, s47, -v80
    v_fma_f32 v65, v65, s47, -v80
    buffer_load_dwordx4 v221, s[24:27], s53 offen offset:1024 lds
    v_fma_f32 v66, v66, s47, -v81
    v_fma_f32 v67, v67, s47, -v81
    v_fma_f32 v68, v68, s47, -v82
    v_fma_f32 v69, v69, s47, -v82
    s_add_u32 s53, s39, 65536
    s_add_u32 m0, s44, 45056
    v_fma_f32 v70, v70, s47, -v83
    v_fma_f32 v71, v71, s47, -v83
    v_fma_f32 v72, v72, s47, -v84
    v_fma_f32 v73, v73, s47, -v84
    buffer_load_dwordx4 v220, s[24:27], s53 offen lds
    v_fma_f32 v74, v74, s47, -v85
    v_fma_f32 v75, v75, s47, -v85
    v_fma_f32 v76, v76, s47, -v86
    v_fma_f32 v77, v77, s47, -v86
    buffer_load_dwordx4 v221, s[24:27], s53 offen offset:1024 lds
    v_fma_f32 v78, v78, s47, -v87
    v_fma_f32 v79, v79, s47, -v87
    v_exp_f32 v64, v64
    v_exp_f32 v65, v65
    s_add_u32 s53, s39, 81920
    s_add_u32 m0, s44, 47104
    v_exp_f32 v66, v66
    v_exp_f32 v67, v67
    v_exp_f32 v68, v68
    v_exp_f32 v69, v69
    buffer_load_dwordx4 v220, s[24:27], s53 offen lds
    v_exp_f32 v70, v70
    v_exp_f32 v71, v71
    v_exp_f32 v72, v72
    v_exp_f32 v73, v73
    buffer_load_dwordx4 v221, s[24:27], s53 offen offset:1024 lds
    v_exp_f32 v74, v74
    v_exp_f32 v75, v75
    v_exp_f32 v76, v76
    v_exp_f32 v77, v77
    s_add_u32 s53, s39, 98304
    s_add_u32 m0, s44, 49152
    v_exp_f32 v78, v78
    v_exp_f32 v79, v79
    v_cvt_pk_bf16_f32 v64, v64, v65
    v_cvt_pk_bf16_f32 v66, v66, v67
    buffer_load_dwordx4 v220, s[24:27], s53 offen lds
    v_cvt_pk_bf16_f32 v68, v68, v69
    v_cvt_pk_bf16_f32 v70, v70, v71
    v_cvt_pk_bf16_f32 v72, v72, v73
    v_cvt_pk_bf16_f32 v74, v74, v75
    buffer_load_dwordx4 v221, s[24:27], s53 offen offset:1024 lds
    v_cvt_pk_bf16_f32 v76, v76, v77
    v_cvt_pk_bf16_f32 v78, v78, v79
    v_perm_b32 v0, v64, v64, v248
    v_perm_b32 v1, v64, v64, v249
    s_add_u32 s53, s39, 114688
    s_add_u32 m0, s44, 51200
    v_perm_b32 v2, v64, v64, v250
    v_perm_b32 v3, v64, v64, v251
    s_nop 1
    v_mfma_f32_16x16x32_bf16 v[32:35], v[192:195], v[0:3], 0
    v_mfma_f32_16x16x32_bf16 v[84:87], v[212:215], v[0:3], 0
    v_perm_b32 v4, v66, v66, v248
    v_perm_b32 v5, v66, v66, v249
    buffer_load_dwordx4 v220, s[24:27], s53 offen lds
    v_perm_b32 v6, v66, v66, v250
    v_perm_b32 v7, v66, v66, v251
L_pad_a4:
    s_cmp_eq_u32 s99, 1
    s_cbranch_scc1 L_padback_a
    s_nop 1
    v_mfma_f32_16x16x32_bf16 v[36:39], v[194:197], v[4:7], 0
    v_mfma_f32_16x16x32_bf16 v[88:91], v[212:215], v[4:7], 0
    v_perm_b32 v8, v68, v68, v248
    v_perm_b32 v9, v68, v68, v249
    buffer_load_dwordx4 v221, s[24:27], s53 offen offset:1024 lds
    v_perm_b32 v10, v68, v68, v250
    v_perm_b32 v11, v68, v68, v251
    s_nop 1
    v_mfma_f32_16x16x32_bf16 v[40:43], v[196:199], v[8:11], 0
    v_mfma_f32_16x16x32_bf16 v[92:95], v[212:215], v[8:11], 0
    v_perm_b32 v12, v70, v70, v248
    v_perm_b32 v13, v70, v70, v249
    v_perm_b32 v14, v70, v70, v250
    v_perm_b32 v15, v70, v70, v251
    s_nop 1
    v_mfma_f32_16x16x32_bf16 v[44:47], v[198:201], v[12:15], 0
    v_mfma_f32_16x16x32_bf16 v[96:99], v[212:215], v[12:15], 0
    v_perm_b32 v16, v72, v72, v248
    v_perm_b32 v17, v72, v72, v249
    v_perm_b32 v18, v72, v72, v250
    v_perm_b32 v19, v72, v72, v251
    s_nop 1
    v_mfma_f32_16x16x32_bf16 v[48:51], v[200:203], v[16:19], 0
    v_mfma_f32_16x16x32_bf16 v[100:103], v[212:215], v[16:19], 0
    v_perm_b32 v20, v74, v74, v248
    v_perm_b32 v21, v74, v74, v249
    v_perm_b32 v22, v74, v74, v250
    v_perm_b32 v23, v74, v74, v251
    s_nop 1
    v_mfma_f32_16x16x32_bf16 v[52:55], v[202:205], v[20:23], 0
    v_mfma_f32_16x16x32_bf16 v[104:107], v[212:215], v[20:23], 0
    v_perm_b32 v24, v76, v76, v248
    v_perm_b32 v25, v76, v76, v249
    v_perm_b32 v26, v76, v76, v250
    v_perm_b32 v27, v76, v76, v251
    s_nop 1
    v_mfma_f32_16x16x32_bf16 v[56:59], v[204:207], v[24:27], 0
    v_mfma_f32_16x16x32_bf16 v[108:111], v[212:215], v[24:27], 0
    v_perm_b32 v28, v78, v78, v248
    v_perm_b32 v29, v78, v78, v249
    v_perm_b32 v30, v78, v78, v250
    v_perm_b32 v31, v78, v78, v251
    s_nop 1
    v_mfma_f32_16x16x32_bf16 v[60:63], v[206:209], v[28:31], 0
    v_mfma_f32_16x16x32_bf16 v[112:115], v[212:215], v[28:31], 0
    v_rcp_f32 v84, v84
    v_rcp_f32 v88, v88
    v_rcp_f32 v92, v92
    v_rcp_f32 v96, v96
    v_rcp_f32 v100, v100
    v_rcp_f32 v104, v104
    v_rcp_f32 v108, v108
    s_nop 0
    v_rcp_f32 v112, v112
    v_pk_mul_f32 v[32:33], v[32:33], v[84:85] op_sel:[0,0] op_sel_hi:[1,0]
    v_pk_mul_f32 v[34:35], v[34:35], v[84:85] op_sel:[0,0] op_sel_hi:[1,0]
    v_cvt_pk_bf16_f32 v32, v32, v33
    v_cvt_pk_bf16_f32 v33, v34, v35
    ds_write_b64 v255, v[32:33] offset:0
    v_pk_mul_f32 v[36:37], v[36:37], v[88:89] op_sel:[0,0] op_sel_hi:[1,0]
    v_pk_mul_f32 v[38:39], v[38:39], v[88:89] op_sel:[0,0] op_sel_hi:[1,0]
    v_cvt_pk_bf16_f32 v36, v36, v37
    v_cvt_pk_bf16_f32 v37, v38, v39
    ds_write_b64 v255, v[36:37] offset:512
    v_pk_mul_f32 v[40:41], v[40:41], v[92:93] op_sel:[0,0] op_sel_hi:[1,0]
    v_pk_mul_f32 v[42:43], v[42:43], v[92:93] op_sel:[0,0] op_sel_hi:[1,0]
    v_cvt_pk_bf16_f32 v40, v40, v41
    v_cvt_pk_bf16_f32 v41, v42, v43
    ds_write_b64 v255, v[40:41] offset:1024
    v_pk_mul_f32 v[44:45], v[44:45], v[96:97] op_sel:[0,0] op_sel_hi:[1,0]
    v_pk_mul_f32 v[46:47], v[46:47], v[96:97] op_sel:[0,0] op_sel_hi:[1,0]
    v_cvt_pk_bf16_f32 v44, v44, v45
    v_cvt_pk_bf16_f32 v45, v46, v47
    ds_write_b64 v255, v[44:45] offset:1536
    v_pk_mul_f32 v[48:49], v[48:49], v[100:101] op_sel:[0,0] op_sel_hi:[1,0]
    v_pk_mul_f32 v[50:51], v[50:51], v[100:101] op_sel:[0,0] op_sel_hi:[1,0]
    v_cvt_pk_bf16_f32 v48, v48, v49
    v_cvt_pk_bf16_f32 v49, v50, v51
    ds_write_b64 v255, v[48:49] offset:2048
    v_pk_mul_f32 v[52:53], v[52:53], v[104:105] op_sel:[0,0] op_sel_hi:[1,0]
    v_pk_mul_f32 v[54:55], v[54:55], v[104:105] op_sel:[0,0] op_sel_hi:[1,0]
    v_cvt_pk_bf16_f32 v52, v52, v53
    v_cvt_pk_bf16_f32 v53, v54, v55
    ds_write_b64 v255, v[52:53] offset:2560
    v_pk_mul_f32 v[56:57], v[56:57], v[108:109] op_sel:[0,0] op_sel_hi:[1,0]
    v_pk_mul_f32 v[58:59], v[58:59], v[108:109] op_sel:[0,0] op_sel_hi:[1,0]
    v_cvt_pk_bf16_f32 v56, v56, v57
    v_cvt_pk_bf16_f32 v57, v58, v59
    ds_write_b64 v255, v[56:57] offset:3072
    v_pk_mul_f32 v[60:61], v[60:61], v[112:113] op_sel:[0,0] op_sel_hi:[1,0]
    v_pk_mul_f32 v[62:63], v[62:63], v[112:113] op_sel:[0,0] op_sel_hi:[1,0]
    v_cvt_pk_bf16_f32 v60, v60, v61
    v_cvt_pk_bf16_f32 v61, v62, v63
    ds_write_b64 v255, v[60:61] offset:3584
    buffer_load_dwordx4 v[132:135], v241, s[12:15], s71 offen offset:0 sc1
    buffer_load_dwordx4 v[136:139], v241, s[12:15], s72 offen offset:0 sc1
    buffer_load_dwordx4 v[140:143], v241, s[12:15], s73 offen offset:0 sc1
    buffer_load_dwordx4 v[128:131], v241, s[12:15], s70 offen offset:0 sc1
    s_lshr_b32 s54, s32, 1
    s_lshl_b32 s54, s54, 14
    s_and_b32 s55, s32, 1
    s_lshl_b32 s56, s55, 11
    s_add_u32 s56, s56, s54
    s_add_u32 s56, s56, 129024
    v_lshl_add_u32 v245, v239, 3, s56
    s_waitcnt lgkmcnt(0)
    s_barrier
    ds_read2st64_b64 v[0:3], v245 offset0:0 offset1:16
    ds_read2st64_b64 v[4:7], v245 offset0:1 offset1:17
    ds_read2st64_b64 v[8:11], v245 offset0:2 offset1:18
    ds_read2st64_b64 v[12:15], v245 offset0:3 offset1:19
    v_accvgpr_read_b32 v200, a244
    v_accvgpr_read_b32 v201, a245
    v_accvgpr_read_b32 v202, a246
    v_accvgpr_read_b32 v203, a247
    buffer_load_dwordx4 v[148:151], v241, s[12:15], s71 offen offset:1024 sc1
    buffer_load_dwordx4 v[152:155], v241, s[12:15], s72 offen offset:1024 sc1
    buffer_load_dwordx4 v[156:159], v241, s[12:15], s73 offen offset:1024 sc1
    buffer_load_dwordx4 v[144:147], v241, s[12:15], s70 offen offset:1024 sc1
    s_add_u32 s57, s50, 0
    s_waitcnt lgkmcnt(3)
    buffer_store_dwordx4 v[0:3], v240, s[12:15], s57 offen sc1
    s_add_u32 s57, s50, 60416
    s_waitcnt lgkmcnt(2)
    buffer_store_dwordx4 v[4:7], v240, s[12:15], s57 offen sc1
    s_add_u32 s57, s50, 120832
    s_waitcnt lgkmcnt(1)
    buffer_store_dwordx4 v[8:11], v240, s[12:15], s57 offen sc1
    s_add_u32 s57, s50, 181248
    s_waitcnt lgkmcnt(0)
    buffer_store_dwordx4 v[12:15], v240, s[12:15], s57 offen sc1
    buffer_load_dwordx4 v[164:167], v242, s[12:15], s71 offen offset:0 sc1
    buffer_load_dwordx4 v[168:171], v242, s[12:15], s72 offen offset:0 sc1
    buffer_load_dwordx4 v[172:175], v242, s[12:15], s73 offen offset:0 sc1
    buffer_load_dwordx4 v[160:163], v242, s[12:15], s70 offen offset:0 sc1
    s_waitcnt vmcnt(12)
    v_xor_b32 v132, v200, v132
    v_xor_b32 v133, v201, v133
    v_xor_b32 v134, v202, v134
    v_or3_b32 v248, v132, v133, v134
    v_xor_b32 v135, v203, v135
    v_xor_b32 v136, v200, v136
    v_or3_b32 v248, v248, v135, v136
    v_xor_b32 v137, v201, v137
    v_xor_b32 v138, v202, v138
    v_or3_b32 v248, v248, v137, v138
    v_xor_b32 v139, v203, v139
    v_xor_b32 v140, v200, v140
    v_or3_b32 v248, v248, v139, v140
    v_xor_b32 v141, v201, v141
    v_xor_b32 v142, v202, v142
    v_or3_b32 v248, v248, v141, v142
    v_xor_b32 v143, v203, v143
    v_xor_b32 v128, v200, v128
    v_or3_b32 v248, v248, v143, v128
    v_xor_b32 v129, v201, v129
    v_xor_b32 v130, v202, v130
    v_or3_b32 v248, v248, v129, v130
    v_xor_b32 v131, v203, v131
    v_bitop3_b32 v248, v248, v131, s3 bitop3:0xa8
    v_cmp_ne_u32 vcc, 0, v248
    s_cbranch_vccnz L_slow_a_0_1
L_back_a_0_1:
    v_mfma_f32_16x16x32_bf16 v[16:19], a[0:3], v[132:135], 0
    v_add_u32 v244, 0x1000, v241
    v_mfma_f32_16x16x32_bf16 v[20:23], a[4:7], v[132:135], 0
    buffer_load_dwordx4 v[180:183], v242, s[12:15], s71 offen offset:1024 sc1
    v_mfma_f32_16x16x32_bf16 v[24:27], a[8:11], v[132:135], 0
    s_waitcnt vmcnt(9)
    v_xor_b32 v148, v200, v148
    v_mfma_f32_16x16x32_bf16 v[28:31], a[12:15], v[132:135], 0
    buffer_load_dwordx4 v[184:187], v242, s[12:15], s72 offen offset:1024 sc1
    v_mfma_f32_16x16x32_bf16 v[44:47], a[12:15], v[136:139], 0
    v_xor_b32 v149, v201, v149
    v_xor_b32 v150, v202, v150
    v_mfma_f32_16x16x32_bf16 v[40:43], a[8:11], v[136:139], 0
    v_add_u32 v246, 0x1000, v242
    buffer_load_dwordx4 v[188:191], v242, s[12:15], s73 offen offset:1024 sc1
    v_mfma_f32_16x16x32_bf16 v[36:39], a[4:7], v[136:139], 0
    v_or3_b32 v248, v148, v149, v150
    v_xor_b32 v151, v203, v151
    v_mfma_f32_16x16x32_bf16 v[32:35], a[0:3], v[136:139], 0
    buffer_load_dwordx4 v[176:179], v242, s[12:15], s70 offen offset:1024 sc1
    v_mfma_f32_16x16x32_bf16 v[48:51], a[0:3], v[140:143], 0
    v_xor_b32 v152, v200, v152
    v_or3_b32 v248, v248, v151, v152
    v_mfma_f32_16x16x32_bf16 v[52:55], a[4:7], v[140:143], 0
    s_cmp_eq_u32 s32, 3
    s_cselect_b32 s54, 0, 1024
    v_add_u32 v245, s54, v244
    buffer_load_dwordx4 v[68:71], v241, s[12:15], s71 offen offset:2048 sc1
    v_mfma_f32_16x16x32_bf16 v[56:59], a[8:11], v[140:143], 0
    v_xor_b32 v153, v201, v153
    v_xor_b32 v154, v202, v154
    v_mfma_f32_16x16x32_bf16 v[60:63], a[12:15], v[140:143], 0
    buffer_load_dwordx4 v[72:75], v241, s[12:15], s72 offen offset:2048 sc1
    v_mfma_f32_16x16x32_bf16 v[12:15], a[12:15], v[128:131], 0
    v_or3_b32 v248, v248, v153, v154
    v_xor_b32 v155, v203, v155
    v_mfma_f32_16x16x32_bf16 v[8:11], a[8:11], v[128:131], 0
    s_lshl_b32 s54, s32, 12
    s_add_u32 s54, s54, 44032
    v_add_u32 v243, s54, v240
    buffer_load_dwordx4 v[76:79], v241, s[12:15], s73 offen offset:2048 sc1
    v_mfma_f32_16x16x32_bf16 v[4:7], a[4:7], v[128:131], 0
    v_xor_b32 v156, v200, v156
    v_or3_b32 v248, v248, v155, v156
    v_xor_b32 v157, v201, v157
    v_xor_b32 v158, v202, v158
    v_or3_b32 v248, v248, v157, v158
    v_xor_b32 v159, v203, v159
    v_xor_b32 v144, v200, v144
    v_or3_b32 v248, v248, v159, v144
    v_xor_b32 v145, v201, v145
    v_xor_b32 v146, v202, v146
    v_or3_b32 v248, v248, v145, v146
    v_xor_b32 v147, v203, v147
    v_bitop3_b32 v248, v248, v147, s3 bitop3:0xa8
    v_cmp_ne_u32 vcc, 0, v248
    s_cbranch_vccnz L_slow_a_1_1
L_back_a_1_1:
    v_mfma_f32_16x16x32_bf16 v[0:3], a[0:3], v[128:131], 0
    buffer_load_dwordx4 v[64:67], v241, s[12:15], s70 offen offset:2048 sc1
    v_mfma_f32_16x16x32_bf16 v[16:19], a[16:19], v[148:151], v[16:19]
    ds_read_b64_tr_b16 a[114:115], v228 offset:0
    v_mfma_f32_16x16x32_bf16 v[20:23], a[20:23], v[148:151], v[20:23]
    buffer_load_dwordx4 v[84:87], v241, s[12:15], s71 offen offset:3072 sc1
    v_mfma_f32_16x16x32_bf16 v[24:27], a[24:27], v[148:151], v[24:27]
    s_waitcnt vmcnt(9)
    v_xor_b32 v164, v200, v164
    v_mfma_f32_16x16x32_bf16 v[28:31], a[28:31], v[148:151], v[28:31]
    buffer_load_dwordx4 v[88:91], v241, s[12:15], s72 offen offset:3072 sc1
    v_mfma_f32_16x16x32_bf16 v[44:47], a[28:31], v[152:155], v[44:47]
    v_xor_b32 v165, v201, v165
    v_xor_b32 v166, v202, v166
    v_mfma_f32_16x16x32_bf16 v[40:43], a[24:27], v[152:155], v[40:43]
    buffer_load_dwordx4 v[92:95], v241, s[12:15], s73 offen offset:3072 sc1
    v_mfma_f32_16x16x32_bf16 v[36:39], a[20:23], v[152:155], v[36:39]
    v_or3_b32 v248, v164, v165, v166
    v_xor_b32 v167, v203, v167
    ds_read_b64_tr_b16 a[118:119], v229 offset:0
    v_mfma_f32_16x16x32_bf16 v[32:35], a[16:19], v[152:155], v[32:35]
    buffer_load_dwordx4 v[80:83], v241, s[12:15], s70 offen offset:3072 sc1
    v_mfma_f32_16x16x32_bf16 v[48:51], a[16:19], v[156:159], v[48:51]
    v_xor_b32 v168, v200, v168
    v_or3_b32 v248, v248, v167, v168
    v_mfma_f32_16x16x32_bf16 v[52:55], a[20:23], v[156:159], v[52:55]
    buffer_load_dwordx4 v[100:103], v242, s[12:15], s71 offen offset:2048 sc1
    v_mfma_f32_16x16x32_bf16 v[56:59], a[24:27], v[156:159], v[56:59]
    v_xor_b32 v169, v201, v169
    v_xor_b32 v170, v202, v170
    v_mfma_f32_16x16x32_bf16 v[60:63], a[28:31], v[156:159], v[60:63]
    ds_read_b64_tr_b16 a[122:123], v230 offset:0
    buffer_load_dwordx4 v[104:107], v242, s[12:15], s72 offen offset:2048 sc1
    v_mfma_f32_16x16x32_bf16 v[12:15], a[28:31], v[144:147], v[12:15]
    v_or3_b32 v248, v248, v169, v170
    v_xor_b32 v171, v203, v171
    v_mfma_f32_16x16x32_bf16 v[8:11], a[24:27], v[144:147], v[8:11]
    buffer_load_dwordx4 v[108:111], v242, s[12:15], s73 offen offset:2048 sc1
    v_mfma_f32_16x16x32_bf16 v[4:7], a[20:23], v[144:147], v[4:7]
    v_xor_b32 v172, v200, v172
    v_or3_b32 v248, v248, v171, v172
    v_xor_b32 v173, v201, v173
    v_xor_b32 v174, v202, v174
    v_or3_b32 v248, v248, v173, v174
    v_xor_b32 v175, v203, v175
    v_xor_b32 v160, v200, v160
    v_or3_b32 v248, v248, v175, v160
    v_xor_b32 v161, v201, v161
    v_xor_b32 v162, v202, v162
    v_or3_b32 v248, v248, v161, v162
    v_xor_b32 v163, v203, v163
    v_bitop3_b32 v248, v248, v163, s3 bitop3:0xa8
    v_cmp_ne_u32 vcc, 0, v248
    s_cbranch_vccnz L_slow_a_2_1
L_back_a_2_1:
    v_mfma_f32_16x16x32_bf16 v[0:3], a[16:19], v[144:147], v[0:3]
    buffer_load_dwordx4 v[96:99], v242, s[12:15], s70 offen offset:2048 sc1
    v_mfma_f32_16x16x32_bf16 v[16:19], a[32:35], v[164:167], v[16:19]
    ds_read_b64_tr_b16 a[126:127], v231 offset:0
    v_mfma_f32_16x16x32_bf16 v[20:23], a[36:39], v[164:167], v[20:23]
    s_waitcnt vmcnt(12)
    v_xor_b32 v180, v200, v180
    v_mfma_f32_16x16x32_bf16 v[24:27], a[40:43], v[164:167], v[24:27]
    buffer_load_dwordx4 v[116:119], v242, s[12:15], s71 offen offset:3072 sc1
    v_mfma_f32_16x16x32_bf16 v[28:31], a[44:47], v[164:167], v[28:31]
    v_xor_b32 v181, v201, v181
    v_xor_b32 v182, v202, v182
    v_mfma_f32_16x16x32_bf16 v[44:47], a[44:47], v[168:171], v[44:47]
    v_or3_b32 v248, v180, v181, v182
    v_xor_b32 v183, v203, v183
    v_mfma_f32_16x16x32_bf16 v[40:43], a[40:43], v[168:171], v[40:43]
    v_xor_b32 v184, v200, v184
    v_or3_b32 v248, v248, v183, v184
    ds_read_b64_tr_b16 a[128:129], v228 offset:2048
    v_mfma_f32_16x16x32_bf16 v[36:39], a[36:39], v[168:171], v[36:39]
    buffer_load_dwordx4 v[120:123], v242, s[12:15], s72 offen offset:3072 sc1
    v_mfma_f32_16x16x32_bf16 v[32:35], a[32:35], v[168:171], v[32:35]
    v_xor_b32 v185, v201, v185
    v_xor_b32 v186, v202, v186
    v_mfma_f32_16x16x32_bf16 v[48:51], a[32:35], v[172:175], v[48:51]
    v_or3_b32 v248, v248, v185, v186
    v_xor_b32 v187, v203, v187
    ds_read_b64_tr_b16 a[132:133], v229 offset:2048
    v_mfma_f32_16x16x32_bf16 v[52:55], a[36:39], v[172:175], v[52:55]
    v_xor_b32 v188, v200, v188
    v_or3_b32 v248, v248, v187, v188
    v_mfma_f32_16x16x32_bf16 v[56:59], a[40:43], v[172:175], v[56:59]
    buffer_load_dwordx4 v[124:127], v242, s[12:15], s73 offen offset:3072 sc1
    v_mfma_f32_16x16x32_bf16 v[60:63], a[44:47], v[172:175], v[60:63]
    v_xor_b32 v189, v201, v189
    v_xor_b32 v190, v202, v190
    v_mfma_f32_16x16x32_bf16 v[12:15], a[44:47], v[160:163], v[12:15]
    v_or3_b32 v248, v248, v189, v190
    v_xor_b32 v191, v203, v191
    ds_read_b64_tr_b16 a[136:137], v230 offset:2048
    v_mfma_f32_16x16x32_bf16 v[8:11], a[40:43], v[160:163], v[8:11]
    v_xor_b32 v176, v200, v176
    v_or3_b32 v248, v248, v191, v176
    v_xor_b32 v177, v201, v177
    v_xor_b32 v178, v202, v178
    v_or3_b32 v248, v248, v177, v178
    v_xor_b32 v179, v203, v179
    v_mfma_f32_16x16x32_bf16 v[4:7], a[36:39], v[160:163], v[4:7]
    v_bitop3_b32 v248, v248, v179, s3 bitop3:0xa8
    buffer_load_dwordx4 v[112:115], v242, s[12:15], s70 offen offset:3072 sc1
    v_mfma_f32_16x16x32_bf16 v[0:3], a[32:35], v[160:163], v[0:3]
    v_cmp_ne_u32 vcc, 0, v248
    s_cbranch_vccnz L_slow_a_3_1
L_back_a_3_1:
    v_mfma_f32_16x16x32_bf16 v[16:19], a[48:51], v[180:183], v[16:19]
    ds_read_b64_tr_b16 a[140:141], v231 offset:2048
    v_mfma_f32_16x16x32_bf16 v[20:23], a[52:55], v[180:183], v[20:23]
    s_waitcnt vmcnt(12)
    v_xor_b32 v68, v200, v68
    v_mfma_f32_16x16x32_bf16 v[24:27], a[56:59], v[180:183], v[24:27]
    buffer_load_dwordx4 v[132:135], v244, s[12:15], s71 offen offset:0 sc1
    v_mfma_f32_16x16x32_bf16 v[28:31], a[60:63], v[180:183], v[28:31]
    v_xor_b32 v69, v201, v69
    v_xor_b32 v70, v202, v70
    v_mfma_f32_16x16x32_bf16 v[44:47], a[60:63], v[184:187], v[44:47]
    v_or3_b32 v248, v68, v69, v70
    v_xor_b32 v71, v203, v71
    v_mfma_f32_16x16x32_bf16 v[40:43], a[56:59], v[184:187], v[40:43]
    v_xor_b32 v72, v200, v72
    v_or3_b32 v248, v248, v71, v72
    v_mfma_f32_16x16x32_bf16 v[36:39], a[52:55], v[184:187], v[36:39]
    ds_read_b64_tr_b16 a[130:131], v228 offset:4096
    buffer_load_dwordx4 v[136:139], v244, s[12:15], s72 offen offset:0 sc1
    v_mfma_f32_16x16x32_bf16 v[32:35], a[48:51], v[184:187], v[32:35]
    v_xor_b32 v73, v201, v73
    v_xor_b32 v74, v202, v74
    v_mfma_f32_16x16x32_bf16 v[48:51], a[48:51], v[188:191], v[48:51]
    v_or3_b32 v248, v248, v73, v74
    v_xor_b32 v75, v203, v75
    v_mfma_f32_16x16x32_bf16 v[52:55], a[52:55], v[188:191], v[52:55]
    v_xor_b32 v76, v200, v76
    v_or3_b32 v248, v248, v75, v76
    v_mfma_f32_16x16x32_bf16 v[56:59], a[56:59], v[188:191], v[56:59]
    buffer_load_dwordx4 v[140:143], v244, s[12:15], s73 offen offset:0 sc1
    v_mfma_f32_16x16x32_bf16 v[60:63], a[60:63], v[188:191], v[60:63]
    v_xor_b32 v77, v201, v77
    v_xor_b32 v78, v202, v78
    ds_read_b64_tr_b16 a[134:135], v229 offset:4096
    v_mfma_f32_16x16x32_bf16 v[12:15], a[60:63], v[176:179], v[12:15]
    v_or3_b32 v248, v248, v77, v78
    v_xor_b32 v79, v203, v79
    v_mfma_f32_16x16x32_bf16 v[8:11], a[56:59], v[176:179], v[8:11]
    v_xor_b32 v64, v200, v64
    v_or3_b32 v248, v248, v79, v64
    v_xor_b32 v65, v201, v65
    v_xor_b32 v66, v202, v66
    v_or3_b32 v248, v248, v65, v66
    v_xor_b32 v67, v203, v67
    v_mfma_f32_16x16x32_bf16 v[4:7], a[52:55], v[176:179], v[4:7]
    v_bitop3_b32 v248, v248, v67, s3 bitop3:0xa8
    buffer_load_dwordx4 v[128:131], v244, s[12:15], s70 offen offset:0 sc1
    v_mfma_f32_16x16x32_bf16 v[0:3], a[48:51], v[176:179], v[0:3]
    v_cmp_ne_u32 vcc, 0, v248
    s_cbranch_vccnz L_slow_a_4_1
L_back_a_4_1:
    v_mfma_f32_16x16x32_bf16 v[16:19], a[64:67], v[68:71], v[16:19]
    ds_read_b64_tr_b16 a[138:139], v230 offset:4096
    v_mfma_f32_16x16x32_bf16 v[20:23], a[68:71], v[68:71], v[20:23]
    s_waitcnt vmcnt(12)
    v_xor_b32 v84, v200, v84
    v_mfma_f32_16x16x32_bf16 v[24:27], a[72:75], v[68:71], v[24:27]
    buffer_load_dwordx4 v[148:151], v245, s[12:15], s71 offen offset:0 sc1
    v_mfma_f32_16x16x32_bf16 v[28:31], a[76:79], v[68:71], v[28:31]
    v_xor_b32 v85, v201, v85
    v_xor_b32 v86, v202, v86
    v_mfma_f32_16x16x32_bf16 v[44:47], a[76:79], v[72:75], v[44:47]
    v_or3_b32 v248, v84, v85, v86
    v_xor_b32 v87, v203, v87
    v_mfma_f32_16x16x32_bf16 v[40:43], a[72:75], v[72:75], v[40:43]
    v_xor_b32 v88, v200, v88
    v_or3_b32 v248, v248, v87, v88
    v_mfma_f32_16x16x32_bf16 v[36:39], a[68:71], v[72:75], v[36:39]
    ds_read_b64_tr_b16 a[142:143], v231 offset:4096
    buffer_load_dwordx4 v[152:155], v245, s[12:15], s72 offen offset:0 sc1
    v_mfma_f32_16x16x32_bf16 v[32:35], a[64:67], v[72:75], v[32:35]
    v_xor_b32 v89, v201, v89
    v_xor_b32 v90, v202, v90
    v_mfma_f32_16x16x32_bf16 v[48:51], a[64:67], v[76:79], v[48:51]
    v_or3_b32 v248, v248, v89, v90
    v_xor_b32 v91, v203, v91
    v_mfma_f32_16x16x32_bf16 v[52:55], a[68:71], v[76:79], v[52:55]
    v_xor_b32 v92, v200, v92
    v_or3_b32 v248, v248, v91, v92
    v_mfma_f32_16x16x32_bf16 v[56:59], a[72:75], v[76:79], v[56:59]
    buffer_load_dwordx4 v[156:159], v245, s[12:15], s73 offen offset:0 sc1
    v_mfma_f32_16x16x32_bf16 v[60:63], a[76:79], v[76:79], v[60:63]
    v_xor_b32 v93, v201, v93
    v_xor_b32 v94, v202, v94
    ds_read_b64_tr_b16 a[144:145], v228 offset:6144
    v_mfma_f32_16x16x32_bf16 v[12:15], a[76:79], v[64:67], v[12:15]
    v_or3_b32 v248, v248, v93, v94
    v_xor_b32 v95, v203, v95
    v_mfma_f32_16x16x32_bf16 v[8:11], a[72:75], v[64:67], v[8:11]
    v_xor_b32 v80, v200, v80
    v_or3_b32 v248, v248, v95, v80
    v_xor_b32 v81, v201, v81
    v_xor_b32 v82, v202, v82
    v_or3_b32 v248, v248, v81, v82
    v_xor_b32 v83, v203, v83
    v_mfma_f32_16x16x32_bf16 v[4:7], a[68:71], v[64:67], v[4:7]
    v_bitop3_b32 v248, v248, v83, s3 bitop3:0xa8
    buffer_load_dwordx4 v[144:147], v245, s[12:15], s70 offen offset:0 sc1
    v_mfma_f32_16x16x32_bf16 v[0:3], a[64:67], v[64:67], v[0:3]
    v_cmp_ne_u32 vcc, 0, v248
    s_cbranch_vccnz L_slow_a_5_1
L_back_a_5_1:
    v_mfma_f32_16x16x32_bf16 v[16:19], a[80:83], v[84:87], v[16:19]
    ds_read_b64_tr_b16 a[148:149], v229 offset:6144
    v_mfma_f32_16x16x32_bf16 v[20:23], a[84:87], v[84:87], v[20:23]
    s_waitcnt vmcnt(12)
    v_xor_b32 v100, v200, v100
    v_mfma_f32_16x16x32_bf16 v[24:27], a[88:91], v[84:87], v[24:27]
    buffer_load_dwordx4 v[164:167], v246, s[12:15], s71 offen offset:0 sc1
    v_mfma_f32_16x16x32_bf16 v[28:31], a[92:95], v[84:87], v[28:31]
    v_xor_b32 v101, v201, v101
    v_xor_b32 v102, v202, v102
    v_mfma_f32_16x16x32_bf16 v[44:47], a[92:95], v[88:91], v[44:47]
    v_or3_b32 v248, v100, v101, v102
    v_xor_b32 v103, v203, v103
    v_mfma_f32_16x16x32_bf16 v[40:43], a[88:91], v[88:91], v[40:43]
    v_xor_b32 v104, v200, v104
    v_or3_b32 v248, v248, v103, v104
    v_mfma_f32_16x16x32_bf16 v[36:39], a[84:87], v[88:91], v[36:39]
    ds_read_b64_tr_b16 a[152:153], v230 offset:6144
    buffer_load_dwordx4 v[168:171], v246, s[12:15], s72 offen offset:0 sc1
    v_mfma_f32_16x16x32_bf16 v[32:35], a[80:83], v[88:91], v[32:35]
    v_xor_b32 v105, v201, v105
    v_xor_b32 v106, v202, v106
    v_mfma_f32_16x16x32_bf16 v[48:51], a[80:83], v[92:95], v[48:51]
    v_or3_b32 v248, v248, v105, v106
    v_xor_b32 v107, v203, v107
    v_mfma_f32_16x16x32_bf16 v[52:55], a[84:87], v[92:95], v[52:55]
    v_xor_b32 v108, v200, v108
    v_or3_b32 v248, v248, v107, v108
    v_mfma_f32_16x16x32_bf16 v[56:59], a[88:91], v[92:95], v[56:59]
    buffer_load_dwordx4 v[172:175], v246, s[12:15], s73 offen offset:0 sc1
    v_mfma_f32_16x16x32_bf16 v[60:63], a[92:95], v[92:95], v[60:63]
    v_xor_b32 v109, v201, v109
    v_xor_b32 v110, v202, v110
    ds_read_b64_tr_b16 a[156:157], v231 offset:6144
    v_mfma_f32_16x16x32_bf16 v[12:15], a[92:95], v[80:83], v[12:15]
    v_or3_b32 v248, v248, v109, v110
    v_xor_b32 v111, v203, v111
    v_mfma_f32_16x16x32_bf16 v[8:11], a[88:91], v[80:83], v[8:11]
    v_xor_b32 v96, v200, v96
    v_or3_b32 v248, v248, v111, v96
    v_xor_b32 v97, v201, v97
    v_xor_b32 v98, v202, v98
    v_or3_b32 v248, v248, v97, v98
    v_xor_b32 v99, v203, v99
    v_mfma_f32_16x16x32_bf16 v[4:7], a[84:87], v[80:83], v[4:7]
    v_bitop3_b32 v248, v248, v99, s3 bitop3:0xa8
    buffer_load_dwordx4 v[160:163], v246, s[12:15], s70 offen offset:0 sc1
    v_mfma_f32_16x16x32_bf16 v[0:3], a[80:83], v[80:83], v[0:3]
    v_cmp_ne_u32 vcc, 0, v248
    s_cbranch_vccnz L_slow_a_6_1
L_back_a_6_1:
    v_mfma_f32_16x16x32_bf16 v[16:19], a[96:99], v[100:103], v[16:19]
    v_cmp_ne_u32 vcc, s58, v222
    v_cmp_ne_u32 s[54:55], s59, v223
    s_or_b64 vcc, vcc, s[54:55]
    s_cmp_eq_u64 vcc, 0
    s_cbranch_scc1 L_flg_ok_36
    s_mov_b32 s75, 0
L_flg_again_37:
    s_sleep 1
    buffer_load_dwordx2 v[222:223], v236, s[12:15], s41 offen sc1
    s_waitcnt vmcnt(0)
    v_cmp_ne_u32 vcc, s58, v222
    v_cmp_ne_u32 s[54:55], s59, v223
    s_or_b64 vcc, vcc, s[54:55]
    s_cmp_eq_u64 vcc, 0
    s_cbranch_scc1 L_flg_ok_36
    s_add_u32 s75, s75, 1
    s_cmp_lt_u32 s75, 4000
    s_cbranch_scc1 L_flg_again_37
L_flg_ok_36:
    v_mfma_f32_16x16x32_bf16 v[20:23], a[100:103], v[100:103], v[20:23]
    s_waitcnt vmcnt(12)
    v_xor_b32 v116, v200, v116
    v_mfma_f32_16x16x32_bf16 v[24:27], a[104:107], v[100:103], v[24:27]
    ds_read_b64_tr_b16 a[146:147], v228 offset:8192
    buffer_load_dwordx4 v[180:183], v243, s[12:15], s71 offen offset:0 sc1
    v_mfma_f32_16x16x32_bf16 v[28:31], a[108:111], v[100:103], v[28:31]
    v_xor_b32 v117, v201, v117
    v_xor_b32 v118, v202, v118
    v_mfma_f32_16x16x32_bf16 v[44:47], a[108:111], v[104:107], v[44:47]
    v_or3_b32 v248, v116, v117, v118
    v_xor_b32 v119, v203, v119
    v_mfma_f32_16x16x32_bf16 v[40:43], a[104:107], v[104:107], v[40:43]
    v_xor_b32 v120, v200, v120
    v_or3_b32 v248, v248, v119, v120
    v_mfma_f32_16x16x32_bf16 v[36:39], a[100:103], v[104:107], v[36:39]
    ds_read_b64_tr_b16 a[150:151], v229 offset:8192
    buffer_load_dwordx4 v[184:187], v243, s[12:15], s72 offen offset:0 sc1
    v_mfma_f32_16x16x32_bf16 v[32:35], a[96:99], v[104:107], v[32:35]
    v_xor_b32 v121, v201, v121
    v_xor_b32 v122, v202, v122
    v_mfma_f32_16x16x32_bf16 v[48:51], a[96:99], v[108:111], v[48:51]
    v_or3_b32 v248, v248, v121, v122
    v_xor_b32 v123, v203, v123
    v_mfma_f32_16x16x32_bf16 v[52:55], a[100:103], v[108:111], v[52:55]
    v_xor_b32 v124, v200, v124
    v_or3_b32 v248, v248, v123, v124
    v_mfma_f32_16x16x32_bf16 v[56:59], a[104:107], v[108:111], v[56:59]
    buffer_load_dwordx4 v[188:191], v243, s[12:15], s73 offen offset:0 sc1
    v_mfma_f32_16x16x32_bf16 v[60:63], a[108:111], v[108:111], v[60:63]
    v_xor_b32 v125, v201, v125
    v_xor_b32 v126, v202, v126
    ds_read_b64_tr_b16 a[154:155], v230 offset:8192
    v_mfma_f32_16x16x32_bf16 v[12:15], a[108:111], v[96:99], v[12:15]
    v_or3_b32 v248, v248, v125, v126
    v_xor_b32 v127, v203, v127
    v_mfma_f32_16x16x32_bf16 v[8:11], a[104:107], v[96:99], v[8:11]
    v_xor_b32 v112, v200, v112
    v_or3_b32 v248, v248, v127, v112
    v_xor_b32 v113, v201, v113
    v_xor_b32 v114, v202, v114
    v_or3_b32 v248, v248, v113, v114
    v_xor_b32 v115, v203, v115
    v_mfma_f32_16x16x32_bf16 v[4:7], a[100:103], v[96:99], v[4:7]
    v_bitop3_b32 v248, v248, v115, s3 bitop3:0xa8
    buffer_load_dwordx4 v[176:179], v243, s[12:15], s70 offen offset:0 sc1
    v_mfma_f32_16x16x32_bf16 v[0:3], a[96:99], v[96:99], v[0:3]
    v_cmp_ne_u32 vcc, 0, v248
    s_cbranch_vccnz L_slow_a_7_1
L_back_a_7_1:
    s_waitcnt lgkmcnt(15)
    v_mfma_f32_16x16x32_bf16 v[16:19], a[112:115], v[116:119], v[16:19]
    ds_read_b64_tr_b16 a[158:159], v231 offset:8192
    s_waitcnt lgkmcnt(15)
    v_mfma_f32_16x16x32_bf16 v[20:23], a[116:119], v[116:119], v[20:23]
    s_waitcnt vmcnt(12)
    v_xor_b32 v132, v200, v132
    s_waitcnt lgkmcnt(15)
    v_mfma_f32_16x16x32_bf16 v[24:27], a[120:123], v[116:119], v[24:27]
    buffer_load_dwordx4 v[68:71], v243, s[12:15], s71 offen offset:1024 sc1
    s_waitcnt lgkmcnt(15)
    v_mfma_f32_16x16x32_bf16 v[28:31], a[124:127], v[116:119], v[28:31]
    v_xor_b32 v133, v201, v133
    v_xor_b32 v134, v202, v134
    v_mfma_f32_16x16x32_bf16 v[44:47], a[124:127], v[120:123], v[44:47]
    v_or3_b32 v248, v132, v133, v134
    v_xor_b32 v135, v203, v135
    v_mfma_f32_16x16x32_bf16 v[40:43], a[120:123], v[120:123], v[40:43]
    v_xor_b32 v136, v200, v136
    v_or3_b32 v248, v248, v135, v136
    v_mfma_f32_16x16x32_bf16 v[36:39], a[116:119], v[120:123], v[36:39]
    ds_read_b64_tr_b16 a[160:161], v232 offset:0
    buffer_load_dwordx4 v[84:87], v243, s[12:15], s71 offen offset:2048 sc1
    v_mfma_f32_16x16x32_bf16 v[32:35], a[112:115], v[120:123], v[32:35]
    v_xor_b32 v137, v201, v137
    v_xor_b32 v138, v202, v138
    v_mfma_f32_16x16x32_bf16 v[48:51], a[112:115], v[124:127], v[48:51]
    v_or3_b32 v248, v248, v137, v138
    v_xor_b32 v139, v203, v139
    v_mfma_f32_16x16x32_bf16 v[52:55], a[116:119], v[124:127], v[52:55]
    v_xor_b32 v140, v200, v140
    v_or3_b32 v248, v248, v139, v140
    v_mfma_f32_16x16x32_bf16 v[56:59], a[120:123], v[124:127], v[56:59]
    buffer_load_dwordx4 v[100:103], v243, s[12:15], s71 offen offset:3072 sc1
    v_mfma_f32_16x16x32_bf16 v[60:63], a[124:127], v[124:127], v[60:63]
    v_xor_b32 v141, v201, v141
    v_xor_b32 v142, v202, v142
    ds_read_b64_tr_b16 a[164:165], v233 offset:0
    v_mfma_f32_16x16x32_bf16 v[12:15], a[124:127], v[112:115], v[12:15]
    v_or3_b32 v248, v248, v141, v142
    v_xor_b32 v143, v203, v143
    v_mfma_f32_16x16x32_bf16 v[8:11], a[120:123], v[112:115], v[8:11]
    v_xor_b32 v128, v200, v128
    v_or3_b32 v248, v248, v143, v128
    v_xor_b32 v129, v201, v129
    v_xor_b32 v130, v202, v130
    v_or3_b32 v248, v248, v129, v130
    v_xor_b32 v131, v203, v131
    v_mfma_f32_16x16x32_bf16 v[4:7], a[116:119], v[112:115], v[4:7]
    v_bitop3_b32 v248, v248, v131, s3 bitop3:0xa8
    buffer_load_dwordx4 v[72:75], v243, s[12:15], s72 offen offset:1024 sc1
    v_mfma_f32_16x16x32_bf16 v[0:3], a[112:115], v[112:115], v[0:3]
    v_cmp_ne_u32 vcc, 0, v248
    s_cbranch_vccnz L_slow_a_8_1
L_back_a_8_1:
    s_waitcnt lgkmcnt(13)
    v_mfma_f32_16x16x32_bf16 v[16:19], a[128:131], v[132:135], v[16:19]
    ds_read_b64_tr_b16 a[168:169], v234 offset:0
    s_waitcnt lgkmcnt(13)
    v_mfma_f32_16x16x32_bf16 v[20:23], a[132:135], v[132:135], v[20:23]
    s_waitcnt vmcnt(12)
    v_xor_b32 v148, v200, v148
    s_waitcnt lgkmcnt(12)
    v_mfma_f32_16x16x32_bf16 v[24:27], a[136:139], v[132:135], v[24:27]
    buffer_load_dwordx4 v[88:91], v243, s[12:15], s72 offen offset:2048 sc1
    s_waitcnt lgkmcnt(11)
    v_mfma_f32_16x16x32_bf16 v[28:31], a[140:143], v[132:135], v[28:31]
    v_xor_b32 v149, v201, v149
    v_xor_b32 v150, v202, v150
    v_mfma_f32_16x16x32_bf16 v[44:47], a[140:143], v[136:139], v[44:47]
    v_or3_b32 v248, v148, v149, v150
    v_xor_b32 v151, v203, v151
    v_mfma_f32_16x16x32_bf16 v[40:43], a[136:139], v[136:139], v[40:43]
    v_xor_b32 v152, v200, v152
    v_or3_b32 v248, v248, v151, v152
    v_mfma_f32_16x16x32_bf16 v[36:39], a[132:135], v[136:139], v[36:39]
    ds_read_b64_tr_b16 a[172:173], v235 offset:0
    buffer_load_dwordx4 v[104:107], v243, s[12:15], s72 offen offset:3072 sc1
    v_mfma_f32_16x16x32_bf16 v[32:35], a[128:131], v[136:139], v[32:35]
    v_xor_b32 v153, v201, v153
    v_xor_b32 v154, v202, v154
    v_mfma_f32_16x16x32_bf16 v[48:51], a[128:131], v[140:143], v[48:51]
    v_or3_b32 v248, v248, v153, v154
    v_xor_b32 v155, v203, v155
L_pad_a5:
    s_cmp_eq_u32 s99, 1
    s_cbranch_scc1 L_padback_a
    v_mfma_f32_16x16x32_bf16 v[52:55], a[132:135], v[140:143], v[52:55]
    v_xor_b32 v156, v200, v156
    v_or3_b32 v248, v248, v155, v156
    v_mfma_f32_16x16x32_bf16 v[56:59], a[136:139], v[140:143], v[56:59]
    buffer_load_dwordx4 v[76:79], v243, s[12:15], s73 offen offset:1024 sc1
    v_mfma_f32_16x16x32_bf16 v[60:63], a[140:143], v[140:143], v[60:63]
    v_xor_b32 v157, v201, v157
    v_xor_b32 v158, v202, v158
    ds_read_b64_tr_b16 a[162:163], v232 offset:2048
    v_mfma_f32_16x16x32_bf16 v[12:15], a[140:143], v[128:131], v[12:15]
    v_or3_b32 v248, v248, v157, v158
    v_xor_b32 v159, v203, v159
    v_mfma_f32_16x16x32_bf16 v[8:11], a[136:139], v[128:131], v[8:11]
    v_xor_b32 v144, v200, v144
    v_or3_b32 v248, v248, v159, v144
    v_xor_b32 v145, v201, v145
    v_xor_b32 v146, v202, v146
    v_or3_b32 v248, v248, v145, v146
    v_xor_b32 v147, v203, v147
    v_mfma_f32_16x16x32_bf16 v[4:7], a[132:135], v[128:131], v[4:7]
    v_bitop3_b32 v248, v248, v147, s3 bitop3:0xa8
    buffer_load_dwordx4 v[92:95], v243, s[12:15], s73 offen offset:2048 sc1
    v_mfma_f32_16x16x32_bf16 v[0:3], a[128:131], v[128:131], v[0:3]
    v_cmp_ne_u32 vcc, 0, v248
    s_cbranch_vccnz L_slow_a_9_1
L_back_a_9_1:
    s_waitcnt lgkmcnt(8)
    v_mfma_f32_16x16x32_bf16 v[16:19], a[144:147], v[148:151], v[16:19]
    ds_read_b64_tr_b16 a[166:167], v233 offset:2048
    s_waitcnt lgkmcnt(8)
    v_mfma_f32_16x16x32_bf16 v[20:23], a[148:151], v[148:151], v[20:23]
    s_waitcnt vmcnt(12)
    v_xor_b32 v164, v200, v164
    s_waitcnt lgkmcnt(7)
    v_mfma_f32_16x16x32_bf16 v[24:27], a[152:155], v[148:151], v[24:27]
    buffer_load_dwordx4 v[108:111], v243, s[12:15], s73 offen offset:3072 sc1
    s_waitcnt lgkmcnt(6)
    v_mfma_f32_16x16x32_bf16 v[28:31], a[156:159], v[148:151], v[28:31]
    v_xor_b32 v165, v201, v165
    v_xor_b32 v166, v202, v166
    v_mfma_f32_16x16x32_bf16 v[44:47], a[156:159], v[152:155], v[44:47]
    v_or3_b32 v248, v164, v165, v166
    v_xor_b32 v167, v203, v167
    v_mfma_f32_16x16x32_bf16 v[40:43], a[152:155], v[152:155], v[40:43]
    v_xor_b32 v168, v200, v168
    v_or3_b32 v248, v248, v167, v168
    v_mfma_f32_16x16x32_bf16 v[36:39], a[148:151], v[152:155], v[36:39]
    ds_read_b64_tr_b16 a[170:171], v234 offset:2048
    buffer_load_dwordx4 v[64:67], v243, s[12:15], s70 offen offset:1024 sc1
    v_mfma_f32_16x16x32_bf16 v[32:35], a[144:147], v[152:155], v[32:35]
    v_xor_b32 v169, v201, v169
    v_xor_b32 v170, v202, v170
    v_mfma_f32_16x16x32_bf16 v[48:51], a[144:147], v[156:159], v[48:51]
    v_or3_b32 v248, v248, v169, v170
    v_xor_b32 v171, v203, v171
    v_mfma_f32_16x16x32_bf16 v[52:55], a[148:151], v[156:159], v[52:55]
    v_xor_b32 v172, v200, v172
    v_or3_b32 v248, v248, v171, v172
    v_mfma_f32_16x16x32_bf16 v[56:59], a[152:155], v[156:159], v[56:59]
    buffer_load_dwordx4 v[80:83], v243, s[12:15], s70 offen offset:2048 sc1
    v_mfma_f32_16x16x32_bf16 v[60:63], a[156:159], v[156:159], v[60:63]
    v_xor_b32 v173, v201, v173
    v_xor_b32 v174, v202, v174
    ds_read_b64_tr_b16 a[174:175], v235 offset:2048
    v_mfma_f32_16x16x32_bf16 v[12:15], a[156:159], v[144:147], v[12:15]
    v_or3_b32 v248, v248, v173, v174
    v_xor_b32 v175, v203, v175
    v_mfma_f32_16x16x32_bf16 v[8:11], a[152:155], v[144:147], v[8:11]
    v_xor_b32 v160, v200, v160
    v_or3_b32 v248, v248, v175, v160
    v_xor_b32 v161, v201, v161
    v_xor_b32 v162, v202, v162
    v_or3_b32 v248, v248, v161, v162
    v_xor_b32 v163, v203, v163
    v_mfma_f32_16x16x32_bf16 v[4:7], a[148:151], v[144:147], v[4:7]
    v_bitop3_b32 v248, v248, v163, s3 bitop3:0xa8
    buffer_load_dwordx4 v[96:99], v243, s[12:15], s70 offen offset:3072 sc1
    v_mfma_f32_16x16x32_bf16 v[0:3], a[144:147], v[144:147], v[0:3]
    v_cmp_ne_u32 vcc, 0, v248
    s_cbranch_vccnz L_slow_a_10_1
L_back_a_10_1:
    s_waitcnt lgkmcnt(3)
    v_mfma_f32_16x16x32_bf16 v[16:19], a[160:163], v[164:167], v[16:19]
    ds_read_b64_tr_b16 a[176:177], v232 offset:4096
    s_waitcnt lgkmcnt(3)
    v_mfma_f32_16x16x32_bf16 v[20:23], a[164:167], v[164:167], v[20:23]
    s_waitcnt lgkmcnt(2)
    v_mfma_f32_16x16x32_bf16 v[24:27], a[168:171], v[164:167], v[24:27]
    buffer_load_dwordx2 v[192:193], v226, s[4:7], 0 offen offset:0
    s_waitcnt lgkmcnt(1)
    v_mfma_f32_16x16x32_bf16 v[28:31], a[172:175], v[164:167], v[28:31]
    ds_read_b64_tr_b16 a[180:181], v233 offset:4096
    v_mfma_f32_16x16x32_bf16 v[44:47], a[172:175], v[168:171], v[44:47]
    ds_read_b64_tr_b16 a[184:185], v234 offset:4096
    v_mfma_f32_16x16x32_bf16 v[40:43], a[168:171], v[168:171], v[40:43]
    ds_read_b64_tr_b16 a[188:189], v235 offset:4096
    v_mfma_f32_16x16x32_bf16 v[36:39], a[164:167], v[168:171], v[36:39]
    buffer_load_dwordx2 v[194:195], v226, s[4:7], 0 offen offset:32
    v_mfma_f32_16x16x32_bf16 v[32:35], a[160:163], v[168:171], v[32:35]
    ds_read_b64_tr_b16 a[178:179], v232 offset:6144
    v_mfma_f32_16x16x32_bf16 v[48:51], a[160:163], v[172:175], v[48:51]
    v_mfma_f32_16x16x32_bf16 v[52:55], a[164:167], v[172:175], v[52:55]
    ds_read_b64_tr_b16 a[182:183], v233 offset:6144
    v_mfma_f32_16x16x32_bf16 v[56:59], a[168:171], v[172:175], v[56:59]
    buffer_load_dwordx2 v[196:197], v226, s[4:7], 0 offen offset:64
    v_mfma_f32_16x16x32_bf16 v[60:63], a[172:175], v[172:175], v[60:63]
    s_waitcnt vmcnt(15)
    v_max3_u32 v248, v180, v184, v188
    v_mfma_f32_16x16x32_bf16 v[12:15], a[172:175], v[160:163], v[12:15]
    ds_read_b64_tr_b16 a[186:187], v234 offset:6144
    v_mfma_f32_16x16x32_bf16 v[8:11], a[168:171], v[160:163], v[8:11]
    v_max_u32 v248, v248, v176
    ds_read_b64_tr_b16 a[190:191], v235 offset:6144
    v_mfma_f32_16x16x32_bf16 v[4:7], a[164:167], v[160:163], v[4:7]
    buffer_load_dwordx2 v[198:199], v226, s[4:7], 0 offen offset:96
    v_mfma_f32_16x16x32_bf16 v[0:3], a[160:163], v[160:163], v[0:3]
    v_cmp_eq_u32 vcc, -1, v248
    s_cbranch_vccnz L_slow_a_11_1
L_back_a_11_1:
    s_waitcnt lgkmcnt(3)
    v_mfma_f32_16x16x32_bf16 v[16:19], a[176:179], v[180:183], v[16:19]
    ds_read_b64_tr_b16 a[192:193], v232 offset:8192
    ds_read_b64_tr_b16 a[196:197], v233 offset:8192
    s_waitcnt lgkmcnt(4)
    v_mfma_f32_16x16x32_bf16 v[20:23], a[180:183], v[180:183], v[20:23]
    ds_read_b64_tr_b16 a[200:201], v234 offset:8192
    s_waitcnt lgkmcnt(4)
    v_mfma_f32_16x16x32_bf16 v[24:27], a[184:187], v[180:183], v[24:27]
    ds_read_b64_tr_b16 a[204:205], v235 offset:8192
    ds_read_b64_tr_b16 a[194:195], v232 offset:43008
    s_waitcnt lgkmcnt(5)
    v_mfma_f32_16x16x32_bf16 v[28:31], a[188:191], v[180:183], v[28:31]
    ds_read_b64_tr_b16 a[198:199], v233 offset:43008
    ds_read_b64_tr_b16 a[202:203], v234 offset:43008
    v_mfma_f32_16x16x32_bf16 v[44:47], a[188:191], v[184:187], v[44:47]
    ds_read_b64_tr_b16 a[206:207], v235 offset:43008
    ds_read_b64_tr_b16 a[208:209], v232 offset:45056
    v_mfma_f32_16x16x32_bf16 v[40:43], a[184:187], v[184:187], v[40:43]
    ds_read_b64_tr_b16 a[212:213], v233 offset:45056
    v_add_u32 v253, s44, v240
    v_mfma_f32_16x16x32_bf16 v[36:39], a[180:183], v[184:187], v[36:39]
    ds_read_b64_tr_b16 a[216:217], v234 offset:45056
    ds_read_b64_tr_b16 a[220:221], v235 offset:45056
    v_mfma_f32_16x16x32_bf16 v[32:35], a[176:179], v[184:187], v[32:35]
    ds_read_b64_tr_b16 a[210:211], v232 offset:47104
    ds_read_b64_tr_b16 a[214:215], v233 offset:47104
    v_mfma_f32_16x16x32_bf16 v[48:51], a[176:179], v[188:191], v[48:51]
    ds_read_b64_tr_b16 a[218:219], v234 offset:47104
    v_add_u32 v254, 86016, v253
    v_mfma_f32_16x16x32_bf16 v[52:55], a[180:183], v[188:191], v[52:55]
    ds_read_b64_tr_b16 a[222:223], v235 offset:47104
    ds_read_b64_tr_b16 a[224:225], v232 offset:49152
    v_mfma_f32_16x16x32_bf16 v[56:59], a[184:187], v[188:191], v[56:59]
    s_waitcnt vmcnt(13)
    ds_read_b64_tr_b16 a[228:229], v233 offset:49152
    v_mfma_f32_16x16x32_bf16 v[60:63], a[188:191], v[188:191], v[60:63]
    ds_read_b64_tr_b16 a[232:233], v234 offset:49152
    ds_read_b64_tr_b16 a[236:237], v235 offset:49152
    v_mfma_f32_16x16x32_bf16 v[12:15], a[188:191], v[176:179], v[12:15]
    v_max3_u32 v248, v68, v84, v100
    ds_read_b64_tr_b16 a[226:227], v232 offset:51200
    v_mfma_f32_16x16x32_bf16 v[8:11], a[184:187], v[176:179], v[8:11]
    ds_read_b64_tr_b16 a[230:231], v233 offset:51200
    ds_read_b64_tr_b16 a[234:235], v234 offset:51200
    ds_read_b64_tr_b16 a[238:239], v235 offset:51200
    v_mfma_f32_16x16x32_bf16 v[4:7], a[180:183], v[176:179], v[4:7]
    v_cmp_eq_u32 vcc, -1, v248
    s_cbranch_vccnz L_slow_a_12_1
L_back_a_12_1:
    v_mfma_f32_16x16x32_bf16 v[0:3], a[176:179], v[176:179], v[0:3]
    s_waitcnt lgkmcnt(15)
    v_mfma_f32_16x16x32_bf16 v[16:19], a[192:195], v[68:71], v[16:19]
    s_waitcnt lgkmcnt(15)
    v_mfma_f32_16x16x32_bf16 v[20:23], a[196:199], v[68:71], v[20:23]
    s_waitcnt lgkmcnt(15)
    v_mfma_f32_16x16x32_bf16 v[24:27], a[200:203], v[68:71], v[24:27]
    s_waitcnt lgkmcnt(15)
    v_mfma_f32_16x16x32_bf16 v[28:31], a[204:207], v[68:71], v[28:31]
    s_sub_u32 s54, s32, 1
    s_and_b32 s54, s54, 3
    s_mul_i32 s54, s54, 10752
    s_add_u32 s54, s54, 0
    v_add_u32 v249, s54, v240
    s_waitcnt lgkmcnt(11)
    v_mfma_f32_16x16x32_bf16 v[16:19], a[208:211], v[84:87], v[16:19]
    s_waitcnt lgkmcnt(10)
    v_mfma_f32_16x16x32_bf16 v[20:23], a[212:215], v[84:87], v[20:23]
    s_waitcnt lgkmcnt(9)
    v_mfma_f32_16x16x32_bf16 v[24:27], a[216:219], v[84:87], v[24:27]
    s_waitcnt lgkmcnt(8)
    v_mfma_f32_16x16x32_bf16 v[28:31], a[220:223], v[84:87], v[28:31]
    s_waitcnt vmcnt(10)
    s_waitcnt lgkmcnt(3)
    v_mfma_f32_16x16x32_bf16 v[16:19], a[224:227], v[100:103], v[16:19]
    s_waitcnt lgkmcnt(2)
    v_mfma_f32_16x16x32_bf16 v[20:23], a[228:231], v[100:103], v[20:23]
    v_max3_u32 v248, v72, v88, v104
    s_waitcnt lgkmcnt(1)
    v_mfma_f32_16x16x32_bf16 v[24:27], a[232:235], v[100:103], v[24:27]
    s_waitcnt lgkmcnt(0)
    v_mfma_f32_16x16x32_bf16 v[28:31], a[236:239], v[100:103], v[28:31]
    v_cmp_eq_u32 vcc, -1, v248
    s_cbranch_vccnz L_slow_a_12_2
L_back_a_12_2:
    v_mfma_f32_16x16x32_bf16 v[32:35], a[192:195], v[72:75], v[32:35]
    v_mfma_f32_16x16x32_bf16 v[36:39], a[196:199], v[72:75], v[36:39]
    v_mfma_f32_16x16x32_bf16 v[40:43], a[200:203], v[72:75], v[40:43]
    ds_write_b128 v253, v[16:19] offset:0
    v_mfma_f32_16x16x32_bf16 v[44:47], a[204:207], v[72:75], v[44:47]
    s_sub_u32 s54, s32, 2
    s_and_b32 s54, s54, 3
    s_mul_i32 s54, s54, 10752
    s_add_u32 s54, s54, 43008
    v_add_u32 v250, s54, v240
    v_mfma_f32_16x16x32_bf16 v[32:35], a[208:211], v[88:91], v[32:35]
    ds_write_b128 v253, v[20:23] offset:1024
    v_mfma_f32_16x16x32_bf16 v[36:39], a[212:215], v[88:91], v[36:39]
    v_mfma_f32_16x16x32_bf16 v[40:43], a[216:219], v[88:91], v[40:43]
    v_mfma_f32_16x16x32_bf16 v[44:47], a[220:223], v[88:91], v[44:47]
    s_waitcnt vmcnt(7)
    ds_write_b128 v253, v[24:27] offset:2048
    v_mfma_f32_16x16x32_bf16 v[32:35], a[224:227], v[104:107], v[32:35]
    v_mfma_f32_16x16x32_bf16 v[36:39], a[228:231], v[104:107], v[36:39]
    v_max3_u32 v248, v76, v92, v108
    ds_write_b128 v253, v[28:31] offset:3072
    v_mfma_f32_16x16x32_bf16 v[40:43], a[232:235], v[104:107], v[40:43]
    v_mfma_f32_16x16x32_bf16 v[44:47], a[236:239], v[104:107], v[44:47]
    v_cmp_eq_u32 vcc, -1, v248
    s_cbranch_vccnz L_slow_a_12_3
L_back_a_12_3:
    v_mfma_f32_16x16x32_bf16 v[48:51], a[192:195], v[76:79], v[48:51]
    v_mfma_f32_16x16x32_bf16 v[52:55], a[196:199], v[76:79], v[52:55]
    v_mfma_f32_16x16x32_bf16 v[56:59], a[200:203], v[76:79], v[56:59]
    ds_write_b128 v253, v[32:35] offset:43008
    v_mfma_f32_16x16x32_bf16 v[60:63], a[204:207], v[76:79], v[60:63]
    s_sub_u32 s54, s32, 3
    s_and_b32 s54, s54, 3
    s_mul_i32 s54, s54, 10752
    s_add_u32 s54, s54, 86016
    v_add_u32 v251, s54, v240
    v_mfma_f32_16x16x32_bf16 v[48:51], a[208:211], v[92:95], v[48:51]
    ds_write_b128 v253, v[36:39] offset:44032
    v_mfma_f32_16x16x32_bf16 v[52:55], a[212:215], v[92:95], v[52:55]
    v_mfma_f32_16x16x32_bf16 v[56:59], a[216:219], v[92:95], v[56:59]
    v_mfma_f32_16x16x32_bf16 v[60:63], a[220:223], v[92:95], v[60:63]
    s_waitcnt vmcnt(4)
    ds_write_b128 v253, v[40:43] offset:45056
    v_mfma_f32_16x16x32_bf16 v[48:51], a[224:227], v[108:111], v[48:51]
    v_mfma_f32_16x16x32_bf16 v[52:55], a[228:231], v[108:111], v[52:55]
    v_max3_u32 v248, v64, v80, v96
    ds_write_b128 v253, v[44:47] offset:46080
    v_mfma_f32_16x16x32_bf16 v[56:59], a[232:235], v[108:111], v[56:59]
    v_mfma_f32_16x16x32_bf16 v[60:63], a[236:239], v[108:111], v[60:63]
    v_cmp_eq_u32 vcc, -1, v248
    s_cbranch_vccnz L_slow_a_12_0
L_back_a_12_0:
    v_mfma_f32_16x16x32_bf16 v[0:3], a[192:195], v[64:67], v[0:3]
    s_waitcnt vmcnt(3)
    v_lshlrev_b32 v112, 16, v192
    v_mfma_f32_16x16x32_bf16 v[4:7], a[196:199], v[64:67], v[4:7]
    v_and_b32 v113, 0xffff0000, v192
    v_lshlrev_b32 v114, 16, v193
    v_mfma_f32_16x16x32_bf16 v[8:11], a[200:203], v[64:67], v[8:11]
    v_and_b32 v115, 0xffff0000, v193
    ds_write_b128 v254, v[48:51] offset:0
    v_mfma_f32_16x16x32_bf16 v[12:15], a[204:207], v[64:67], v[12:15]
    s_waitcnt vmcnt(2)
    v_lshlrev_b32 v116, 16, v194
    v_mfma_f32_16x16x32_bf16 v[0:3], a[208:211], v[80:83], v[0:3]
    v_and_b32 v117, 0xffff0000, v194
    ds_write_b128 v254, v[52:55] offset:1024
    v_mfma_f32_16x16x32_bf16 v[4:7], a[212:215], v[80:83], v[4:7]
    v_lshlrev_b32 v118, 16, v195
    v_and_b32 v119, 0xffff0000, v195
    v_mfma_f32_16x16x32_bf16 v[8:11], a[216:219], v[80:83], v[8:11]
    s_waitcnt vmcnt(1)
    v_lshlrev_b32 v120, 16, v196
    v_mfma_f32_16x16x32_bf16 v[12:15], a[220:223], v[80:83], v[12:15]
    v_and_b32 v121, 0xffff0000, v196
    ds_write_b128 v254, v[56:59] offset:2048
    v_mfma_f32_16x16x32_bf16 v[0:3], a[224:227], v[96:99], v[0:3]
    v_lshlrev_b32 v122, 16, v197
    v_and_b32 v123, 0xffff0000, v197
    v_mfma_f32_16x16x32_bf16 v[4:7], a[228:231], v[96:99], v[4:7]
    s_waitcnt vmcnt(0)
    v_lshlrev_b32 v124, 16, v198
    ds_write_b128 v254, v[60:63] offset:3072
    v_mfma_f32_16x16x32_bf16 v[8:11], a[232:235], v[96:99], v[8:11]
    v_and_b32 v125, 0xffff0000, v198
    v_lshlrev_b32 v126, 16, v199
    v_mfma_f32_16x16x32_bf16 v[12:15], a[236:239], v[96:99], v[12:15]
    v_and_b32 v127, 0xffff0000, v199
    v_pk_add_f32 v[0:1], v[0:1], v[112:113]
    v_pk_add_f32 v[2:3], v[2:3], v[114:115]
    v_pk_add_f32 v[4:5], v[4:5], v[116:117]
    v_pk_add_f32 v[6:7], v[6:7], v[118:119]
    v_pk_add_f32 v[8:9], v[8:9], v[120:121]
    v_pk_add_f32 v[10:11], v[10:11], v[122:123]
    s_nop 0
    v_pk_add_f32 v[12:13], v[12:13], v[124:125]
    v_pk_add_f32 v[14:15], v[14:15], v[126:127]
    s_waitcnt lgkmcnt(0)
    s_barrier
    ds_read_b128 v[64:67], v249 offset:0
    ds_read_b128 v[68:71], v249 offset:1024
    ds_read_b128 v[72:75], v249 offset:2048
    ds_read_b128 v[76:79], v249 offset:3072
    ds_read_b128 v[80:83], v250 offset:0
    ds_read_b128 v[84:87], v250 offset:1024
    ds_read_b128 v[88:91], v250 offset:2048
    ds_read_b128 v[92:95], v250 offset:3072
    ds_read_b128 v[96:99], v251 offset:0
    ds_read_b128 v[100:103], v251 offset:1024
    ds_read_b128 v[104:107], v251 offset:2048
    ds_read_b128 v[108:111], v251 offset:3072
    s_waitcnt lgkmcnt(11)
    v_pk_add_f32 v[0:1], v[0:1], v[64:65]
    v_pk_add_f32 v[2:3], v[2:3], v[66:67]
    s_waitcnt lgkmcnt(10)
    v_pk_add_f32 v[4:5], v[4:5], v[68:69]
    v_pk_add_f32 v[6:7], v[6:7], v[70:71]
    s_waitcnt lgkmcnt(9)
    v_pk_add_f32 v[8:9], v[8:9], v[72:73]
    v_pk_add_f32 v[10:11], v[10:11], v[74:75]
    s_waitcnt lgkmcnt(8)
    v_pk_add_f32 v[12:13], v[12:13], v[76:77]
    v_pk_add_f32 v[14:15], v[14:15], v[78:79]
    s_waitcnt lgkmcnt(7)
    v_pk_add_f32 v[0:1], v[0:1], v[80:81]
    v_pk_add_f32 v[2:3], v[2:3], v[82:83]
    s_waitcnt lgkmcnt(6)
    v_pk_add_f32 v[4:5], v[4:5], v[84:85]
    v_pk_add_f32 v[6:7], v[6:7], v[86:87]
    s_waitcnt lgkmcnt(5)
    v_pk_add_f32 v[8:9], v[8:9], v[88:89]
    v_pk_add_f32 v[10:11], v[10:11], v[90:91]
    s_waitcnt lgkmcnt(4)
    v_pk_add_f32 v[12:13], v[12:13], v[92:93]
    v_pk_add_f32 v[14:15], v[14:15], v[94:95]
    s_waitcnt lgkmcnt(3)
    v_pk_add_f32 v[0:1], v[0:1], v[96:97]
    v_pk_add_f32 v[2:3], v[2:3], v[98:99]
    s_waitcnt lgkmcnt(2)
    v_pk_add_f32 v[4:5], v[4:5], v[100:101]
    v_pk_add_f32 v[6:7], v[6:7], v[102:103]
    s_waitcnt lgkmcnt(1)
    v_pk_add_f32 v[8:9], v[8:9], v[104:105]
    v_pk_add_f32 v[10:11], v[10:11], v[106:107]
    s_waitcnt lgkmcnt(0)
    v_pk_add_f32 v[12:13], v[12:13], v[108:109]
    v_pk_add_f32 v[14:15], v[14:15], v[110:111]
    v_cvt_pk_bf16_f32 v16, v0, v1
    v_cvt_pk_bf16_f32 v17, v2, v3
    v_cvt_pk_bf16_f32 v18, v4, v5
    v_cvt_pk_bf16_f32 v19, v6, v7
    v_cvt_pk_bf16_f32 v20, v8, v9
    v_cvt_pk_bf16_f32 v21, v10, v11
    v_cvt_pk_bf16_f32 v22, v12, v13
    v_cvt_pk_bf16_f32 v23, v14, v15
    v_permlane16_swap_b32 v16, v18
    v_permlane16_swap_b32 v17, v19
    v_permlane16_swap_b32 v20, v22
    v_permlane16_swap_b32 v21, v23
    buffer_store_dwordx4 v[16:19], v237, s[28:31], 0 offen offset:0
    buffer_store_dwordx4 v[20:23], v237, s[28:31], 0 offen offset:64
    s_endpgm
    s_nop 0
L_slow_a_0_1:
    s_mov_b32 s75, 0
L_slow_a_0_1_a:
    buffer_load_dwordx4 v[132:135], v241, s[12:15], s71 offen offset:0 sc1
    buffer_load_dwordx4 v[136:139], v241, s[12:15], s72 offen offset:0 sc1
    buffer_load_dwordx4 v[140:143], v241, s[12:15], s73 offen offset:0 sc1
    buffer_load_dwordx4 v[128:131], v241, s[12:15], s70 offen offset:0 sc1
    s_waitcnt vmcnt(0)
    v_xor_b32 v132, v200, v132
    v_xor_b32 v133, v201, v133
    v_xor_b32 v134, v202, v134
    v_or3_b32 v248, v132, v133, v134
    v_xor_b32 v135, v203, v135
    v_xor_b32 v136, v200, v136
    v_or3_b32 v248, v248, v135, v136
    v_xor_b32 v137, v201, v137
    v_xor_b32 v138, v202, v138
    v_or3_b32 v248, v248, v137, v138
    v_xor_b32 v139, v203, v139
    v_xor_b32 v140, v200, v140
    v_or3_b32 v248, v248, v139, v140
    v_xor_b32 v141, v201, v141
    v_xor_b32 v142, v202, v142
    v_or3_b32 v248, v248, v141, v142
    v_xor_b32 v143, v203, v143
    v_xor_b32 v128, v200, v128
    v_or3_b32 v248, v248, v143, v128
    v_xor_b32 v129, v201, v129
    v_xor_b32 v130, v202, v130
    v_or3_b32 v248, v248, v129, v130
    v_xor_b32 v131, v203, v131
    v_bitop3_b32 v248, v248, v131, s3 bitop3:0xa8
    v_cmp_ne_u32 vcc, 0, v248
    s_cbranch_vccz L_slow_a_0_1_r
    s_add_u32 s75, s75, 1
    s_cmp_lt_u32 s75, 4000
    s_cbranch_scc1 L_slow_a_0_1_a
L_slow_a_0_1_r:
    buffer_load_dwordx4 v[148:151], v241, s[12:15], s71 offen offset:1024 sc1
    buffer_load_dwordx4 v[152:155], v241, s[12:15], s72 offen offset:1024 sc1
    buffer_load_dwordx4 v[156:159], v241, s[12:15], s73 offen offset:1024 sc1
    buffer_load_dwordx4 v[144:147], v241, s[12:15], s70 offen offset:1024 sc1
    buffer_load_dword v252, off, s[12:15], 0
    s_waitcnt vmcnt(0)
    buffer_load_dword v252, off, s[12:15], 0
    s_waitcnt vmcnt(0)
    buffer_load_dword v252, off, s[12:15], 0
    s_waitcnt vmcnt(0)
    buffer_load_dword v252, off, s[12:15], 0
    buffer_load_dwordx4 v[164:167], v242, s[12:15], s71 offen offset:0 sc1
    buffer_load_dwordx4 v[168:171], v242, s[12:15], s72 offen offset:0 sc1
    buffer_load_dwordx4 v[172:175], v242, s[12:15], s73 offen offset:0 sc1
    buffer_load_dwordx4 v[160:163], v242, s[12:15], s70 offen offset:0 sc1
    s_branch L_back_a_0_1
    s_nop 0
L_slow_a_1_1:
    s_mov_b32 s75, 0
L_slow_a_1_1_a:
    buffer_load_dwordx4 v[148:151], v241, s[12:15], s71 offen offset:1024 sc1
    buffer_load_dwordx4 v[152:155], v241, s[12:15], s72 offen offset:1024 sc1
    buffer_load_dwordx4 v[156:159], v241, s[12:15], s73 offen offset:1024 sc1
    buffer_load_dwordx4 v[144:147], v241, s[12:15], s70 offen offset:1024 sc1
    s_waitcnt vmcnt(0)
    v_xor_b32 v148, v200, v148
    v_xor_b32 v149, v201, v149
    v_xor_b32 v150, v202, v150
    v_or3_b32 v248, v148, v149, v150
    v_xor_b32 v151, v203, v151
    v_xor_b32 v152, v200, v152
    v_or3_b32 v248, v248, v151, v152
    v_xor_b32 v153, v201, v153
    v_xor_b32 v154, v202, v154
    v_or3_b32 v248, v248, v153, v154
    v_xor_b32 v155, v203, v155
    v_xor_b32 v156, v200, v156
    v_or3_b32 v248, v248, v155, v156
    v_xor_b32 v157, v201, v157
    v_xor_b32 v158, v202, v158
    v_or3_b32 v248, v248, v157, v158
    v_xor_b32 v159, v203, v159
    v_xor_b32 v144, v200, v144
    v_or3_b32 v248, v248, v159, v144
    v_xor_b32 v145, v201, v145
    v_xor_b32 v146, v202, v146
    v_or3_b32 v248, v248, v145, v146
    v_xor_b32 v147, v203, v147
    v_bitop3_b32 v248, v248, v147, s3 bitop3:0xa8
    v_cmp_ne_u32 vcc, 0, v248
    s_cbranch_vccz L_slow_a_1_1_r
    s_add_u32 s75, s75, 1
    s_cmp_lt_u32 s75, 4000
    s_cbranch_scc1 L_slow_a_1_1_a
L_slow_a_1_1_r:
    buffer_load_dword v252, off, s[12:15], 0
    s_waitcnt vmcnt(0)
    buffer_load_dword v252, off, s[12:15], 0
    s_waitcnt vmcnt(0)
    buffer_load_dword v252, off, s[12:15], 0
    s_waitcnt vmcnt(0)
    buffer_load_dword v252, off, s[12:15], 0
    buffer_load_dwordx4 v[164:167], v242, s[12:15], s71 offen offset:0 sc1
    buffer_load_dwordx4 v[168:171], v242, s[12:15], s72 offen offset:0 sc1
    buffer_load_dwordx4 v[172:175], v242, s[12:15], s73 offen offset:0 sc1
    buffer_load_dwordx4 v[160:163], v242, s[12:15], s70 offen offset:0 sc1
    buffer_load_dwordx4 v[180:183], v242, s[12:15], s71 offen offset:1024 sc1
    buffer_load_dwordx4 v[184:187], v242, s[12:15], s72 offen offset:1024 sc1
    buffer_load_dwordx4 v[188:191], v242, s[12:15], s73 offen offset:1024 sc1
    buffer_load_dwordx4 v[176:179], v242, s[12:15], s70 offen offset:1024 sc1
    buffer_load_dwordx4 v[68:71], v241, s[12:15], s71 offen offset:2048 sc1
    buffer_load_dwordx4 v[72:75], v241, s[12:15], s72 offen offset:2048 sc1
    buffer_load_dwordx4 v[76:79], v241, s[12:15], s73 offen offset:2048 sc1
    s_branch L_back_a_1_1
    s_nop 0
L_slow_a_2_1:
    s_mov_b32 s75, 0
L_slow_a_2_1_a:
    buffer_load_dwordx4 v[164:167], v242, s[12:15], s71 offen offset:0 sc1
    buffer_load_dwordx4 v[168:171], v242, s[12:15], s72 offen offset:0 sc1
    buffer_load_dwordx4 v[172:175], v242, s[12:15], s73 offen offset:0 sc1
    buffer_load_dwordx4 v[160:163], v242, s[12:15], s70 offen offset:0 sc1
    s_waitcnt vmcnt(0)
    v_xor_b32 v164, v200, v164
    v_xor_b32 v165, v201, v165
    v_xor_b32 v166, v202, v166
    v_or3_b32 v248, v164, v165, v166
    v_xor_b32 v167, v203, v167
    v_xor_b32 v168, v200, v168
    v_or3_b32 v248, v248, v167, v168
    v_xor_b32 v169, v201, v169
    v_xor_b32 v170, v202, v170
    v_or3_b32 v248, v248, v169, v170
    v_xor_b32 v171, v203, v171
    v_xor_b32 v172, v200, v172
    v_or3_b32 v248, v248, v171, v172
    v_xor_b32 v173, v201, v173
    v_xor_b32 v174, v202, v174
    v_or3_b32 v248, v248, v173, v174
    v_xor_b32 v175, v203, v175
    v_xor_b32 v160, v200, v160
    v_or3_b32 v248, v248, v175, v160
    v_xor_b32 v161, v201, v161
    v_xor_b32 v162, v202, v162
    v_or3_b32 v248, v248, v161, v162
    v_xor_b32 v163, v203, v163
    v_bitop3_b32 v248, v248, v163, s3 bitop3:0xa8
    v_cmp_ne_u32 vcc, 0, v248
    s_cbranch_vccz L_slow_a_2_1_r
    s_add_u32 s75, s75, 1
    s_cmp_lt_u32 s75, 4000
    s_cbranch_scc1 L_slow_a_2_1_a
L_slow_a_2_1_r:
    buffer_load_dwordx4 v[180:183], v242, s[12:15], s71 offen offset:1024 sc1
    buffer_load_dwordx4 v[184:187], v242, s[12:15], s72 offen offset:1024 sc1
    buffer_load_dwordx4 v[188:191], v242, s[12:15], s73 offen offset:1024 sc1
    buffer_load_dwordx4 v[176:179], v242, s[12:15], s70 offen offset:1024 sc1
    buffer_load_dwordx4 v[68:71], v241, s[12:15], s71 offen offset:2048 sc1
    buffer_load_dwordx4 v[72:75], v241, s[12:15], s72 offen offset:2048 sc1
    buffer_load_dwordx4 v[76:79], v241, s[12:15], s73 offen offset:2048 sc1
    buffer_load_dwordx4 v[64:67], v241, s[12:15], s70 offen offset:2048 sc1
    buffer_load_dwordx4 v[84:87], v241, s[12:15], s71 offen offset:3072 sc1
    buffer_load_dwordx4 v[88:91], v241, s[12:15], s72 offen offset:3072 sc1
    buffer_load_dwordx4 v[92:95], v241, s[12:15], s73 offen offset:3072 sc1
    buffer_load_dwordx4 v[80:83], v241, s[12:15], s70 offen offset:3072 sc1
    buffer_load_dwordx4 v[100:103], v242, s[12:15], s71 offen offset:2048 sc1
    buffer_load_dwordx4 v[104:107], v242, s[12:15], s72 offen offset:2048 sc1
    buffer_load_dwordx4 v[108:111], v242, s[12:15], s73 offen offset:2048 sc1
    s_branch L_back_a_2_1
    s_nop 0
L_slow_a_3_1:
    s_mov_b32 s75, 0
L_slow_a_3_1_a:
    buffer_load_dwordx4 v[180:183], v242, s[12:15], s71 offen offset:1024 sc1
    buffer_load_dwordx4 v[184:187], v242, s[12:15], s72 offen offset:1024 sc1
    buffer_load_dwordx4 v[188:191], v242, s[12:15], s73 offen offset:1024 sc1
    buffer_load_dwordx4 v[176:179], v242, s[12:15], s70 offen offset:1024 sc1
    s_waitcnt vmcnt(0)
    v_xor_b32 v180, v200, v180
    v_xor_b32 v181, v201, v181
    v_xor_b32 v182, v202, v182
    v_or3_b32 v248, v180, v181, v182
    v_xor_b32 v183, v203, v183
    v_xor_b32 v184, v200, v184
    v_or3_b32 v248, v248, v183, v184
    v_xor_b32 v185, v201, v185
    v_xor_b32 v186, v202, v186
    v_or3_b32 v248, v248, v185, v186
    v_xor_b32 v187, v203, v187
    v_xor_b32 v188, v200, v188
    v_or3_b32 v248, v248, v187, v188
    v_xor_b32 v189, v201, v189
    v_xor_b32 v190, v202, v190
    v_or3_b32 v248, v248, v189, v190
    v_xor_b32 v191, v203, v191
    v_xor_b32 v176, v200, v176
    v_or3_b32 v248, v248, v191, v176
    v_xor_b32 v177, v201, v177
    v_xor_b32 v178, v202, v178
    v_or3_b32 v248, v248, v177, v178
    v_xor_b32 v179, v203, v179
    v_bitop3_b32 v248, v248, v179, s3 bitop3:0xa8
    v_cmp_ne_u32 vcc, 0, v248
    s_cbranch_vccz L_slow_a_3_1_r
    s_add_u32 s75, s75, 1
    s_cmp_lt_u32 s75, 4000
    s_cbranch_scc1 L_slow_a_3_1_a
L_slow_a_3_1_r:
    buffer_load_dwordx4 v[68:71], v241, s[12:15], s71 offen offset:2048 sc1
    buffer_load_dwordx4 v[72:75], v241, s[12:15], s72 offen offset:2048 sc1
    buffer_load_dwordx4 v[76:79], v241, s[12:15], s73 offen offset:2048 sc1
    buffer_load_dwordx4 v[64:67], v241, s[12:15], s70 offen offset:2048 sc1
    buffer_load_dwordx4 v[84:87], v241, s[12:15], s71 offen offset:3072 sc1
    buffer_load_dwordx4 v[88:91], v241, s[12:15], s72 offen offset:3072 sc1
    buffer_load_dwordx4 v[92:95], v241, s[12:15], s73 offen offset:3072 sc1
    buffer_load_dwordx4 v[80:83], v241, s[12:15], s70 offen offset:3072 sc1
    buffer_load_dwordx4 v[100:103], v242, s[12:15], s71 offen offset:2048 sc1
    buffer_load_dwordx4 v[104:107], v242, s[12:15], s72 offen offset:2048 sc1
    buffer_load_dwordx4 v[108:111], v242, s[12:15], s73 offen offset:2048 sc1
    buffer_load_dwordx4 v[96:99], v242, s[12:15], s70 offen offset:2048 sc1
    buffer_load_dwordx4 v[116:119], v242, s[12:15], s71 offen offset:3072 sc1
    buffer_load_dwordx4 v[120:123], v242, s[12:15], s72 offen offset:3072 sc1
    buffer_load_dwordx4 v[124:127], v242, s[12:15], s73 offen offset:3072 sc1
    buffer_load_dwordx4 v[112:115], v242, s[12:15], s70 offen offset:3072 sc1
    s_branch L_back_a_3_1
    s_nop 0
L_slow_a_4_1:
    s_mov_b32 s75, 0
L_slow_a_4_1_a:
    buffer_load_dwordx4 v[68:71], v241, s[12:15], s71 offen offset:2048 sc1
    buffer_load_dwordx4 v[72:75], v241, s[12:15], s72 offen offset:2048 sc1
    buffer_load_dwordx4 v[76:79], v241, s[12:15], s73 offen offset:2048 sc1
    buffer_load_dwordx4 v[64:67], v241, s[12:15], s70 offen offset:2048 sc1
    s_waitcnt vmcnt(0)
    v_xor_b32 v68, v200, v68
    v_xor_b32 v69, v201, v69
    v_xor_b32 v70, v202, v70
    v_or3_b32 v248, v68, v69, v70
    v_xor_b32 v71, v203, v71
    v_xor_b32 v72, v200, v72
    v_or3_b32 v248, v248, v71, v72
    v_xor_b32 v73, v201, v73
    v_xor_b32 v74, v202, v74
    v_or3_b32 v248, v248, v73, v74
    v_xor_b32 v75, v203, v75
    v_xor_b32 v76, v200, v76
    v_or3_b32 v248, v248, v75, v76
    v_xor_b32 v77, v201, v77
    v_xor_b32 v78, v202, v78
    v_or3_b32 v248, v248, v77, v78
    v_xor_b32 v79, v203, v79
    v_xor_b32 v64, v200, v64
    v_or3_b32 v248, v248, v79, v64
    v_xor_b32 v65, v201, v65
    v_xor_b32 v66, v202, v66
    v_or3_b32 v248, v248, v65, v66
    v_xor_b32 v67, v203, v67
    v_bitop3_b32 v248, v248, v67, s3 bitop3:0xa8
    v_cmp_ne_u32 vcc, 0, v248
    s_cbranch_vccz L_slow_a_4_1_r
    s_add_u32 s75, s75, 1
    s_cmp_lt_u32 s75, 4000
    s_cbranch_scc1 L_slow_a_4_1_a
L_slow_a_4_1_r:
    buffer_load_dwordx4 v[84:87], v241, s[12:15], s71 offen offset:3072 sc1
    buffer_load_dwordx4 v[88:91], v241, s[12:15], s72 offen offset:3072 sc1
    buffer_load_dwordx4 v[92:95], v241, s[12:15], s73 offen offset:3072 sc1
    buffer_load_dwordx4 v[80:83], v241, s[12:15], s70 offen offset:3072 sc1
    buffer_load_dwordx4 v[100:103], v242, s[12:15], s71 offen offset:2048 sc1
    buffer_load_dwordx4 v[104:107], v242, s[12:15], s72 offen offset:2048 sc1
    buffer_load_dwordx4 v[108:111], v242, s[12:15], s73 offen offset:2048 sc1
    buffer_load_dwordx4 v[96:99], v242, s[12:15], s70 offen offset:2048 sc1
    buffer_load_dwordx4 v[116:119], v242, s[12:15], s71 offen offset:3072 sc1
    buffer_load_dwordx4 v[120:123], v242, s[12:15], s72 offen offset:3072 sc1
    buffer_load_dwordx4 v[124:127], v242, s[12:15], s73 offen offset:3072 sc1
    buffer_load_dwordx4 v[112:115], v242, s[12:15], s70 offen offset:3072 sc1
    buffer_load_dwordx4 v[132:135], v244, s[12:15], s71 offen offset:0 sc1
    buffer_load_dwordx4 v[136:139], v244, s[12:15], s72 offen offset:0 sc1
    buffer_load_dwordx4 v[140:143], v244, s[12:15], s73 offen offset:0 sc1
    buffer_load_dwordx4 v[128:131], v244, s[12:15], s70 offen offset:0 sc1
    s_branch L_back_a_4_1
    s_nop 0
L_slow_a_5_1:
    s_mov_b32 s75, 0
L_slow_a_5_1_a:
    buffer_load_dwordx4 v[84:87], v241, s[12:15], s71 offen offset:3072 sc1
    buffer_load_dwordx4 v[88:91], v241, s[12:15], s72 offen offset:3072 sc1
    buffer_load_dwordx4 v[92:95], v241, s[12:15], s73 offen offset:3072 sc1
    buffer_load_dwordx4 v[80:83], v241, s[12:15], s70 offen offset:3072 sc1
    s_waitcnt vmcnt(0)
    v_xor_b32 v84, v200, v84
    v_xor_b32 v85, v201, v85
    v_xor_b32 v86, v202, v86
    v_or3_b32 v248, v84, v85, v86
    v_xor_b32 v87, v203, v87
    v_xor_b32 v88, v200, v88
    v_or3_b32 v248, v248, v87, v88
    v_xor_b32 v89, v201, v89
    v_xor_b32 v90, v202, v90
    v_or3_b32 v248, v248, v89, v90
    v_xor_b32 v91, v203, v91
    v_xor_b32 v92, v200, v92
    v_or3_b32 v248, v248, v91, v92
    v_xor_b32 v93, v201, v93
    v_xor_b32 v94, v202, v94
    v_or3_b32 v248, v248, v93, v94
    v_xor_b32 v95, v203, v95
    v_xor_b32 v80, v200, v80
    v_or3_b32 v248, v248, v95, v80
    v_xor_b32 v81, v201, v81
    v_xor_b32 v82, v202, v82
    v_or3_b32 v248, v248, v81, v82
    v_xor_b32 v83, v203, v83
    v_bitop3_b32 v248, v248, v83, s3 bitop3:0xa8
    v_cmp_ne_u32 vcc, 0, v248
    s_cbranch_vccz L_slow_a_5_1_r
    s_add_u32 s75, s75, 1
    s_cmp_lt_u32 s75, 4000
    s_cbranch_scc1 L_slow_a_5_1_a
L_slow_a_5_1_r:
    buffer_load_dwordx4 v[100:103], v242, s[12:15], s71 offen offset:2048 sc1
    buffer_load_dwordx4 v[104:107], v242, s[12:15], s72 offen offset:2048 sc1
    buffer_load_dwordx4 v[108:111], v242, s[12:15], s73 offen offset:2048 sc1
    buffer_load_dwordx4 v[96:99], v242, s[12:15], s70 offen offset:2048 sc1
    buffer_load_dwordx4 v[116:119], v242, s[12:15], s71 offen offset:3072 sc1
    buffer_load_dwordx4 v[120:123], v242, s[12:15], s72 offen offset:3072 sc1
    buffer_load_dwordx4 v[124:127], v242, s[12:15], s73 offen offset:3072 sc1
    buffer_load_dwordx4 v[112:115], v242, s[12:15], s70 offen offset:3072 sc1
    buffer_load_dwordx4 v[132:135], v244, s[12:15], s71 offen offset:0 sc1
    buffer_load_dwordx4 v[136:139], v244, s[12:15], s72 offen offset:0 sc1
    buffer_load_dwordx4 v[140:143], v244, s[12:15], s73 offen offset:0 sc1
    buffer_load_dwordx4 v[128:131], v244, s[12:15], s70 offen offset:0 sc1
    buffer_load_dwordx4 v[148:151], v245, s[12:15], s71 offen offset:0 sc1
    buffer_load_dwordx4 v[152:155], v245, s[12:15], s72 offen offset:0 sc1
    buffer_load_dwordx4 v[156:159], v245, s[12:15], s73 offen offset:0 sc1
    buffer_load_dwordx4 v[144:147], v245, s[12:15], s70 offen offset:0 sc1
    s_branch L_back_a_5_1
    s_nop 0
L_slow_a_6_1:
    s_mov_b32 s75, 0
L_slow_a_6_1_a:
    buffer_load_dwordx4 v[100:103], v242, s[12:15], s71 offen offset:2048 sc1
    buffer_load_dwordx4 v[104:107], v242, s[12:15], s72 offen offset:2048 sc1
    buffer_load_dwordx4 v[108:111], v242, s[12:15], s73 offen offset:2048 sc1
    buffer_load_dwordx4 v[96:99], v242, s[12:15], s70 offen offset:2048 sc1
    s_waitcnt vmcnt(0)
    v_xor_b32 v100, v200, v100
    v_xor_b32 v101, v201, v101
    v_xor_b32 v102, v202, v102
    v_or3_b32 v248, v100, v101, v102
    v_xor_b32 v103, v203, v103
    v_xor_b32 v104, v200, v104
    v_or3_b32 v248, v248, v103, v104
    v_xor_b32 v105, v201, v105
    v_xor_b32 v106, v202, v106
    v_or3_b32 v248, v248, v105, v106
    v_xor_b32 v107, v203, v107
    v_xor_b32 v108, v200, v108
    v_or3_b32 v248, v248, v107, v108
    v_xor_b32 v109, v201, v109
    v_xor_b32 v110, v202, v110
    v_or3_b32 v248, v248, v109, v110
    v_xor_b32 v111, v203, v111
    v_xor_b32 v96, v200, v96
    v_or3_b32 v248, v248, v111, v96
    v_xor_b32 v97, v201, v97
    v_xor_b32 v98, v202, v98
    v_or3_b32 v248, v248, v97, v98
    v_xor_b32 v99, v203, v99
    v_bitop3_b32 v248, v248, v99, s3 bitop3:0xa8
    v_cmp_ne_u32 vcc, 0, v248
    s_cbranch_vccz L_slow_a_6_1_r
    s_add_u32 s75, s75, 1
    s_cmp_lt_u32 s75, 4000
    s_cbranch_scc1 L_slow_a_6_1_a
L_slow_a_6_1_r:
    buffer_load_dwordx4 v[116:119], v242, s[12:15], s71 offen offset:3072 sc1
    buffer_load_dwordx4 v[120:123], v242, s[12:15], s72 offen offset:3072 sc1
    buffer_load_dwordx4 v[124:127], v242, s[12:15], s73 offen offset:3072 sc1
    buffer_load_dwordx4 v[112:115], v242, s[12:15], s70 offen offset:3072 sc1
    buffer_load_dwordx4 v[132:135], v244, s[12:15], s71 offen offset:0 sc1
    buffer_load_dwordx4 v[136:139], v244, s[12:15], s72 offen offset:0 sc1
    buffer_load_dwordx4 v[140:143], v244, s[12:15], s73 offen offset:0 sc1
    buffer_load_dwordx4 v[128:131], v244, s[12:15], s70 offen offset:0 sc1
    buffer_load_dwordx4 v[148:151], v245, s[12:15], s71 offen offset:0 sc1
    buffer_load_dwordx4 v[152:155], v245, s[12:15], s72 offen offset:0 sc1
    buffer_load_dwordx4 v[156:159], v245, s[12:15], s73 offen offset:0 sc1
    buffer_load_dwordx4 v[144:147], v245, s[12:15], s70 offen offset:0 sc1
    buffer_load_dwordx4 v[164:167], v246, s[12:15], s71 offen offset:0 sc1
    buffer_load_dwordx4 v[168:171], v246, s[12:15], s72 offen offset:0 sc1
    buffer_load_dwordx4 v[172:175], v246, s[12:15], s73 offen offset:0 sc1
    buffer_load_dwordx4 v[160:163], v246, s[12:15], s70 offen offset:0 sc1
    s_branch L_back_a_6_1
    s_nop 0
L_slow_a_7_1:
    s_mov_b32 s75, 0
L_slow_a_7_1_a:
    buffer_load_dwordx4 v[116:119], v242, s[12:15], s71 offen offset:3072 sc1
    buffer_load_dwordx4 v[120:123], v242, s[12:15], s72 offen offset:3072 sc1
    buffer_load_dwordx4 v[124:127], v242, s[12:15], s73 offen offset:3072 sc1
    buffer_load_dwordx4 v[112:115], v242, s[12:15], s70 offen offset:3072 sc1
    s_waitcnt vmcnt(0)
    v_xor_b32 v116, v200, v116
    v_xor_b32 v117, v201, v117
    v_xor_b32 v118, v202, v118
    v_or3_b32 v248, v116, v117, v118
    v_xor_b32 v119, v203, v119
    v_xor_b32 v120, v200, v120
    v_or3_b32 v248, v248, v119, v120
    v_xor_b32 v121, v201, v121
    v_xor_b32 v122, v202, v122
    v_or3_b32 v248, v248, v121, v122
    v_xor_b32 v123, v203, v123
    v_xor_b32 v124, v200, v124
    v_or3_b32 v248, v248, v123, v124
    v_xor_b32 v125, v201, v125
    v_xor_b32 v126, v202, v126
    v_or3_b32 v248, v248, v125, v126
    v_xor_b32 v127, v203, v127
    v_xor_b32 v112, v200, v112
    v_or3_b32 v248, v248, v127, v112
    v_xor_b32 v113, v201, v113
    v_xor_b32 v114, v202, v114
    v_or3_b32 v248, v248, v113, v114
    v_xor_b32 v115, v203, v115
    v_bitop3_b32 v248, v248, v115, s3 bitop3:0xa8
    v_cmp_ne_u32 vcc, 0, v248
    s_cbranch_vccz L_slow_a_7_1_r
    s_add_u32 s75, s75, 1
    s_cmp_lt_u32 s75, 4000
    s_cbranch_scc1 L_slow_a_7_1_a
L_slow_a_7_1_r:
    buffer_load_dwordx4 v[132:135], v244, s[12:15], s71 offen offset:0 sc1
    buffer_load_dwordx4 v[136:139], v244, s[12:15], s72 offen offset:0 sc1
    buffer_load_dwordx4 v[140:143], v244, s[12:15], s73 offen offset:0 sc1
    buffer_load_dwordx4 v[128:131], v244, s[12:15], s70 offen offset:0 sc1
    buffer_load_dwordx4 v[148:151], v245, s[12:15], s71 offen offset:0 sc1
    buffer_load_dwordx4 v[152:155], v245, s[12:15], s72 offen offset:0 sc1
    buffer_load_dwordx4 v[156:159], v245, s[12:15], s73 offen offset:0 sc1
    buffer_load_dwordx4 v[144:147], v245, s[12:15], s70 offen offset:0 sc1
    buffer_load_dwordx4 v[164:167], v246, s[12:15], s71 offen offset:0 sc1
    buffer_load_dwordx4 v[168:171], v246, s[12:15], s72 offen offset:0 sc1
    buffer_load_dwordx4 v[172:175], v246, s[12:15], s73 offen offset:0 sc1
    buffer_load_dwordx4 v[160:163], v246, s[12:15], s70 offen offset:0 sc1
    buffer_load_dwordx4 v[180:183], v243, s[12:15], s71 offen offset:0 sc1
    buffer_load_dwordx4 v[184:187], v243, s[12:15], s72 offen offset:0 sc1
    buffer_load_dwordx4 v[188:191], v243, s[12:15], s73 offen offset:0 sc1
    buffer_load_dwordx4 v[176:179], v243, s[12:15], s70 offen offset:0 sc1
    s_branch L_back_a_7_1
    s_nop 0
L_slow_a_8_1:
    s_mov_b32 s75, 0
L_slow_a_8_1_a:
    buffer_load_dwordx4 v[132:135], v244, s[12:15], s71 offen offset:0 sc1
    buffer_load_dwordx4 v[136:139], v244, s[12:15], s72 offen offset:0 sc1
    buffer_load_dwordx4 v[140:143], v244, s[12:15], s73 offen offset:0 sc1
    buffer_load_dwordx4 v[128:131], v244, s[12:15], s70 offen offset:0 sc1
    s_waitcnt vmcnt(0)
    v_xor_b32 v132, v200, v132
    v_xor_b32 v133, v201, v133
    v_xor_b32 v134, v202, v134
    v_or3_b32 v248, v132, v133, v134
    v_xor_b32 v135, v203, v135
    v_xor_b32 v136, v200, v136
    v_or3_b32 v248, v248, v135, v136
    v_xor_b32 v137, v201, v137
    v_xor_b32 v138, v202, v138
    v_or3_b32 v248, v248, v137, v138
    v_xor_b32 v139, v203, v139
    v_xor_b32 v140, v200, v140
    v_or3_b32 v248, v248, v139, v140
    v_xor_b32 v141, v201, v141
    v_xor_b32 v142, v202, v142
    v_or3_b32 v248, v248, v141, v142
    v_xor_b32 v143, v203, v143
    v_xor_b32 v128, v200, v128
    v_or3_b32 v248, v248, v143, v128
    v_xor_b32 v129, v201, v129
    v_xor_b32 v130, v202, v130
    v_or3_b32 v248, v248, v129, v130
    v_xor_b32 v131, v203, v131
    v_bitop3_b32 v248, v248, v131, s3 bitop3:0xa8
    v_cmp_ne_u32 vcc, 0, v248
    s_cbranch_vccz L_slow_a_8_1_r
    s_add_u32 s75, s75, 1
    s_cmp_lt_u32 s75, 4000
    s_cbranch_scc1 L_slow_a_8_1_a
L_slow_a_8_1_r:
    buffer_load_dwordx4 v[148:151], v245, s[12:15], s71 offen offset:0 sc1
    buffer_load_dwordx4 v[152:155], v245, s[12:15], s72 offen offset:0 sc1
    buffer_load_dwordx4 v[156:159], v245, s[12:15], s73 offen offset:0 sc1
    buffer_load_dwordx4 v[144:147], v245, s[12:15], s70 offen offset:0 sc1
    buffer_load_dwordx4 v[164:167], v246, s[12:15], s71 offen offset:0 sc1
    buffer_load_dwordx4 v[168:171], v246, s[12:15], s72 offen offset:0 sc1
    buffer_load_dwordx4 v[172:175], v246, s[12:15], s73 offen offset:0 sc1
    buffer_load_dwordx4 v[160:163], v246, s[12:15], s70 offen offset:0 sc1
    buffer_load_dwordx4 v[180:183], v243, s[12:15], s71 offen offset:0 sc1
    buffer_load_dwordx4 v[184:187], v243, s[12:15], s72 offen offset:0 sc1
    buffer_load_dwordx4 v[188:191], v243, s[12:15], s73 offen offset:0 sc1
    buffer_load_dwordx4 v[176:179], v243, s[12:15], s70 offen offset:0 sc1
    buffer_load_dwordx4 v[68:71], v243, s[12:15], s71 offen offset:1024 sc1
    buffer_load_dwordx4 v[84:87], v243, s[12:15], s71 offen offset:2048 sc1
    buffer_load_dwordx4 v[100:103], v243, s[12:15], s71 offen offset:3072 sc1
    buffer_load_dwordx4 v[72:75], v243, s[12:15], s72 offen offset:1024 sc1
    s_branch L_back_a_8_1
    s_nop 0
L_slow_a_9_1:
    s_mov_b32 s75, 0
L_slow_a_9_1_a:
    buffer_load_dwordx4 v[148:151], v245, s[12:15], s71 offen offset:0 sc1
    buffer_load_dwordx4 v[152:155], v245, s[12:15], s72 offen offset:0 sc1
    buffer_load_dwordx4 v[156:159], v245, s[12:15], s73 offen offset:0 sc1
    buffer_load_dwordx4 v[144:147], v245, s[12:15], s70 offen offset:0 sc1
    s_waitcnt vmcnt(0)
    v_xor_b32 v148, v200, v148
    v_xor_b32 v149, v201, v149
    v_xor_b32 v150, v202, v150
    v_or3_b32 v248, v148, v149, v150
    v_xor_b32 v151, v203, v151
    v_xor_b32 v152, v200, v152
    v_or3_b32 v248, v248, v151, v152
    v_xor_b32 v153, v201, v153
    v_xor_b32 v154, v202, v154
    v_or3_b32 v248, v248, v153, v154
    v_xor_b32 v155, v203, v155
    v_xor_b32 v156, v200, v156
    v_or3_b32 v248, v248, v155, v156
    v_xor_b32 v157, v201, v157
    v_xor_b32 v158, v202, v158
    v_or3_b32 v248, v248, v157, v158
    v_xor_b32 v159, v203, v159
    v_xor_b32 v144, v200, v144
    v_or3_b32 v248, v248, v159, v144
    v_xor_b32 v145, v201, v145
    v_xor_b32 v146, v202, v146
    v_or3_b32 v248, v248, v145, v146
    v_xor_b32 v147, v203, v147
    v_bitop3_b32 v248, v248, v147, s3 bitop3:0xa8
    v_cmp_ne_u32 vcc, 0, v248
    s_cbranch_vccz L_slow_a_9_1_r
    s_add_u32 s75, s75, 1
    s_cmp_lt_u32 s75, 4000
    s_cbranch_scc1 L_slow_a_9_1_a
L_slow_a_9_1_r:
    buffer_load_dwordx4 v[164:167], v246, s[12:15], s71 offen offset:0 sc1
    buffer_load_dwordx4 v[168:171], v246, s[12:15], s72 offen offset:0 sc1
    buffer_load_dwordx4 v[172:175], v246, s[12:15], s73 offen offset:0 sc1
    buffer_load_dwordx4 v[160:163], v246, s[12:15], s70 offen offset:0 sc1
    buffer_load_dwordx4 v[180:183], v243, s[12:15], s71 offen offset:0 sc1
    buffer_load_dwordx4 v[184:187], v243, s[12:15], s72 offen offset:0 sc1
    buffer_load_dwordx4 v[188:191], v243, s[12:15], s73 offen offset:0 sc1
    buffer_load_dwordx4 v[176:179], v243, s[12:15], s70 offen offset:0 sc1
    buffer_load_dwordx4 v[68:71], v243, s[12:15], s71 offen offset:1024 sc1
    buffer_load_dwordx4 v[84:87], v243, s[12:15], s71 offen offset:2048 sc1
    buffer_load_dwordx4 v[100:103], v243, s[12:15], s71 offen offset:3072 sc1
    buffer_load_dwordx4 v[72:75], v243, s[12:15], s72 offen offset:1024 sc1
    buffer_load_dwordx4 v[88:91], v243, s[12:15], s72 offen offset:2048 sc1
    buffer_load_dwordx4 v[104:107], v243, s[12:15], s72 offen offset:3072 sc1
    buffer_load_dwordx4 v[76:79], v243, s[12:15], s73 offen offset:1024 sc1
    buffer_load_dwordx4 v[92:95], v243, s[12:15], s73 offen offset:2048 sc1
    s_branch L_back_a_9_1
    s_nop 0
L_slow_a_10_1:
    s_mov_b32 s75, 0
L_slow_a_10_1_a:
    buffer_load_dwordx4 v[164:167], v246, s[12:15], s71 offen offset:0 sc1
    buffer_load_dwordx4 v[168:171], v246, s[12:15], s72 offen offset:0 sc1
    buffer_load_dwordx4 v[172:175], v246, s[12:15], s73 offen offset:0 sc1
    buffer_load_dwordx4 v[160:163], v246, s[12:15], s70 offen offset:0 sc1
    s_waitcnt vmcnt(0)
    v_xor_b32 v164, v200, v164
    v_xor_b32 v165, v201, v165
    v_xor_b32 v166, v202, v166
    v_or3_b32 v248, v164, v165, v166
    v_xor_b32 v167, v203, v167
    v_xor_b32 v168, v200, v168
    v_or3_b32 v248, v248, v167, v168
    v_xor_b32 v169, v201, v169
    v_xor_b32 v170, v202, v170
    v_or3_b32 v248, v248, v169, v170
    v_xor_b32 v171, v203, v171
    v_xor_b32 v172, v200, v172
    v_or3_b32 v248, v248, v171, v172
    v_xor_b32 v173, v201, v173
    v_xor_b32 v174, v202, v174
    v_or3_b32 v248, v248, v173, v174
    v_xor_b32 v175, v203, v175
    v_xor_b32 v160, v200, v160
    v_or3_b32 v248, v248, v175, v160
    v_xor_b32 v161, v201, v161
    v_xor_b32 v162, v202, v162
    v_or3_b32 v248, v248, v161, v162
    v_xor_b32 v163, v203, v163
    v_bitop3_b32 v248, v248, v163, s3 bitop3:0xa8
    v_cmp_ne_u32 vcc, 0, v248
    s_cbranch_vccz L_slow_a_10_1_r
    s_add_u32 s75, s75, 1
    s_cmp_lt_u32 s75, 4000
    s_cbranch_scc1 L_slow_a_10_1_a
L_slow_a_10_1_r:
    buffer_load_dwordx4 v[180:183], v243, s[12:15], s71 offen offset:0 sc1
    buffer_load_dwordx4 v[184:187], v243, s[12:15], s72 offen offset:0 sc1
    buffer_load_dwordx4 v[188:191], v243, s[12:15], s73 offen offset:0 sc1
    buffer_load_dwordx4 v[176:179], v243, s[12:15], s70 offen offset:0 sc1
    buffer_load_dwordx4 v[68:71], v243, s[12:15], s71 offen offset:1024 sc1
    buffer_load_dwordx4 v[84:87], v243, s[12:15], s71 offen offset:2048 sc1
    buffer_load_dwordx4 v[100:103], v243, s[12:15], s71 offen offset:3072 sc1
    buffer_load_dwordx4 v[72:75], v243, s[12:15], s72 offen offset:1024 sc1
    buffer_load_dwordx4 v[88:91], v243, s[12:15], s72 offen offset:2048 sc1
    buffer_load_dwordx4 v[104:107], v243, s[12:15], s72 offen offset:3072 sc1
    buffer_load_dwordx4 v[76:79], v243, s[12:15], s73 offen offset:1024 sc1
    buffer_load_dwordx4 v[92:95], v243, s[12:15], s73 offen offset:2048 sc1
    buffer_load_dwordx4 v[108:111], v243, s[12:15], s73 offen offset:3072 sc1
    buffer_load_dwordx4 v[64:67], v243, s[12:15], s70 offen offset:1024 sc1
    buffer_load_dwordx4 v[80:83], v243, s[12:15], s70 offen offset:2048 sc1
    buffer_load_dwordx4 v[96:99], v243, s[12:15], s70 offen offset:3072 sc1
    s_branch L_back_a_10_1
    s_nop 0
L_slow_a_11_1:
    s_mov_b32 s75, 0
L_slow_a_11_1_a:
    buffer_load_dwordx4 v[180:183], v243, s[12:15], s71 offen offset:0 sc1
    buffer_load_dwordx4 v[184:187], v243, s[12:15], s72 offen offset:0 sc1
    buffer_load_dwordx4 v[188:191], v243, s[12:15], s73 offen offset:0 sc1
    buffer_load_dwordx4 v[176:179], v243, s[12:15], s70 offen offset:0 sc1
    s_waitcnt vmcnt(0)
    v_max3_u32 v248, v180, v184, v188
    v_max_u32 v248, v248, v176
    v_cmp_eq_u32 vcc, -1, v248
    s_cbranch_vccz L_slow_a_11_1_r
    s_add_u32 s75, s75, 1
    s_cmp_lt_u32 s75, 4000
    s_cbranch_scc1 L_slow_a_11_1_a
L_slow_a_11_1_r:
    buffer_load_dwordx4 v[68:71], v243, s[12:15], s71 offen offset:1024 sc1
    buffer_load_dwordx4 v[84:87], v243, s[12:15], s71 offen offset:2048 sc1
    buffer_load_dwordx4 v[100:103], v243, s[12:15], s71 offen offset:3072 sc1
    buffer_load_dwordx4 v[72:75], v243, s[12:15], s72 offen offset:1024 sc1
    buffer_load_dwordx4 v[88:91], v243, s[12:15], s72 offen offset:2048 sc1
    buffer_load_dwordx4 v[104:107], v243, s[12:15], s72 offen offset:3072 sc1
    buffer_load_dwordx4 v[76:79], v243, s[12:15], s73 offen offset:1024 sc1
    buffer_load_dwordx4 v[92:95], v243, s[12:15], s73 offen offset:2048 sc1
    buffer_load_dwordx4 v[108:111], v243, s[12:15], s73 offen offset:3072 sc1
    buffer_load_dwordx4 v[64:67], v243, s[12:15], s70 offen offset:1024 sc1
    buffer_load_dwordx4 v[80:83], v243, s[12:15], s70 offen offset:2048 sc1
    buffer_load_dwordx4 v[96:99], v243, s[12:15], s70 offen offset:3072 sc1
    buffer_load_dword v252, off, s[12:15], 0
    s_waitcnt vmcnt(0)
    buffer_load_dword v252, off, s[12:15], 0
    s_waitcnt vmcnt(0)
    buffer_load_dword v252, off, s[12:15], 0
    s_waitcnt vmcnt(0)
    buffer_load_dword v252, off, s[12:15], 0
    s_branch L_back_a_11_1
    s_nop 0
L_slow_a_12_1:
    s_mov_b32 s75, 0
L_slow_a_12_1_a:
    buffer_load_dwordx4 v[68:71], v243, s[12:15], s71 offen offset:1024 sc1
    buffer_load_dwordx4 v[84:87], v243, s[12:15], s71 offen offset:2048 sc1
    buffer_load_dwordx4 v[100:103], v243, s[12:15], s71 offen offset:3072 sc1
    s_waitcnt vmcnt(0)
    v_max3_u32 v248, v68, v84, v100
    v_cmp_eq_u32 vcc, -1, v248
    s_cbranch_vccz L_slow_a_12_1_r
    s_add_u32 s75, s75, 1
    s_cmp_lt_u32 s75, 4000
    s_cbranch_scc1 L_slow_a_12_1_a
L_slow_a_12_1_r:
    buffer_load_dwordx4 v[72:75], v243, s[12:15], s72 offen offset:1024 sc1
    buffer_load_dwordx4 v[88:91], v243, s[12:15], s72 offen offset:2048 sc1
    buffer_load_dwordx4 v[104:107], v243, s[12:15], s72 offen offset:3072 sc1
    buffer_load_dwordx4 v[76:79], v243, s[12:15], s73 offen offset:1024 sc1
    buffer_load_dwordx4 v[92:95], v243, s[12:15], s73 offen offset:2048 sc1
    buffer_load_dwordx4 v[108:111], v243, s[12:15], s73 offen offset:3072 sc1
    buffer_load_dwordx4 v[64:67], v243, s[12:15], s70 offen offset:1024 sc1
    buffer_load_dwordx4 v[80:83], v243, s[12:15], s70 offen offset:2048 sc1
    buffer_load_dwordx4 v[96:99], v243, s[12:15], s70 offen offset:3072 sc1
    buffer_load_dword v252, off, s[12:15], 0
    s_waitcnt vmcnt(0)
    buffer_load_dword v252, off, s[12:15], 0
    s_waitcnt vmcnt(0)
    buffer_load_dword v252, off, s[12:15], 0
    s_waitcnt vmcnt(0)
    buffer_load_dword v252, off, s[12:15], 0
    s_branch L_back_a_12_1
    s_nop 0
L_slow_a_12_2:
    s_mov_b32 s75, 0
L_slow_a_12_2_a:
    buffer_load_dwordx4 v[72:75], v243, s[12:15], s72 offen offset:1024 sc1
    buffer_load_dwordx4 v[88:91], v243, s[12:15], s72 offen offset:2048 sc1
    buffer_load_dwordx4 v[104:107], v243, s[12:15], s72 offen offset:3072 sc1
    s_waitcnt vmcnt(0)
    v_max3_u32 v248, v72, v88, v104
    v_cmp_eq_u32 vcc, -1, v248
    s_cbranch_vccz L_slow_a_12_2_r
    s_add_u32 s75, s75, 1
    s_cmp_lt_u32 s75, 4000
    s_cbranch_scc1 L_slow_a_12_2_a
L_slow_a_12_2_r:
    buffer_load_dwordx4 v[76:79], v243, s[12:15], s73 offen offset:1024 sc1
    buffer_load_dwordx4 v[92:95], v243, s[12:15], s73 offen offset:2048 sc1
    buffer_load_dwordx4 v[108:111], v243, s[12:15], s73 offen offset:3072 sc1
    buffer_load_dwordx4 v[64:67], v243, s[12:15], s70 offen offset:1024 sc1
    buffer_load_dwordx4 v[80:83], v243, s[12:15], s70 offen offset:2048 sc1
    buffer_load_dwordx4 v[96:99], v243, s[12:15], s70 offen offset:3072 sc1
    buffer_load_dword v252, off, s[12:15], 0
    s_waitcnt vmcnt(0)
    buffer_load_dword v252, off, s[12:15], 0
    s_waitcnt vmcnt(0)
    buffer_load_dword v252, off, s[12:15], 0
    s_waitcnt vmcnt(0)
    buffer_load_dword v252, off, s[12:15], 0
    s_branch L_back_a_12_2
    s_nop 0
L_slow_a_12_3:
    s_mov_b32 s75, 0
L_slow_a_12_3_a:
    buffer_load_dwordx4 v[76:79], v243, s[12:15], s73 offen offset:1024 sc1
    buffer_load_dwordx4 v[92:95], v243, s[12:15], s73 offen offset:2048 sc1
    buffer_load_dwordx4 v[108:111], v243, s[12:15], s73 offen offset:3072 sc1
    s_waitcnt vmcnt(0)
    v_max3_u32 v248, v76, v92, v108
    v_cmp_eq_u32 vcc, -1, v248
    s_cbranch_vccz L_slow_a_12_3_r
    s_add_u32 s75, s75, 1
    s_cmp_lt_u32 s75, 4000
    s_cbranch_scc1 L_slow_a_12_3_a
L_slow_a_12_3_r:
    buffer_load_dwordx4 v[64:67], v243, s[12:15], s70 offen offset:1024 sc1
    buffer_load_dwordx4 v[80:83], v243, s[12:15], s70 offen offset:2048 sc1
    buffer_load_dwordx4 v[96:99], v243, s[12:15], s70 offen offset:3072 sc1
    buffer_load_dword v252, off, s[12:15], 0
    s_waitcnt vmcnt(0)
    buffer_load_dword v252, off, s[12:15], 0
    s_waitcnt vmcnt(0)
    buffer_load_dword v252, off, s[12:15], 0
    s_waitcnt vmcnt(0)
    buffer_load_dword v252, off, s[12:15], 0
    s_branch L_back_a_12_3
    s_nop 0
L_slow_a_12_0:
    s_mov_b32 s75, 0
L_slow_a_12_0_a:
    buffer_load_dwordx4 v[64:67], v243, s[12:15], s70 offen offset:1024 sc1
    buffer_load_dwordx4 v[80:83], v243, s[12:15], s70 offen offset:2048 sc1
    buffer_load_dwordx4 v[96:99], v243, s[12:15], s70 offen offset:3072 sc1
    s_waitcnt vmcnt(0)
    v_max3_u32 v248, v64, v80, v96
    v_cmp_eq_u32 vcc, -1, v248
    s_cbranch_vccz L_slow_a_12_0_r
    s_add_u32 s75, s75, 1
    s_cmp_lt_u32 s75, 4000
    s_cbranch_scc1 L_slow_a_12_0_a
L_slow_a_12_0_r:
    buffer_load_dword v252, off, s[12:15], 0
    s_waitcnt vmcnt(0)
    buffer_load_dword v252, off, s[12:15], 0
    s_waitcnt vmcnt(0)
    buffer_load_dword v252, off, s[12:15], 0
    s_waitcnt vmcnt(0)
    buffer_load_dword v252, off, s[12:15], 0
    s_branch L_back_a_12_0
L_end:
    s_endpgm
.section .rodata,"a"
.p2align 6
.amdhsa_kernel parallel_sum__sliding_local_dilated__dense_activation_relu__prompt_kernel
  .amdhsa_next_free_vgpr 512
  .amdhsa_next_free_sgpr 102
  .amdhsa_accum_offset 256
  .amdhsa_group_segment_fixed_size 0
  .amdhsa_kernarg_size 72
  .amdhsa_user_sgpr_count 2
  .amdhsa_user_sgpr_kernarg_segment_ptr 1
  .amdhsa_system_sgpr_workgroup_id_x 1
.end_amdhsa_kernel
```
